```python
import torch

def _softmax(x, axis=-1):
    return torch.softmax(x, dim=axis)
def _gelu(x):
    return torch.nn.functional.gelu(x, approximate="tanh")
def _silu(x):
    return torch.nn.functional.silu(x)
def _sigmoid(x):
    return torch.sigmoid(x)
def _layernorm(x, axis=-1, eps=1e-5):
    m = x.mean(dim=axis, keepdim=True)
    v = x.var(dim=axis, keepdim=True, unbiased=False)
    return (x - m) / torch.sqrt(v + eps)
def _scatter_add(tgt, idx, src, axis=0):
    return tgt.clone().index_add_(axis, idx, src)
def _segment_sum(src, seg, n):
    out = torch.zeros((n,) + src.shape[1:], dtype=src.dtype)
    return out.index_add_(0, seg, src)
def _pad(x, pw):
    flat = tuple(v for pair in reversed(pw) for v in pair)
    return torch.nn.functional.pad(x, flat)

kernel_name = 'standalone__self_sup_conv_stem_hubert__speech'

def setup_inputs():

    _w = (lambda a: (lambda t: t.to(torch.bfloat16) if t.is_floating_point() else t)(torch.as_tensor(a)))
    B, T, D, K = 2, 4000, 512, 31
    scale = (1.0 / (K * D)) ** 0.5
    return {
        "x": _w((lambda *s: torch.randn(*s, dtype=torch.bfloat16) * 0.05)(B, T, D)),
        "w": _w((lambda *s: torch.randn(*s, dtype=torch.bfloat16) * 0.05)(K, D, D) * scale),
        "b": _w((lambda *s: torch.randn(*s, dtype=torch.bfloat16) * 0.05)(D) * 0.1),
        "gamma": _w(torch.ones((D,), dtype=float)),
        "beta": _w(torch.zeros((D,), dtype=float)),
    }

def reference(x, w, b, gamma, beta):
    B, T, D = x.shape
    K = w.shape[0]
    s = 2
    L = (T - K) // s + 1
    y = torch.einsum('blc,cd->bld', x[:, 0 : s * L : s, :], w[0])
    for i in range(1, K):
        y = y + torch.einsum('blc,cd->bld', x[:, i : i + s * L : s, :], w[i])
    y = y + b[None, None, :]
    mu = y.mean(1, keepdims=True)
    var = ((y - mu) ** 2).mean(1, keepdims=True)
    yn = (y - mu) / torch.sqrt(var + 1e-5)
    yn = yn * gamma[None, None, :] + beta[None, None, :]
    return _gelu(yn)
```

```asm
; @launch grid=(256,1,1) block=(256,1,1) lds=155648
.amdgcn_target "amdgcn-amd-amdhsa--gfx950"
.text
.globl standalone__self_sup_conv_stem_hubert__speech_kernel
.p2align 12
.p2align 8
.type standalone__self_sup_conv_stem_hubert__speech_kernel,@function
standalone__self_sup_conv_stem_hubert__speech_kernel:
s_cmp_ge_u32 s2, 256
s_cbranch_scc1 L_done
s_load_dwordx16 s[48:63], s[0:1], 0
v_lshrrev_b32 v1, 6, v0
v_and_b32 v0, 63, v0
s_and_b32 s40, s2, 0xf8
s_lshl_b32 s40, s40, 1
s_add_u32 s40, s40, 32
v_and_b32 v46, 3, v0
v_lshl_add_u32 v46, v1, 2, v46
v_add_u32 v46, s40, v46
v_cmp_gt_u32 vcc, 8, v0
v_lshl_add_u32 v47, v1, 3, v0
s_getpc_b64 s[38:39]
L_pc0:
v_cndmask_b32 v46, v46, v47, vcc
v_lshlrev_b32 v46, 7, v46
v_min_u32 v46, L_end-L_pc0-4, v46
global_load_dword a192, v46, s[38:39]
s_and_b32 s29, s2, 1
s_bfe_u32 s25, s2, 0x10003
s_and_b32 s38, s2, 6
s_or_b32 s25, s25, s38
s_xor_b32 s100, s2, 1
s_lshr_b32 s47, s2, 4
v_readfirstlane_b32 s24, v1
s_and_b32 s26, s47, 7
s_lshr_b32 s27, s47, 3
s_mul_i32 s38, s27, 4000
s_mul_i32 s39, s26, 496
s_add_u32 s38, s38, s39
s_lshl_b32 s38, s38, 1
s_add_u32 s38, s38, s29
s_lshl_b32 s34, s38, 9
s_lshl_b32 s39, s24, 16
s_add_u32 s38, s34, s39
v_lshrrev_b32 v40, 4, v0
v_bfe_u32 v41, v0, 3, 1
v_lshl_add_u32 v42, v41, 4, v40
v_lshlrev_b32 v42, 11, v42
v_add_u32 v42, s38, v42
v_and_b32 v43, 7, v0
s_lshl_b32 s39, s24, 1
v_xor_b32 v44, s39, v43
v_lshl_add_u32 v9, v44, 4, v42
s_lshl_b32 s39, s24, 13
s_add_u32 s38, s34, s39
s_add_u32 s38, s38, 524288
v_lshlrev_b32 v42, 11, v40
v_lshl_add_u32 v42, v43, 4, v42
v_lshl_add_u32 v42, v41, 30, v42
v_add_u32 v10, s38, v42
s_lshl_b32 s41, s24, 12
s_lshl_b32 s46, s24, 10
s_mov_b32 s6, 8192000
s_mov_b32 s7, 0x20000
s_mov_b32 s10, 16252928
s_mov_b32 s11, 0x20000
s_lshr_b32 s31, s24, 1
s_and_b32 s32, s24, 1
v_lshrrev_b32 v44, 3, v0
v_and_b32 v45, 2, v44
v_xor_b32 v43, v43, v45
s_lshl_b32 s38, s29, 18
s_lshl_b32 s39, s24, 14
s_add_u32 s38, s38, s39
s_lshl_b32 s39, s25, 7
s_add_u32 s38, s38, s39
v_lshlrev_b32 v44, 10, v44
v_add_u32 v44, s38, v44
v_lshlrev_b32 v45, 4, v43
v_xor_b32 v46, 64, v45
v_add_u32 v5, v44, v45
v_add_u32 v6, v44, v46
v_add_u32 v6, 7168, v6
s_lshl_b32 s39, s31, 15
s_lshl_b32 s40, s32, 11
s_add_u32 s30, s39, s40
s_add_u32 s30, s30, 73728
s_min_u32 s22, s47, 14
s_lshl_b32 s22, s22, 20
s_lshl_b32 s21, s47, 20
v_lshrrev_b32 v46, 2, v0
v_lshlrev_b32 v46, 10, v46
v_add_u32 v11, s38, v46
s_add_u32 s22, s22, 524288
s_mov_b32 s35, 0
s_mov_b32 s101, 0
s_mov_b32 m0, s41
s_lshl_b32 s38, s29, 18
s_lshl_b32 s39, s25, 7
s_add_u32 s38, s38, s39
s_lshl_b32 s39, s24, 12
s_add_u32 s38, s38, s39
s_and_b32 s39, s47, 3
s_lshl_b32 s39, s39, 14
s_add_u32 s38, s38, s39
s_lshr_b32 s39, s47, 2
s_lshl_b32 s39, s39, 20
s_add_u32 s28, s38, s39
v_lshlrev_b32 v47, 10, v40
s_lshl_b32 s38, s31, 2
v_add_u32 v41, s38, v40
v_and_b32 v42, 15, v0
v_add_u32 v43, 0, v42
v_lshrrev_b32 v44, 1, v43
v_and_b32 v45, 3, v44
v_lshlrev_b32 v45, 1, v45
v_xor_b32 v45, v45, v41
v_and_b32 v43, 1, v43
v_lshlrev_b32 v43, 7, v43
v_lshl_add_u32 v43, v45, 4, v43
v_lshl_add_u32 v1, v44, 12, v43
v_add_u32 v43, 1, v42
v_lshrrev_b32 v44, 1, v43
v_and_b32 v45, 3, v44
v_lshlrev_b32 v45, 1, v45
v_xor_b32 v45, v45, v41
v_and_b32 v43, 1, v43
v_lshlrev_b32 v43, 7, v43
v_lshl_add_u32 v43, v45, 4, v43
v_lshl_add_u32 v2, v44, 12, v43
v_bfe_u32 v42, v0, 2, 2
v_lshl_add_u32 v43, v40, 3, v42
v_lshlrev_b32 v43, 7, v43
v_and_b32 v44, 3, v0
v_lshl_add_u32 v43, v44, 3, v43
s_lshl_b32 s38, s31, 15
s_add_u32 s38, s38, 73728
v_add_u32 v43, s38, v43
v_lshrrev_b32 v42, 1, v42
v_and_b32 v44, 1, v40
v_lshl_or_b32 v42, v44, 1, v42
s_lshl_b32 s38, s29, 1
s_add_u32 s38, s38, s32
v_xor_b32 v42, s38, v42
v_lshl_add_u32 v3, v42, 5, v43
v_xor_b32 v4, 64, v3
s_mov_b32 s20, 0x07060302
s_mov_b32 s1, 0xffff0000
s_mov_b32 s37, 3
s_mov_b32 s3, 0
s_mov_b32 s33, 1048576
s_mov_b32 s34, 128
s_waitcnt lgkmcnt(0)
s_mov_b64 s[4:5], s[48:49]
s_mov_b64 s[8:9], s[50:51]
buffer_load_dwordx4 v9, s[4:7], s101 offen lds
s_add_u32 m0, s41, 16384
s_mov_b32 s101, 262144
buffer_load_dwordx4 v9, s[4:7], s101 offen lds
s_add_u32 m0, s41, 1024
s_mov_b32 s101, 8192
buffer_load_dwordx4 v9, s[4:7], s101 offen lds
s_add_u32 m0, s41, 17408
s_mov_b32 s101, 270336
buffer_load_dwordx4 v9, s[4:7], s101 offen lds
s_add_u32 m0, s41, 2048
s_mov_b32 s101, 16384
buffer_load_dwordx4 v9, s[4:7], s101 offen lds
s_add_u32 m0, s41, 18432
s_mov_b32 s101, 278528
buffer_load_dwordx4 v9, s[4:7], s101 offen lds
s_add_u32 m0, s41, 3072
s_mov_b32 s101, 24576
buffer_load_dwordx4 v9, s[4:7], s101 offen lds
s_add_u32 m0, s41, 19456
s_mov_b32 s101, 286720
buffer_load_dwordx4 v9, s[4:7], s101 offen lds
s_add_u32 m0, s46, 32768
s_mov_b32 s101, 0
buffer_load_dwordx4 v10, s[4:7], s101 offen lds
buffer_load_dword a192, v47, s[8:11], s28 offen
s_add_u32 m0, s30, 0
s_mov_b32 s36, 0
buffer_load_dwordx4 v5, s[8:11], s36 offen offset:0 lds
buffer_load_dwordx4 v6, s[8:11], s36 offen offset:1024 lds
s_lshl_b32 s28, s27, 3
s_add_u32 s28, s28, s25
s_lshl_b32 s38, s28, 14
s_add_u32 s12, s62, s38
s_addc_u32 s13, s63, 0
s_mov_b32 s14, 16384
s_mov_b32 s15, 0x20000
s_lshr_b32 s38, s100, 1
s_lshl_b32 s38, s38, 16
s_add_u32 s38, s38, 2097152
s_add_u32 s96, s62, s38
s_addc_u32 s97, s63, 0
s_mov_b32 s98, 65536
s_mov_b32 s99, 0x20000
s_mov_b32 s95, 4096
s_mov_b64 s[16:17], s[60:61]
s_mov_b32 s18, 256
s_mov_b32 s19, 0x20000
s_mov_b64 exec, 0
s_cmp_eq_u32 s24, 1
s_cbranch_scc1 L_pad1
s_cmp_eq_u32 s24, 2
s_cbranch_scc1 L_pad2
s_cmp_eq_u32 s24, 3
s_cbranch_scc1 L_pad3
s_branch L_pad0
L_hret:
s_mov_b64 exec, -1
s_waitcnt vmcnt(10)
s_barrier
ds_read_b128 v[156:159], v1 offset:0
ds_read_b128 v[96:99], v1 offset:256
ds_read_b128 v[76:79], v1 offset:512
ds_read_b128 v[80:83], v1 offset:768
s_add_u32 m0, s30, 4096
s_mov_b32 s36, 1048576
buffer_load_dwordx4 v5, s[8:11], s36 offen offset:0 lds
buffer_load_dwordx4 v6, s[8:11], s36 offen offset:1024 lds
s_waitcnt vmcnt(10)
s_barrier
ds_read_b128 v[160:163], v1 offset:1024
ds_read_b128 v[148:151], v1 offset:1280
ds_read_b128 v[140:143], v1 offset:1536
ds_read_b128 v[108:111], v1 offset:1792
s_waitcnt lgkmcnt(5)
v_lshlrev_b64 v[16:17], 16, v[96:97]
v_lshlrev_b64 v[18:19], 16, v[76:77]
v_add_f32 v20, v96, v76
v_add_f32 v21, v97, v77
v_add_f32 v16, v16, v18
v_add_f32 v17, v17, v19
v_perm_b32 v84, v20, v16, s20
v_perm_b32 v85, v21, v17, s20
v_lshlrev_b64 v[22:23], 16, v[98:99]
v_lshlrev_b64 v[24:25], 16, v[78:79]
v_add_f32 v26, v98, v78
v_add_f32 v27, v99, v79
v_add_f32 v22, v22, v24
v_add_f32 v23, v23, v25
v_cvt_pk_bf16_f32 v86, v22, v26
v_perm_b32 v87, v27, v23, s20
s_add_u32 m0, s30, 8192
s_mov_b32 s36, 2097152
buffer_load_dwordx4 v5, s[8:11], s36 offen offset:0 lds
buffer_load_dwordx4 v6, s[8:11], s36 offen offset:1024 lds
s_waitcnt vmcnt(10)
s_barrier
ds_read_b128 v[132:135], v1 offset:2048
ds_read_b128 v[128:131], v1 offset:2304
ds_read_b128 v[116:119], v1 offset:2560
ds_read_b128 v[120:123], v1 offset:2816
s_waitcnt lgkmcnt(7)
v_lshlrev_b64 v[16:17], 16, v[80:81]
v_lshlrev_b64 v[18:19], 16, v[160:161]
v_add_f32 v20, v80, v160
v_add_f32 v21, v81, v161
v_add_f32 v16, v16, v18
v_add_f32 v17, v17, v19
v_perm_b32 v164, v20, v16, s20
v_perm_b32 v165, v21, v17, s20
v_lshlrev_b64 v[22:23], 16, v[82:83]
v_lshlrev_b64 v[24:25], 16, v[162:163]
v_add_f32 v26, v82, v162
v_add_f32 v27, v83, v163
v_add_f32 v22, v22, v24
v_add_f32 v23, v23, v25
v_cvt_pk_bf16_f32 v166, v22, v26
v_perm_b32 v167, v27, v23, s20
s_waitcnt lgkmcnt(5)
v_lshlrev_b64 v[16:17], 16, v[148:149]
v_lshlrev_b64 v[18:19], 16, v[140:141]
v_add_f32 v20, v148, v140
v_add_f32 v21, v149, v141
v_add_f32 v16, v16, v18
v_add_f32 v17, v17, v19
v_perm_b32 v144, v20, v16, s20
v_perm_b32 v145, v21, v17, s20
v_lshlrev_b64 v[22:23], 16, v[150:151]
v_lshlrev_b64 v[24:25], 16, v[142:143]
v_add_f32 v26, v150, v142
v_add_f32 v27, v151, v143
v_add_f32 v22, v22, v24
v_add_f32 v23, v23, v25
v_cvt_pk_bf16_f32 v146, v22, v26
v_perm_b32 v147, v27, v23, s20
s_add_u32 m0, s30, 12288
s_mov_b32 s36, 3145728
buffer_load_dwordx4 v5, s[8:11], s36 offen offset:0 lds
buffer_load_dwordx4 v6, s[8:11], s36 offen offset:1024 lds
s_waitcnt vmcnt(10)
s_barrier
ds_read_b128 v[104:107], v1 offset:3072
ds_read_b128 v[92:95], v1 offset:3328
ds_read_b128 v[88:91], v1 offset:3584
ds_read_b128 v[100:103], v1 offset:3840
s_waitcnt lgkmcnt(7)
v_lshlrev_b64 v[16:17], 16, v[108:109]
v_lshlrev_b64 v[18:19], 16, v[132:133]
v_add_f32 v20, v108, v132
v_add_f32 v21, v109, v133
v_add_f32 v16, v16, v18
v_add_f32 v17, v17, v19
v_perm_b32 v136, v20, v16, s20
v_perm_b32 v137, v21, v17, s20
v_lshlrev_b64 v[22:23], 16, v[110:111]
v_lshlrev_b64 v[24:25], 16, v[134:135]
v_add_f32 v26, v110, v134
v_add_f32 v27, v111, v135
v_add_f32 v22, v22, v24
v_add_f32 v23, v23, v25
v_cvt_pk_bf16_f32 v138, v22, v26
v_perm_b32 v139, v27, v23, s20
s_waitcnt lgkmcnt(5)
v_lshlrev_b64 v[16:17], 16, v[128:129]
v_lshlrev_b64 v[18:19], 16, v[116:117]
v_add_f32 v20, v128, v116
v_add_f32 v21, v129, v117
v_add_f32 v16, v16, v18
v_add_f32 v17, v17, v19
v_perm_b32 v124, v20, v16, s20
v_perm_b32 v125, v21, v17, s20
v_lshlrev_b64 v[22:23], 16, v[130:131]
v_lshlrev_b64 v[24:25], 16, v[118:119]
v_add_f32 v26, v130, v118
v_add_f32 v27, v131, v119
v_add_f32 v22, v22, v24
v_add_f32 v23, v23, v25
v_cvt_pk_bf16_f32 v126, v22, v26
v_perm_b32 v127, v27, v23, s20
buffer_load_dword a192, v11, s[8:11], s21 offen
s_add_u32 s21, s21, 65536
s_waitcnt lgkmcnt(3)
v_lshlrev_b64 v[16:17], 16, v[120:121]
v_lshlrev_b64 v[18:19], 16, v[104:105]
v_add_f32 v20, v120, v104
v_add_f32 v21, v121, v105
v_add_f32 v16, v16, v18
v_add_f32 v17, v17, v19
v_perm_b32 v112, v20, v16, s20
v_perm_b32 v113, v21, v17, s20
v_lshlrev_b64 v[22:23], 16, v[122:123]
v_lshlrev_b64 v[24:25], 16, v[106:107]
v_add_f32 v26, v122, v106
v_add_f32 v27, v123, v107
v_add_f32 v22, v22, v24
v_add_f32 v23, v23, v25
v_cvt_pk_bf16_f32 v114, v22, v26
v_perm_b32 v115, v27, v23, s20
s_waitcnt vmcnt(5)
s_barrier
ds_read_b64_tr_b16 v[28:29], v3 offset:0
ds_read_b64_tr_b16 v[30:31], v3 offset:512
ds_read_b64_tr_b16 v[32:33], v4 offset:0
ds_read_b64_tr_b16 v[34:35], v4 offset:512
ds_read_b128 v[152:155], v2 offset:0
ds_read_b64_tr_b16 v[44:45], v3 offset:4096
ds_read_b64_tr_b16 v[46:47], v3 offset:4608
ds_read_b64_tr_b16 v[48:49], v4 offset:4096
ds_read_b64_tr_b16 v[50:51], v4 offset:4608
s_add_u32 m0, s30, 16384
s_mov_b32 s36, 4194304
buffer_load_dwordx4 v5, s[8:11], s36 offen offset:0 lds
buffer_load_dwordx4 v6, s[8:11], s36 offen offset:1024 lds
s_add_u32 m0, s30, 20480
s_mov_b32 s36, 5242880
buffer_load_dwordx4 v5, s[8:11], s36 offen offset:0 lds
buffer_load_dwordx4 v6, s[8:11], s36 offen offset:1024 lds
s_add_u32 m0, s30, 24576
s_mov_b32 s36, 6291456
buffer_load_dwordx4 v5, s[8:11], s36 offen offset:0 lds
buffer_load_dwordx4 v6, s[8:11], s36 offen offset:1024 lds
s_add_u32 m0, s30, 28672
s_mov_b32 s36, 7340032
buffer_load_dwordx4 v5, s[8:11], s36 offen offset:0 lds
buffer_load_dwordx4 v6, s[8:11], s36 offen offset:1024 lds
s_waitcnt lgkmcnt(7)
s_branch L_main
.p2align 12
L_pg:
L_pad0:
s_branch L_pad4
s_nop 0
L_main:
v_mfma_f32_16x16x32_bf16 a[0:3], v[28:31], v[156:159], 0
s_waitcnt lgkmcnt(2)
v_lshlrev_b64 v[16:17], 16, v[28:29]
v_lshlrev_b64 v[18:19], 16, v[44:45]
v_mfma_f32_16x16x32_bf16 a[4:7], v[32:35], v[156:159], 0
s_add_u32 m0, s41, 36864
v_add_f32 v20, v28, v44
v_add_f32 v21, v29, v45
v_mfma_f32_16x16x32_bf16 a[12:15], v[32:35], v[76:79], 0
s_lshl_b32 s38, s26, 1
v_add_f32 v16, v16, v18
v_add_f32 v17, v17, v19
v_mfma_f32_16x16x32_bf16 a[8:11], v[28:31], v[76:79], 0
s_add_u32 s38, s38, s31
s_mov_b32 s101, 1024
v_perm_b32 v60, v20, v16, s20
v_perm_b32 v61, v21, v17, s20
v_mfma_f32_16x16x32_bf16 a[16:19], v[28:31], v[160:163], 0
s_lshl_b32 s38, s38, 1
buffer_load_dwordx4 v9, s[4:7], s101 offen lds
v_mfma_f32_16x16x32_bf16 a[20:23], v[32:35], v[160:163], 0
s_add_u32 s38, s38, s29
v_lshlrev_b64 v[22:23], 16, v[30:31]
v_lshlrev_b64 v[24:25], 16, v[46:47]
v_mfma_f32_16x16x32_bf16 a[28:31], v[32:35], v[140:143], 0
s_lshl_b32 s38, s38, 1
v_add_f32 v26, v30, v46
v_add_f32 v27, v31, v47
v_mfma_f32_16x16x32_bf16 a[24:27], v[28:31], v[140:143], 0
s_add_u32 s38, s38, s32
s_mov_b32 s101, 9216
v_add_f32 v22, v22, v24
v_add_f32 v23, v23, v25
v_mfma_f32_16x16x32_bf16 a[32:35], v[28:31], v[132:135], 0
s_lshl_b32 s38, s38, 7
s_add_u32 m0, s41, 37888
v_cvt_pk_bf16_f32 v62, v22, v26
v_perm_b32 v63, v27, v23, s20
v_mfma_f32_16x16x32_bf16 a[36:39], v[32:35], v[132:135], 0
s_waitcnt lgkmcnt(0)
s_lshl_b32 s39, s29, 2
v_lshlrev_b64 v[16:17], 16, v[32:33]
v_lshlrev_b64 v[18:19], 16, v[48:49]
v_mfma_f32_16x16x32_bf16 a[44:47], v[32:35], v[116:119], 0
s_add_u32 s39, s39, s24
buffer_load_dwordx4 v9, s[4:7], s101 offen lds
v_mfma_f32_16x16x32_bf16 a[40:43], v[28:31], v[116:119], 0
s_lshl_b32 s39, s39, 13
ds_read_b128 v[172:175], v2 offset:256
v_add_f32 v20, v32, v48
v_mfma_f32_16x16x32_bf16 a[48:51], v[28:31], v[104:107], 0
s_lshl_b32 s40, s25, 1
ds_read_b128 v[228:231], v2 offset:512
v_add_f32 v21, v33, v49
v_mfma_f32_16x16x32_bf16 a[52:55], v[32:35], v[104:107], 0
s_add_u32 s40, s40, s29
v_add_f32 v16, v16, v18
v_add_f32 v17, v17, v19
v_mfma_f32_16x16x32_bf16 a[60:63], v[32:35], v[88:91], 0
s_lshl_b32 s40, s40, 1
s_mov_b32 s101, 17408
v_perm_b32 v64, v20, v16, s20
v_perm_b32 v65, v21, v17, s20
v_mfma_f32_16x16x32_bf16 a[56:59], v[28:31], v[88:91], 0
s_add_u32 s40, s40, s32
s_add_u32 m0, s41, 38912
v_lshlrev_b64 v[22:23], 16, v[34:35]
v_lshlrev_b64 v[24:25], 16, v[50:51]
v_mfma_f32_16x16x32_bf16 a[64:67], v[44:47], v[96:99], 0
s_lshl_b32 s40, s40, 5
buffer_load_dwordx4 v9, s[4:7], s101 offen lds
v_mfma_f32_16x16x32_bf16 a[68:71], v[48:51], v[96:99], 0
s_lshl_b32 s47, s29, 6
v_add_f32 v26, v34, v50
v_add_f32 v27, v35, v51
v_mfma_f32_16x16x32_bf16 a[76:79], v[48:51], v[80:83], 0
v_add_f32 v22, v22, v24
v_add_f32 v23, v23, v25
v_mfma_f32_16x16x32_bf16 a[72:75], v[44:47], v[80:83], 0
v_cvt_pk_bf16_f32 v66, v22, v26
v_perm_b32 v67, v27, v23, s20
v_mfma_f32_16x16x32_bf16 a[80:83], v[44:47], v[148:151], 0
v_lshlrev_b64 v[16:17], 16, v[92:93]
v_lshlrev_b64 v[18:19], 16, v[88:89]
v_mfma_f32_16x16x32_bf16 a[84:87], v[48:51], v[148:151], 0
v_add_f32 v20, v92, v88
v_add_f32 v21, v93, v89
v_mfma_f32_16x16x32_bf16 a[92:95], v[48:51], v[108:111], 0
v_add_f32 v16, v16, v18
v_add_f32 v17, v17, v19
v_mfma_f32_16x16x32_bf16 a[88:91], v[44:47], v[108:111], 0
s_waitcnt vmcnt(12)
v_perm_b32 v224, v20, v16, s20
v_perm_b32 v225, v21, v17, s20
v_mfma_f32_16x16x32_bf16 a[96:99], v[44:47], v[128:131], 0
s_barrier
ds_read_b64_tr_b16 v[36:37], v3 offset:8192
v_mfma_f32_16x16x32_bf16 a[100:103], v[48:51], v[128:131], 0
ds_read_b64_tr_b16 v[38:39], v3 offset:8704
v_lshlrev_b64 v[22:23], 16, v[94:95]
v_mfma_f32_16x16x32_bf16 a[108:111], v[48:51], v[120:123], 0
ds_read_b64_tr_b16 v[40:41], v4 offset:8192
v_lshlrev_b64 v[24:25], 16, v[90:91]
v_mfma_f32_16x16x32_bf16 a[104:107], v[44:47], v[120:123], 0
ds_read_b64_tr_b16 v[42:43], v4 offset:8704
v_add_f32 v26, v94, v90
v_mfma_f32_16x16x32_bf16 a[112:115], v[44:47], v[92:95], 0
ds_read_b64_tr_b16 v[52:53], v3 offset:12288
v_add_f32 v27, v95, v91
v_mfma_f32_16x16x32_bf16 a[116:119], v[48:51], v[92:95], 0
ds_read_b64_tr_b16 v[54:55], v3 offset:12800
v_add_f32 v22, v22, v24
v_mfma_f32_16x16x32_bf16 a[124:127], v[48:51], v[100:103], 0
s_add_u32 s36, s35, 8388608
ds_read_b64_tr_b16 v[56:57], v4 offset:12288
v_add_f32 v23, v23, v25
v_mfma_f32_16x16x32_bf16 a[120:123], v[44:47], v[100:103], 0
s_add_u32 m0, s30, 0
ds_read_b64_tr_b16 v[58:59], v4 offset:12800
v_cvt_pk_bf16_f32 v226, v22, v26
v_mfma_f32_16x16x32_bf16 a[128:131], v[60:63], v[84:87], 0
buffer_load_dwordx4 v5, s[8:11], s36 offen offset:0 lds
v_mfma_f32_16x16x32_bf16 a[132:135], v[64:67], v[84:87], 0
buffer_load_dwordx4 v6, s[8:11], s36 offen offset:1024 lds
v_mfma_f32_16x16x32_bf16 a[140:143], v[64:67], v[164:167], 0
s_add_u32 s36, s35, 9437184
v_perm_b32 v227, v27, v23, s20
v_lshlrev_b64 v[16:17], 16, v[100:101]
v_mfma_f32_16x16x32_bf16 a[136:139], v[60:63], v[164:167], 0
s_add_u32 m0, s30, 4096
v_lshlrev_b64 v[18:19], 16, v[152:153]
v_add_f32 v20, v100, v152
v_mfma_f32_16x16x32_bf16 a[144:147], v[60:63], v[144:147], 0
buffer_load_dwordx4 v5, s[8:11], s36 offen offset:0 lds
v_mfma_f32_16x16x32_bf16 a[148:151], v[64:67], v[144:147], 0
v_add_f32 v21, v101, v153
v_add_f32 v16, v16, v18
v_mfma_f32_16x16x32_bf16 a[156:159], v[64:67], v[136:139], 0
ds_read_b128 v[84:87], v2 offset:768
v_add_f32 v17, v17, v19
v_mfma_f32_16x16x32_bf16 a[152:155], v[60:63], v[136:139], 0
ds_read_b128 v[232:235], v2 offset:1024
v_perm_b32 v96, v20, v16, s20
v_mfma_f32_16x16x32_bf16 a[160:163], v[60:63], v[124:127], 0
v_perm_b32 v97, v21, v17, s20
v_lshlrev_b64 v[22:23], 16, v[102:103]
v_mfma_f32_16x16x32_bf16 a[164:167], v[64:67], v[124:127], 0
buffer_load_dwordx4 v6, s[8:11], s36 offen offset:1024 lds
v_mfma_f32_16x16x32_bf16 a[172:175], v[64:67], v[112:115], 0
v_lshlrev_b64 v[24:25], 16, v[154:155]
v_add_f32 v26, v102, v154
v_mfma_f32_16x16x32_bf16 a[168:171], v[60:63], v[112:115], 0
v_add_f32 v27, v103, v155
v_add_f32 v22, v22, v24
v_mfma_f32_16x16x32_bf16 a[176:179], v[60:63], v[224:227], 0
v_add_f32 v23, v23, v25
v_cvt_pk_bf16_f32 v98, v22, v26
v_perm_b32 v99, v27, v23, s20
v_mfma_f32_16x16x32_bf16 a[180:183], v[64:67], v[224:227], 0
s_waitcnt lgkmcnt(4)
v_lshlrev_b64 v[16:17], 16, v[36:37]
v_lshlrev_b64 v[18:19], 16, v[52:53]
v_mfma_f32_16x16x32_bf16 a[188:191], v[64:67], v[96:99], 0
v_add_f32 v20, v36, v52
v_add_f32 v21, v37, v53
v_mfma_f32_16x16x32_bf16 a[184:187], v[60:63], v[96:99], 0
v_add_f32 v16, v16, v18
v_add_f32 v17, v17, v19
v_mfma_f32_16x16x32_bf16 a[0:3], v[36:39], v[76:79], a[0:3]
s_waitcnt vmcnt(11) lgkmcnt(2)
v_perm_b32 v68, v20, v16, s20
v_perm_b32 v69, v21, v17, s20
v_mfma_f32_16x16x32_bf16 a[4:7], v[40:43], v[76:79], a[4:7]
s_barrier
ds_read_b64_tr_b16 v[28:29], v3 offset:16384
v_mfma_f32_16x16x32_bf16 a[12:15], v[40:43], v[160:163], a[12:15]
ds_read_b64_tr_b16 v[30:31], v3 offset:16896
v_lshlrev_b64 v[22:23], 16, v[38:39]
v_mfma_f32_16x16x32_bf16 a[8:11], v[36:39], v[160:163], a[8:11]
ds_read_b64_tr_b16 v[32:33], v4 offset:16384
v_lshlrev_b64 v[24:25], 16, v[54:55]
v_mfma_f32_16x16x32_bf16 a[16:19], v[36:39], v[140:143], a[16:19]
ds_read_b64_tr_b16 v[34:35], v4 offset:16896
v_add_f32 v26, v38, v54
v_mfma_f32_16x16x32_bf16 a[20:23], v[40:43], v[140:143], a[20:23]
ds_read_b64_tr_b16 v[44:45], v3 offset:20480
v_add_f32 v27, v39, v55
v_mfma_f32_16x16x32_bf16 a[28:31], v[40:43], v[132:135], a[28:31]
ds_read_b64_tr_b16 v[46:47], v3 offset:20992
v_add_f32 v22, v22, v24
v_mfma_f32_16x16x32_bf16 a[24:27], v[36:39], v[132:135], a[24:27]
ds_read_b64_tr_b16 v[48:49], v4 offset:20480
v_add_f32 v23, v23, v25
v_mfma_f32_16x16x32_bf16 a[32:35], v[36:39], v[116:119], a[32:35]
ds_read_b64_tr_b16 v[50:51], v4 offset:20992
v_cvt_pk_bf16_f32 v70, v22, v26
v_mfma_f32_16x16x32_bf16 a[36:39], v[40:43], v[116:119], a[36:39]
v_perm_b32 v71, v27, v23, s20
v_lshlrev_b64 v[16:17], 16, v[40:41]
v_mfma_f32_16x16x32_bf16 a[44:47], v[40:43], v[104:107], a[44:47]
s_add_u32 s36, s35, 10485760
ds_read_b128 v[156:159], v2 offset:1280
v_lshlrev_b64 v[18:19], 16, v[56:57]
v_mfma_f32_16x16x32_bf16 a[40:43], v[36:39], v[104:107], a[40:43]
s_add_u32 m0, s30, 8192
ds_read_b128 v[76:79], v2 offset:1536
v_add_f32 v20, v40, v56
v_mfma_f32_16x16x32_bf16 a[48:51], v[36:39], v[88:91], a[48:51]
buffer_load_dwordx4 v5, s[8:11], s36 offen offset:0 lds
v_mfma_f32_16x16x32_bf16 a[52:55], v[40:43], v[88:91], a[52:55]
v_add_f32 v21, v41, v57
v_add_f32 v16, v16, v18
v_mfma_f32_16x16x32_bf16 a[60:63], v[40:43], v[152:155], a[60:63]
v_add_f32 v17, v17, v19
v_perm_b32 v72, v20, v16, s20
v_mfma_f32_16x16x32_bf16 a[56:59], v[36:39], v[152:155], a[56:59]
v_perm_b32 v73, v21, v17, s20
v_lshlrev_b64 v[22:23], 16, v[42:43]
v_mfma_f32_16x16x32_bf16 a[64:67], v[52:55], v[80:83], a[64:67]
v_lshlrev_b64 v[24:25], 16, v[58:59]
v_add_f32 v26, v42, v58
v_mfma_f32_16x16x32_bf16 a[68:71], v[56:59], v[80:83], a[68:71]
v_add_f32 v27, v43, v59
v_add_f32 v22, v22, v24
v_mfma_f32_16x16x32_bf16 a[76:79], v[56:59], v[148:151], a[76:79]
buffer_load_dwordx4 v6, s[8:11], s36 offen offset:1024 lds
v_mfma_f32_16x16x32_bf16 a[72:75], v[52:55], v[148:151], a[72:75]
v_add_f32 v23, v23, v25
v_cvt_pk_bf16_f32 v74, v22, v26
v_mfma_f32_16x16x32_bf16 a[80:83], v[52:55], v[108:111], a[80:83]
v_perm_b32 v75, v27, v23, s20
v_lshlrev_b64 v[16:17], 16, v[172:173]
v_mfma_f32_16x16x32_bf16 a[84:87], v[56:59], v[108:111], a[84:87]
v_lshlrev_b64 v[18:19], 16, v[228:229]
v_add_f32 v20, v172, v228
v_mfma_f32_16x16x32_bf16 a[92:95], v[56:59], v[128:131], a[92:95]
s_add_u32 s36, s35, 11534336
v_add_f32 v21, v173, v229
v_add_f32 v16, v16, v18
v_mfma_f32_16x16x32_bf16 a[88:91], v[52:55], v[128:131], a[88:91]
s_add_u32 m0, s30, 12288
v_add_f32 v17, v17, v19
v_perm_b32 v176, v20, v16, s20
v_mfma_f32_16x16x32_bf16 a[96:99], v[52:55], v[120:123], a[96:99]
buffer_load_dwordx4 v5, s[8:11], s36 offen offset:0 lds
v_mfma_f32_16x16x32_bf16 a[100:103], v[56:59], v[120:123], a[100:103]
v_perm_b32 v177, v21, v17, s20
v_lshlrev_b64 v[22:23], 16, v[174:175]
v_mfma_f32_16x16x32_bf16 a[108:111], v[56:59], v[92:95], a[108:111]
v_lshlrev_b64 v[24:25], 16, v[230:231]
v_add_f32 v26, v174, v230
v_mfma_f32_16x16x32_bf16 a[104:107], v[52:55], v[92:95], a[104:107]
v_add_f32 v27, v175, v231
v_add_f32 v22, v22, v24
v_mfma_f32_16x16x32_bf16 a[112:115], v[52:55], v[100:103], a[112:115]
v_add_f32 v23, v23, v25
v_cvt_pk_bf16_f32 v178, v22, v26
v_mfma_f32_16x16x32_bf16 a[116:119], v[56:59], v[100:103], a[116:119]
v_perm_b32 v179, v27, v23, s20
v_lshlrev_b32 v81, 4, v0
v_mfma_f32_16x16x32_bf16 a[124:127], v[56:59], v[172:175], a[124:127]
buffer_load_dwordx4 v6, s[8:11], s36 offen offset:1024 lds
v_mfma_f32_16x16x32_bf16 a[120:123], v[52:55], v[172:175], a[120:123]
v_lshrrev_b32 v82, 3, v0
v_and_b32 v80, 0x70, v81
v_mfma_f32_16x16x32_bf16 a[128:131], v[68:71], v[164:167], a[128:131]
v_add_u32 v13, s39, v81
v_lshl_add_u32 v80, v82, 13, v80
v_mfma_f32_16x16x32_bf16 a[132:135], v[72:75], v[164:167], a[132:135]
v_lshrrev_b32 v83, 4, v0
v_add_u32 v80, s38, v80
v_mfma_f32_16x16x32_bf16 a[140:143], v[72:75], v[144:147], a[140:143]
s_mov_b32 s101, 25600
v_lshl_add_u32 v83, v83, 3, s40
v_accvgpr_write_b32 a200, -1
v_mfma_f32_16x16x32_bf16 a[136:139], v[68:71], v[144:147], a[136:139]
s_add_u32 m0, s41, 39936
v_accvgpr_write_b32 a201, -1
v_accvgpr_write_b32 a202, -1
v_mfma_f32_16x16x32_bf16 a[144:147], v[68:71], v[136:139], a[144:147]
buffer_load_dwordx4 v9, s[4:7], s101 offen lds
v_mfma_f32_16x16x32_bf16 a[148:151], v[72:75], v[136:139], a[148:151]
v_accvgpr_write_b32 a203, -1
v_mov_b32 v7, v5
v_mfma_f32_16x16x32_bf16 a[156:159], v[72:75], v[124:127], a[156:159]
ds_read_b128 v[196:199], v2 offset:1792
v_mov_b32 v8, v6
v_mfma_f32_16x16x32_bf16 a[152:155], v[68:71], v[124:127], a[152:155]
v_bfe_u32 v81, v5, 6, 1
v_and_b32 v82, 0xffffffbf, v5
v_mfma_f32_16x16x32_bf16 a[160:163], v[68:71], v[112:115], a[160:163]
s_mov_b32 s101, 263168
v_xor_b32 v81, s29, v81
v_add_u32 v82, s47, v82
v_mfma_f32_16x16x32_bf16 a[164:167], v[72:75], v[112:115], a[164:167]
s_add_u32 m0, s41, 53248
v_lshl_add_u32 v14, v81, 20, v82
v_xor_b32 v81, 1, v81
v_mfma_f32_16x16x32_bf16 a[172:175], v[72:75], v[224:227], a[172:175]
buffer_load_dwordx4 v9, s[4:7], s101 offen lds
v_mfma_f32_16x16x32_bf16 a[168:171], v[68:71], v[224:227], a[168:171]
v_add_u32 v82, 7168, v82
v_lshl_add_u32 v15, v81, 20, v82
v_mfma_f32_16x16x32_bf16 a[176:179], v[68:71], v[96:99], a[176:179]
s_waitcnt lgkmcnt(5)
v_lshlrev_b64 v[16:17], 16, v[28:29]
v_lshlrev_b64 v[18:19], 16, v[44:45]
v_mfma_f32_16x16x32_bf16 a[180:183], v[72:75], v[96:99], a[180:183]
v_add_f32 v20, v28, v44
v_add_f32 v21, v29, v45
v_mfma_f32_16x16x32_bf16 a[188:191], v[72:75], v[176:179], a[188:191]
v_add_f32 v16, v16, v18
v_add_f32 v17, v17, v19
v_mfma_f32_16x16x32_bf16 a[184:187], v[68:71], v[176:179], a[184:187]
v_perm_b32 v60, v20, v16, s20
v_perm_b32 v61, v21, v17, s20
v_mfma_f32_16x16x32_bf16 a[0:3], v[28:31], v[160:163], a[0:3]
s_waitcnt vmcnt(13) lgkmcnt(3)
v_lshlrev_b64 v[22:23], 16, v[30:31]
v_lshlrev_b64 v[24:25], 16, v[46:47]
v_mfma_f32_16x16x32_bf16 a[4:7], v[32:35], v[160:163], a[4:7]
s_barrier
ds_read_b64_tr_b16 v[36:37], v3 offset:24576
v_mfma_f32_16x16x32_bf16 a[12:15], v[32:35], v[140:143], a[12:15]
ds_read_b64_tr_b16 v[38:39], v3 offset:25088
v_add_f32 v26, v30, v46
v_mfma_f32_16x16x32_bf16 a[8:11], v[28:31], v[140:143], a[8:11]
ds_read_b64_tr_b16 v[40:41], v4 offset:24576
v_add_f32 v27, v31, v47
v_mfma_f32_16x16x32_bf16 a[16:19], v[28:31], v[132:135], a[16:19]
ds_read_b64_tr_b16 v[42:43], v4 offset:25088
v_add_f32 v22, v22, v24
v_mfma_f32_16x16x32_bf16 a[20:23], v[32:35], v[132:135], a[20:23]
ds_read_b64_tr_b16 v[52:53], v3 offset:28672
v_add_f32 v23, v23, v25
v_mfma_f32_16x16x32_bf16 a[28:31], v[32:35], v[116:119], a[28:31]
ds_read_b64_tr_b16 v[54:55], v3 offset:29184
v_cvt_pk_bf16_f32 v62, v22, v26
v_mfma_f32_16x16x32_bf16 a[24:27], v[28:31], v[116:119], a[24:27]
ds_read_b64_tr_b16 v[56:57], v4 offset:28672
v_perm_b32 v63, v27, v23, s20
v_mfma_f32_16x16x32_bf16 a[32:35], v[28:31], v[104:107], a[32:35]
ds_read_b64_tr_b16 v[58:59], v4 offset:29184
v_lshlrev_b64 v[16:17], 16, v[32:33]
v_mfma_f32_16x16x32_bf16 a[36:39], v[32:35], v[104:107], a[36:39]
v_lshlrev_b64 v[18:19], 16, v[48:49]
v_add_f32 v20, v32, v48
v_mfma_f32_16x16x32_bf16 a[44:47], v[32:35], v[88:91], a[44:47]
s_add_u32 s36, s35, 12582912
v_add_f32 v21, v33, v49
v_add_f32 v16, v16, v18
v_mfma_f32_16x16x32_bf16 a[40:43], v[28:31], v[88:91], a[40:43]
s_add_u32 m0, s30, 16384
v_add_f32 v17, v17, v19
v_perm_b32 v64, v20, v16, s20
v_mfma_f32_16x16x32_bf16 a[48:51], v[28:31], v[152:155], a[48:51]
buffer_load_dwordx4 v5, s[8:11], s36 offen offset:0 lds
v_mfma_f32_16x16x32_bf16 a[52:55], v[32:35], v[152:155], a[52:55]
v_perm_b32 v65, v21, v17, s20
v_lshlrev_b64 v[22:23], 16, v[34:35]
v_mfma_f32_16x16x32_bf16 a[60:63], v[32:35], v[228:231], a[60:63]
v_lshlrev_b64 v[24:25], 16, v[50:51]
v_add_f32 v26, v34, v50
v_mfma_f32_16x16x32_bf16 a[56:59], v[28:31], v[228:231], a[56:59]
v_add_f32 v27, v35, v51
v_add_f32 v22, v22, v24
v_mfma_f32_16x16x32_bf16 a[64:67], v[44:47], v[148:151], a[64:67]
v_add_f32 v23, v23, v25
v_cvt_pk_bf16_f32 v66, v22, v26
v_mfma_f32_16x16x32_bf16 a[68:71], v[48:51], v[148:151], a[68:71]
v_perm_b32 v67, v27, v23, s20
v_lshlrev_b64 v[16:17], 16, v[84:85]
v_mfma_f32_16x16x32_bf16 a[76:79], v[48:51], v[108:111], a[76:79]
buffer_load_dwordx4 v6, s[8:11], s36 offen offset:1024 lds
v_mfma_f32_16x16x32_bf16 a[72:75], v[44:47], v[108:111], a[72:75]
v_lshlrev_b64 v[18:19], 16, v[232:233]
v_add_f32 v20, v84, v232
v_mfma_f32_16x16x32_bf16 a[80:83], v[44:47], v[128:131], a[80:83]
v_add_f32 v21, v85, v233
v_add_f32 v16, v16, v18
v_mfma_f32_16x16x32_bf16 a[84:87], v[48:51], v[128:131], a[84:87]
v_add_f32 v17, v17, v19
v_perm_b32 v188, v20, v16, s20
v_mfma_f32_16x16x32_bf16 a[92:95], v[48:51], v[120:123], a[92:95]
s_add_u32 s36, s35, 13631488
v_perm_b32 v189, v21, v17, s20
v_lshlrev_b64 v[22:23], 16, v[86:87]
v_mfma_f32_16x16x32_bf16 a[88:91], v[44:47], v[120:123], a[88:91]
s_add_u32 m0, s30, 20480
v_lshlrev_b64 v[24:25], 16, v[234:235]
v_add_f32 v26, v86, v234
v_mfma_f32_16x16x32_bf16 a[96:99], v[44:47], v[92:95], a[96:99]
buffer_load_dwordx4 v5, s[8:11], s36 offen offset:0 lds
v_mfma_f32_16x16x32_bf16 a[100:103], v[48:51], v[92:95], a[100:103]
v_add_f32 v27, v87, v235
v_add_f32 v22, v22, v24
v_mfma_f32_16x16x32_bf16 a[108:111], v[48:51], v[100:103], a[108:111]
v_add_f32 v23, v23, v25
v_cvt_pk_bf16_f32 v190, v22, v26
v_mfma_f32_16x16x32_bf16 a[104:107], v[44:47], v[100:103], a[104:107]
s_waitcnt lgkmcnt(2)
v_perm_b32 v191, v27, v23, s20
v_lshlrev_b64 v[16:17], 16, v[36:37]
v_mfma_f32_16x16x32_bf16 a[112:115], v[44:47], v[172:175], a[112:115]
v_lshlrev_b64 v[18:19], 16, v[52:53]
v_add_f32 v20, v36, v52
v_mfma_f32_16x16x32_bf16 a[116:119], v[48:51], v[172:175], a[116:119]
v_add_f32 v21, v37, v53
v_add_f32 v16, v16, v18
v_mfma_f32_16x16x32_bf16 a[124:127], v[48:51], v[84:87], a[124:127]
buffer_load_dwordx4 v6, s[8:11], s36 offen offset:1024 lds
v_mfma_f32_16x16x32_bf16 a[120:123], v[44:47], v[84:87], a[120:123]
v_add_f32 v17, v17, v19
v_perm_b32 v68, v20, v16, s20
v_mfma_f32_16x16x32_bf16 a[128:131], v[60:63], v[144:147], a[128:131]
v_perm_b32 v69, v21, v17, s20
v_lshlrev_b64 v[22:23], 16, v[38:39]
v_mfma_f32_16x16x32_bf16 a[132:135], v[64:67], v[144:147], a[132:135]
v_lshlrev_b64 v[24:25], 16, v[54:55]
v_add_f32 v26, v38, v54
v_mfma_f32_16x16x32_bf16 a[140:143], v[64:67], v[136:139], a[140:143]
s_mov_b32 s101, 271360
v_add_f32 v27, v39, v55
v_add_f32 v22, v22, v24
v_mfma_f32_16x16x32_bf16 a[136:139], v[60:63], v[136:139], a[136:139]
s_add_u32 m0, s41, 54272
v_add_f32 v23, v23, v25
v_cvt_pk_bf16_f32 v70, v22, v26
v_mfma_f32_16x16x32_bf16 a[144:147], v[60:63], v[124:127], a[144:147]
buffer_load_dwordx4 v9, s[4:7], s101 offen lds
v_mfma_f32_16x16x32_bf16 a[148:151], v[64:67], v[124:127], a[148:151]
s_waitcnt lgkmcnt(0)
v_perm_b32 v71, v27, v23, s20
v_lshlrev_b64 v[16:17], 16, v[40:41]
v_mfma_f32_16x16x32_bf16 a[156:159], v[64:67], v[112:115], a[156:159]
v_lshlrev_b64 v[18:19], 16, v[56:57]
v_add_f32 v20, v40, v56
v_mfma_f32_16x16x32_bf16 a[152:155], v[60:63], v[112:115], a[152:155]
v_add_f32 v21, v41, v57
v_add_f32 v16, v16, v18
v_mfma_f32_16x16x32_bf16 a[160:163], v[60:63], v[224:227], a[160:163]
s_mov_b32 s101, 279552
v_add_f32 v17, v17, v19
v_perm_b32 v72, v20, v16, s20
v_mfma_f32_16x16x32_bf16 a[164:167], v[64:67], v[224:227], a[164:167]
s_add_u32 m0, s41, 55296
v_perm_b32 v73, v21, v17, s20
v_lshlrev_b64 v[22:23], 16, v[42:43]
v_mfma_f32_16x16x32_bf16 a[172:175], v[64:67], v[96:99], a[172:175]
buffer_load_dwordx4 v9, s[4:7], s101 offen lds
v_mfma_f32_16x16x32_bf16 a[168:171], v[60:63], v[96:99], a[168:171]
v_lshlrev_b64 v[24:25], 16, v[58:59]
v_add_f32 v26, v42, v58
v_mfma_f32_16x16x32_bf16 a[176:179], v[60:63], v[176:179], a[176:179]
v_add_f32 v27, v43, v59
v_add_f32 v22, v22, v24
v_mfma_f32_16x16x32_bf16 a[180:183], v[64:67], v[176:179], a[180:183]
v_add_f32 v23, v23, v25
v_cvt_pk_bf16_f32 v74, v22, v26
v_mfma_f32_16x16x32_bf16 a[188:191], v[64:67], v[188:191], a[188:191]
v_perm_b32 v75, v27, v23, s20
v_lshlrev_b64 v[16:17], 16, v[156:157]
v_mfma_f32_16x16x32_bf16 a[184:187], v[60:63], v[188:191], a[184:187]
v_lshlrev_b64 v[18:19], 16, v[76:77]
v_add_f32 v20, v156, v76
v_mfma_f32_16x16x32_bf16 a[0:3], v[36:39], v[140:143], a[0:3]
s_waitcnt vmcnt(12)
v_add_f32 v21, v157, v77
v_add_f32 v16, v16, v18
v_mfma_f32_16x16x32_bf16 a[4:7], v[40:43], v[140:143], a[4:7]
s_barrier
ds_read_b64_tr_b16 v[28:29], v3 offset:0
v_mfma_f32_16x16x32_bf16 a[12:15], v[40:43], v[132:135], a[12:15]
ds_read_b64_tr_b16 v[30:31], v3 offset:512
v_add_f32 v17, v17, v19
v_mfma_f32_16x16x32_bf16 a[8:11], v[36:39], v[132:135], a[8:11]
ds_read_b64_tr_b16 v[32:33], v4 offset:0
v_perm_b32 v192, v20, v16, s20
v_mfma_f32_16x16x32_bf16 a[16:19], v[36:39], v[116:119], a[16:19]
ds_read_b64_tr_b16 v[34:35], v4 offset:512
v_perm_b32 v193, v21, v17, s20
v_mfma_f32_16x16x32_bf16 a[20:23], v[40:43], v[116:119], a[20:23]
ds_read_b64_tr_b16 v[44:45], v3 offset:4096
v_lshlrev_b64 v[22:23], 16, v[158:159]
v_mfma_f32_16x16x32_bf16 a[28:31], v[40:43], v[104:107], a[28:31]
ds_read_b64_tr_b16 v[46:47], v3 offset:4608
v_lshlrev_b64 v[24:25], 16, v[78:79]
v_mfma_f32_16x16x32_bf16 a[24:27], v[36:39], v[104:107], a[24:27]
ds_read_b64_tr_b16 v[48:49], v4 offset:4096
v_add_f32 v26, v158, v78
v_mfma_f32_16x16x32_bf16 a[32:35], v[36:39], v[88:91], a[32:35]
ds_read_b64_tr_b16 v[50:51], v4 offset:4608
v_add_f32 v27, v159, v79
v_mfma_f32_16x16x32_bf16 a[36:39], v[40:43], v[88:91], a[36:39]
v_add_f32 v22, v22, v24
v_add_f32 v23, v23, v25
v_mfma_f32_16x16x32_bf16 a[44:47], v[40:43], v[152:155], a[44:47]
s_add_u32 s36, s35, 14680064
v_cvt_pk_bf16_f32 v194, v22, v26
v_perm_b32 v195, v27, v23, s20
v_mfma_f32_16x16x32_bf16 a[40:43], v[36:39], v[152:155], a[40:43]
s_add_u32 m0, s30, 24576
v_mul_u32_u24 v140, 752, v0
v_xor_b32 v12, 0, v13
v_mfma_f32_16x16x32_bf16 a[48:51], v[36:39], v[228:231], a[48:51]
buffer_load_dwordx4 v5, s[8:11], s36 offen offset:0 lds
v_mfma_f32_16x16x32_bf16 a[52:55], v[40:43], v[228:231], a[52:55]
v_lshrrev_b32 v141, 3, v0
v_add_u32 v12, v140, v12
v_mfma_f32_16x16x32_bf16 a[60:63], v[40:43], v[232:235], a[60:63]
s_waitcnt lgkmcnt(2)
v_lshl_add_u32 v12, v141, 20, v12
v_lshlrev_b64 v[16:17], 16, v[28:29]
v_mfma_f32_16x16x32_bf16 a[56:59], v[36:39], v[232:235], a[56:59]
v_lshlrev_b64 v[18:19], 16, v[44:45]
v_add_f32 v20, v28, v44
v_mfma_f32_16x16x32_bf16 a[64:67], v[52:55], v[108:111], a[64:67]
v_add_f32 v21, v29, v45
v_add_f32 v16, v16, v18
v_mfma_f32_16x16x32_bf16 a[68:71], v[56:59], v[108:111], a[68:71]
v_add_f32 v17, v17, v19
v_perm_b32 v60, v20, v16, s20
v_mfma_f32_16x16x32_bf16 a[76:79], v[56:59], v[128:131], a[76:79]
buffer_load_dwordx4 v6, s[8:11], s36 offen offset:1024 lds
v_mfma_f32_16x16x32_bf16 a[72:75], v[52:55], v[128:131], a[72:75]
v_perm_b32 v61, v21, v17, s20
v_lshlrev_b64 v[22:23], 16, v[30:31]
v_mfma_f32_16x16x32_bf16 a[80:83], v[52:55], v[120:123], a[80:83]
v_lshlrev_b64 v[24:25], 16, v[46:47]
v_add_f32 v26, v30, v46
v_mfma_f32_16x16x32_bf16 a[84:87], v[56:59], v[120:123], a[84:87]
s_add_u32 s36, s35, 15728640
v_add_f32 v27, v31, v47
v_add_f32 v22, v22, v24
v_mfma_f32_16x16x32_bf16 a[92:95], v[56:59], v[92:95], a[92:95]
s_add_u32 m0, s30, 28672
v_add_f32 v23, v23, v25
v_cvt_pk_bf16_f32 v62, v22, v26
v_mfma_f32_16x16x32_bf16 a[88:91], v[52:55], v[92:95], a[88:91]
s_waitcnt lgkmcnt(0)
v_perm_b32 v63, v27, v23, s20
v_lshlrev_b64 v[16:17], 16, v[32:33]
v_mfma_f32_16x16x32_bf16 a[96:99], v[52:55], v[100:103], a[96:99]
buffer_load_dwordx4 v5, s[8:11], s36 offen offset:0 lds
v_mfma_f32_16x16x32_bf16 a[100:103], v[56:59], v[100:103], a[100:103]
v_lshlrev_b64 v[18:19], 16, v[48:49]
v_add_f32 v20, v32, v48
v_mfma_f32_16x16x32_bf16 a[108:111], v[56:59], v[172:175], a[108:111]
v_add_f32 v21, v33, v49
v_add_f32 v16, v16, v18
v_mfma_f32_16x16x32_bf16 a[104:107], v[52:55], v[172:175], a[104:107]
v_add_f32 v17, v17, v19
v_perm_b32 v64, v20, v16, s20
v_mfma_f32_16x16x32_bf16 a[112:115], v[52:55], v[84:87], a[112:115]
v_perm_b32 v65, v21, v17, s20
v_lshlrev_b64 v[22:23], 16, v[34:35]
v_mfma_f32_16x16x32_bf16 a[116:119], v[56:59], v[84:87], a[116:119]
v_lshlrev_b64 v[24:25], 16, v[50:51]
v_add_f32 v26, v34, v50
v_mfma_f32_16x16x32_bf16 a[124:127], v[56:59], v[156:159], a[124:127]
buffer_load_dwordx4 v6, s[8:11], s36 offen offset:1024 lds
v_mfma_f32_16x16x32_bf16 a[120:123], v[52:55], v[156:159], a[120:123]
v_add_f32 v27, v35, v51
v_add_f32 v22, v22, v24
v_mfma_f32_16x16x32_bf16 a[128:131], v[68:71], v[136:139], a[128:131]
v_add_f32 v23, v23, v25
v_cvt_pk_bf16_f32 v66, v22, v26
v_mfma_f32_16x16x32_bf16 a[132:135], v[72:75], v[136:139], a[132:135]
v_perm_b32 v67, v27, v23, s20
v_mov_b32_dpp v108, v136 row_shl:1 row_mask:0xf bank_mask:0xf bound_ctrl:0
v_mfma_f32_16x16x32_bf16 a[140:143], v[72:75], v[124:127], a[140:143]
s_mov_b32 s101, 287744
v_mov_b32_dpp v109, v137 row_shl:1 row_mask:0xf bank_mask:0xf bound_ctrl:0
v_mov_b32_dpp v110, v138 row_shl:1 row_mask:0xf bank_mask:0xf bound_ctrl:0
v_mfma_f32_16x16x32_bf16 a[136:139], v[68:71], v[124:127], a[136:139]
s_add_u32 m0, s41, 56320
v_mov_b32_dpp v111, v139 row_shl:1 row_mask:0xf bank_mask:0xf bound_ctrl:0
v_mfma_f32_16x16x32_bf16 a[144:147], v[68:71], v[112:115], a[144:147]
buffer_load_dwordx4 v9, s[4:7], s101 offen lds
v_mfma_f32_16x16x32_bf16 a[148:151], v[72:75], v[112:115], a[148:151]
v_mfma_f32_16x16x32_bf16 a[156:159], v[72:75], v[224:227], a[156:159]
v_mfma_f32_16x16x32_bf16 a[152:155], v[68:71], v[224:227], a[152:155]
v_mfma_f32_16x16x32_bf16 a[160:163], v[68:71], v[96:99], a[160:163]
s_mov_b32 s101, 1024
v_mfma_f32_16x16x32_bf16 a[164:167], v[72:75], v[96:99], a[164:167]
s_add_u32 m0, s46, 69632
v_mfma_f32_16x16x32_bf16 a[172:175], v[72:75], v[176:179], a[172:175]
buffer_load_dwordx4 v10, s[4:7], s101 offen lds
v_mfma_f32_16x16x32_bf16 a[168:171], v[68:71], v[176:179], a[168:171]
s_add_u32 s2, s35, s22
v_mfma_f32_16x16x32_bf16 a[176:179], v[68:71], v[188:191], a[176:179]
buffer_load_dword a192, v11, s[8:11], s2 offen
v_mfma_f32_16x16x32_bf16 a[180:183], v[72:75], v[188:191], a[180:183]
v_mfma_f32_16x16x32_bf16 a[188:191], v[72:75], v[192:195], a[188:191]
v_mfma_f32_16x16x32_bf16 a[184:187], v[68:71], v[192:195], a[184:187]
L_pad1:
s_cbranch_execz L_pad5
v_mfma_f32_16x16x32_bf16 a[0:3], v[28:31], v[132:135], a[0:3]
s_waitcnt vmcnt(15)
v_mfma_f32_16x16x32_bf16 a[4:7], v[32:35], v[132:135], a[4:7]
s_barrier
ds_read_b64_tr_b16 v[36:37], v3 offset:8192
v_mfma_f32_16x16x32_bf16 a[12:15], v[32:35], v[116:119], a[12:15]
ds_read_b64_tr_b16 v[38:39], v3 offset:8704
v_mov_b32_dpp v212, v132 row_shl:1 row_mask:0xf bank_mask:0xf bound_ctrl:0
v_mfma_f32_16x16x32_bf16 a[8:11], v[28:31], v[116:119], a[8:11]
ds_read_b64_tr_b16 v[40:41], v4 offset:8192
v_mov_b32_dpp v213, v133 row_shl:1 row_mask:0xf bank_mask:0xf bound_ctrl:0
v_mfma_f32_16x16x32_bf16 a[16:19], v[28:31], v[104:107], a[16:19]
ds_read_b64_tr_b16 v[42:43], v4 offset:8704
v_mov_b32_dpp v214, v134 row_shl:1 row_mask:0xf bank_mask:0xf bound_ctrl:0
v_mfma_f32_16x16x32_bf16 a[20:23], v[32:35], v[104:107], a[20:23]
ds_read_b64_tr_b16 v[52:53], v3 offset:12288
v_mov_b32_dpp v215, v135 row_shl:1 row_mask:0xf bank_mask:0xf bound_ctrl:0
v_mfma_f32_16x16x32_bf16 a[28:31], v[32:35], v[88:91], a[28:31]
ds_read_b64_tr_b16 v[54:55], v3 offset:12800
v_mfma_f32_16x16x32_bf16 a[24:27], v[28:31], v[88:91], a[24:27]
ds_read_b64_tr_b16 v[56:57], v4 offset:12288
v_mfma_f32_16x16x32_bf16 a[32:35], v[28:31], v[152:155], a[32:35]
ds_read_b64_tr_b16 v[58:59], v4 offset:12800
v_mfma_f32_16x16x32_bf16 a[36:39], v[32:35], v[152:155], a[36:39]
v_mfma_f32_16x16x32_bf16 a[44:47], v[32:35], v[228:231], a[44:47]
s_add_u32 s36, s35, 524288
v_mfma_f32_16x16x32_bf16 a[40:43], v[28:31], v[228:231], a[40:43]
s_add_u32 m0, s30, 0
v_mfma_f32_16x16x32_bf16 a[48:51], v[28:31], v[232:235], a[48:51]
buffer_load_dwordx4 v7, s[8:11], s36 offen offset:0 lds
v_mfma_f32_16x16x32_bf16 a[52:55], v[32:35], v[232:235], a[52:55]
v_mfma_f32_16x16x32_bf16 a[60:63], v[32:35], v[76:79], a[60:63]
s_waitcnt lgkmcnt(2)
v_lshlrev_b64 v[16:17], 16, v[36:37]
v_lshlrev_b64 v[18:19], 16, v[52:53]
v_mfma_f32_16x16x32_bf16 a[56:59], v[28:31], v[76:79], a[56:59]
v_add_f32 v20, v36, v52
v_add_f32 v21, v37, v53
v_mfma_f32_16x16x32_bf16 a[64:67], v[44:47], v[128:131], a[64:67]
v_add_f32 v16, v16, v18
v_add_f32 v17, v17, v19
v_mfma_f32_16x16x32_bf16 a[68:71], v[48:51], v[128:131], a[68:71]
v_perm_b32 v68, v20, v16, s20
v_perm_b32 v69, v21, v17, s20
v_mfma_f32_16x16x32_bf16 a[76:79], v[48:51], v[120:123], a[76:79]
buffer_load_dwordx4 v8, s[8:11], s36 offen offset:1024 lds
v_mfma_f32_16x16x32_bf16 a[72:75], v[44:47], v[120:123], a[72:75]
v_mov_b32_dpp v200, v128 row_shl:1 row_mask:0xf bank_mask:0xf bound_ctrl:0
v_mov_b32_dpp v201, v129 row_shl:1 row_mask:0xf bank_mask:0xf bound_ctrl:0
v_mfma_f32_16x16x32_bf16 a[80:83], v[44:47], v[92:95], a[80:83]
v_mov_b32_dpp v202, v130 row_shl:1 row_mask:0xf bank_mask:0xf bound_ctrl:0
v_mov_b32_dpp v203, v131 row_shl:1 row_mask:0xf bank_mask:0xf bound_ctrl:0
v_mfma_f32_16x16x32_bf16 a[84:87], v[48:51], v[92:95], a[84:87]
v_lshlrev_b64 v[22:23], 16, v[38:39]
v_lshlrev_b64 v[24:25], 16, v[54:55]
v_mfma_f32_16x16x32_bf16 a[92:95], v[48:51], v[100:103], a[92:95]
s_add_u32 s36, s36, s33
v_add_f32 v26, v38, v54
v_add_f32 v27, v39, v55
v_mfma_f32_16x16x32_bf16 a[88:91], v[44:47], v[100:103], a[88:91]
s_add_u32 m0, s30, 4096
v_add_f32 v22, v22, v24
v_add_f32 v23, v23, v25
v_mfma_f32_16x16x32_bf16 a[96:99], v[44:47], v[172:175], a[96:99]
buffer_load_dwordx4 v7, s[8:11], s36 offen offset:0 lds
v_mfma_f32_16x16x32_bf16 a[100:103], v[48:51], v[172:175], a[100:103]
v_cvt_pk_bf16_f32 v70, v22, v26
v_perm_b32 v71, v27, v23, s20
v_mfma_f32_16x16x32_bf16 a[108:111], v[48:51], v[84:87], a[108:111]
s_waitcnt lgkmcnt(0)
v_lshlrev_b64 v[16:17], 16, v[40:41]
v_lshlrev_b64 v[18:19], 16, v[56:57]
v_mfma_f32_16x16x32_bf16 a[104:107], v[44:47], v[84:87], a[104:107]
v_add_f32 v20, v40, v56
v_add_f32 v21, v41, v57
v_mfma_f32_16x16x32_bf16 a[112:115], v[44:47], v[156:159], a[112:115]
v_add_f32 v16, v16, v18
v_add_f32 v17, v17, v19
v_mfma_f32_16x16x32_bf16 a[116:119], v[48:51], v[156:159], a[116:119]
v_perm_b32 v72, v20, v16, s20
v_perm_b32 v73, v21, v17, s20
v_mfma_f32_16x16x32_bf16 a[124:127], v[48:51], v[196:199], a[124:127]
buffer_load_dwordx4 v8, s[8:11], s36 offen offset:1024 lds
v_mfma_f32_16x16x32_bf16 a[120:123], v[44:47], v[196:199], a[120:123]
v_lshlrev_b64 v[22:23], 16, v[42:43]
v_lshlrev_b64 v[24:25], 16, v[58:59]
v_mfma_f32_16x16x32_bf16 a[128:131], v[60:63], v[124:127], a[128:131]
v_add_f32 v26, v42, v58
v_add_f32 v27, v43, v59
v_mfma_f32_16x16x32_bf16 a[132:135], v[64:67], v[124:127], a[132:135]
v_add_f32 v22, v22, v24
v_add_f32 v23, v23, v25
v_mfma_f32_16x16x32_bf16 a[140:143], v[64:67], v[112:115], a[140:143]
v_cvt_pk_bf16_f32 v74, v22, v26
v_perm_b32 v75, v27, v23, s20
v_mfma_f32_16x16x32_bf16 a[136:139], v[60:63], v[112:115], a[136:139]
v_mov_b32_dpp v128, v124 row_shl:1 row_mask:0xf bank_mask:0xf bound_ctrl:0
v_mov_b32_dpp v129, v125 row_shl:1 row_mask:0xf bank_mask:0xf bound_ctrl:0
v_mfma_f32_16x16x32_bf16 a[144:147], v[60:63], v[224:227], a[144:147]
v_mov_b32_dpp v130, v126 row_shl:1 row_mask:0xf bank_mask:0xf bound_ctrl:0
v_mov_b32_dpp v131, v127 row_shl:1 row_mask:0xf bank_mask:0xf bound_ctrl:0
v_mfma_f32_16x16x32_bf16 a[148:151], v[64:67], v[224:227], a[148:151]
v_mfma_f32_16x16x32_bf16 a[156:159], v[64:67], v[96:99], a[156:159]
v_mfma_f32_16x16x32_bf16 a[152:155], v[60:63], v[96:99], a[152:155]
v_mfma_f32_16x16x32_bf16 a[160:163], v[60:63], v[176:179], a[160:163]
v_mfma_f32_16x16x32_bf16 a[164:167], v[64:67], v[176:179], a[164:167]
v_mfma_f32_16x16x32_bf16 a[172:175], v[64:67], v[188:191], a[172:175]
v_mfma_f32_16x16x32_bf16 a[168:171], v[60:63], v[188:191], a[168:171]
v_mfma_f32_16x16x32_bf16 a[176:179], v[60:63], v[192:195], a[176:179]
v_mfma_f32_16x16x32_bf16 a[180:183], v[64:67], v[192:195], a[180:183]
v_mfma_f32_16x16x32_bf16 a[188:191], v[64:67], v[108:111], a[188:191]
v_mfma_f32_16x16x32_bf16 a[184:187], v[60:63], v[108:111], a[184:187]
s_add_u32 s23, s3, s34
v_mfma_f32_16x16x32_bf16 a[0:3], v[36:39], v[116:119], a[0:3]
s_waitcnt vmcnt(5)
v_mfma_f32_16x16x32_bf16 a[4:7], v[40:43], v[116:119], a[4:7]
s_barrier
ds_read_b64_tr_b16 v[28:29], v3 offset:16384
v_mfma_f32_16x16x32_bf16 a[12:15], v[40:43], v[104:107], a[12:15]
ds_read_b64_tr_b16 v[30:31], v3 offset:16896
v_mov_b32_dpp v216, v116 row_shl:1 row_mask:0xf bank_mask:0xf bound_ctrl:0
v_mfma_f32_16x16x32_bf16 a[8:11], v[36:39], v[104:107], a[8:11]
ds_read_b64_tr_b16 v[32:33], v4 offset:16384
v_mov_b32_dpp v217, v117 row_shl:1 row_mask:0xf bank_mask:0xf bound_ctrl:0
v_mfma_f32_16x16x32_bf16 a[16:19], v[36:39], v[88:91], a[16:19]
ds_read_b64_tr_b16 v[34:35], v4 offset:16896
v_mov_b32_dpp v218, v118 row_shl:1 row_mask:0xf bank_mask:0xf bound_ctrl:0
v_mfma_f32_16x16x32_bf16 a[20:23], v[40:43], v[88:91], a[20:23]
ds_read_b64_tr_b16 v[44:45], v3 offset:20480
v_mov_b32_dpp v219, v119 row_shl:1 row_mask:0xf bank_mask:0xf bound_ctrl:0
v_mfma_f32_16x16x32_bf16 a[28:31], v[40:43], v[152:155], a[28:31]
ds_read_b64_tr_b16 v[46:47], v3 offset:20992
v_mfma_f32_16x16x32_bf16 a[24:27], v[36:39], v[152:155], a[24:27]
ds_read_b64_tr_b16 v[48:49], v4 offset:20480
v_mfma_f32_16x16x32_bf16 a[32:35], v[36:39], v[228:231], a[32:35]
ds_read_b64_tr_b16 v[50:51], v4 offset:20992
v_mfma_f32_16x16x32_bf16 a[36:39], v[40:43], v[228:231], a[36:39]
v_mfma_f32_16x16x32_bf16 a[44:47], v[40:43], v[232:235], a[44:47]
s_add_u32 s36, s36, s33
ds_read_b128 a[204:207], v1 offset:36864
v_mfma_f32_16x16x32_bf16 a[40:43], v[36:39], v[232:235], a[40:43]
s_add_u32 m0, s30, 8192
ds_read_b128 v[180:183], v1 offset:37120
v_mfma_f32_16x16x32_bf16 a[48:51], v[36:39], v[76:79], a[48:51]
buffer_load_dwordx4 v7, s[8:11], s36 offen offset:0 lds
v_mfma_f32_16x16x32_bf16 a[52:55], v[40:43], v[76:79], a[52:55]
ds_read_b128 v[164:167], v1 offset:37376
v_mfma_f32_16x16x32_bf16 a[60:63], v[40:43], v[212:215], a[60:63]
s_waitcnt lgkmcnt(5)
v_lshlrev_b64 v[16:17], 16, v[28:29]
v_lshlrev_b64 v[18:19], 16, v[44:45]
v_mfma_f32_16x16x32_bf16 a[56:59], v[36:39], v[212:215], a[56:59]
v_add_f32 v20, v28, v44
v_add_f32 v21, v29, v45
v_mfma_f32_16x16x32_bf16 a[64:67], v[52:55], v[120:123], a[64:67]
v_add_f32 v16, v16, v18
v_add_f32 v17, v17, v19
v_mfma_f32_16x16x32_bf16 a[68:71], v[56:59], v[120:123], a[68:71]
v_perm_b32 v60, v20, v16, s20
v_perm_b32 v61, v21, v17, s20
v_mfma_f32_16x16x32_bf16 a[76:79], v[56:59], v[92:95], a[76:79]
buffer_load_dwordx4 v8, s[8:11], s36 offen offset:1024 lds
v_mfma_f32_16x16x32_bf16 a[72:75], v[52:55], v[92:95], a[72:75]
v_mov_b32_dpp v204, v120 row_shl:1 row_mask:0xf bank_mask:0xf bound_ctrl:0
v_mov_b32_dpp v205, v121 row_shl:1 row_mask:0xf bank_mask:0xf bound_ctrl:0
v_mfma_f32_16x16x32_bf16 a[80:83], v[52:55], v[100:103], a[80:83]
ds_read_b128 v[140:143], v1 offset:37632
v_mov_b32_dpp v206, v122 row_shl:1 row_mask:0xf bank_mask:0xf bound_ctrl:0
v_mfma_f32_16x16x32_bf16 a[84:87], v[56:59], v[100:103], a[84:87]
ds_read_b128 v[116:119], v1 offset:37888
v_mov_b32_dpp v207, v123 row_shl:1 row_mask:0xf bank_mask:0xf bound_ctrl:0
v_mfma_f32_16x16x32_bf16 a[92:95], v[56:59], v[172:175], a[92:95]
s_add_u32 s36, s36, s33
v_lshlrev_b64 v[22:23], 16, v[30:31]
v_lshlrev_b64 v[24:25], 16, v[46:47]
v_mfma_f32_16x16x32_bf16 a[88:91], v[52:55], v[172:175], a[88:91]
s_add_u32 m0, s30, 12288
v_add_f32 v26, v30, v46
v_add_f32 v27, v31, v47
v_mfma_f32_16x16x32_bf16 a[96:99], v[52:55], v[84:87], a[96:99]
buffer_load_dwordx4 v7, s[8:11], s36 offen offset:0 lds
v_mfma_f32_16x16x32_bf16 a[100:103], v[56:59], v[84:87], a[100:103]
v_add_f32 v22, v22, v24
v_add_f32 v23, v23, v25
v_mfma_f32_16x16x32_bf16 a[108:111], v[56:59], v[156:159], a[108:111]
v_cvt_pk_bf16_f32 v62, v22, v26
v_perm_b32 v63, v27, v23, s20
v_mfma_f32_16x16x32_bf16 a[104:107], v[52:55], v[156:159], a[104:107]
s_waitcnt lgkmcnt(5)
v_lshlrev_b64 v[16:17], 16, v[32:33]
v_lshlrev_b64 v[18:19], 16, v[48:49]
v_mfma_f32_16x16x32_bf16 a[112:115], v[52:55], v[196:199], a[112:115]
v_add_f32 v20, v32, v48
v_add_f32 v21, v33, v49
v_mfma_f32_16x16x32_bf16 a[116:119], v[56:59], v[196:199], a[116:119]
v_add_f32 v16, v16, v18
v_add_f32 v17, v17, v19
v_mfma_f32_16x16x32_bf16 a[124:127], v[56:59], v[200:203], a[124:127]
buffer_load_dwordx4 v8, s[8:11], s36 offen offset:1024 lds
v_mfma_f32_16x16x32_bf16 a[120:123], v[52:55], v[200:203], a[120:123]
v_perm_b32 v64, v20, v16, s20
v_perm_b32 v65, v21, v17, s20
v_mfma_f32_16x16x32_bf16 a[128:131], v[68:71], v[112:115], a[128:131]
ds_read_b128 v[132:135], v1 offset:38144
v_lshlrev_b64 v[22:23], 16, v[34:35]
v_mfma_f32_16x16x32_bf16 a[132:135], v[72:75], v[112:115], a[132:135]
ds_read_b128 v[120:123], v1 offset:38400
v_lshlrev_b64 v[24:25], 16, v[50:51]
v_mfma_f32_16x16x32_bf16 a[140:143], v[72:75], v[224:227], a[140:143]
v_add_f32 v26, v34, v50
v_add_f32 v27, v35, v51
v_mfma_f32_16x16x32_bf16 a[136:139], v[68:71], v[224:227], a[136:139]
v_add_f32 v22, v22, v24
v_add_f32 v23, v23, v25
v_mfma_f32_16x16x32_bf16 a[144:147], v[68:71], v[96:99], a[144:147]
v_cvt_pk_bf16_f32 v66, v22, v26
v_perm_b32 v67, v27, v23, s20
v_mfma_f32_16x16x32_bf16 a[148:151], v[72:75], v[96:99], a[148:151]
v_mov_b32_dpp v136, v112 row_shl:1 row_mask:0xf bank_mask:0xf bound_ctrl:0
v_mov_b32_dpp v137, v113 row_shl:1 row_mask:0xf bank_mask:0xf bound_ctrl:0
v_mfma_f32_16x16x32_bf16 a[156:159], v[72:75], v[176:179], a[156:159]
v_mov_b32_dpp v138, v114 row_shl:1 row_mask:0xf bank_mask:0xf bound_ctrl:0
v_mov_b32_dpp v139, v115 row_shl:1 row_mask:0xf bank_mask:0xf bound_ctrl:0
v_mfma_f32_16x16x32_bf16 a[152:155], v[68:71], v[176:179], a[152:155]
s_waitcnt lgkmcnt(4)
v_lshlrev_b64 v[16:17], 16, v[180:181]
v_lshlrev_b64 v[18:19], 16, v[164:165]
v_mfma_f32_16x16x32_bf16 a[160:163], v[68:71], v[188:191], a[160:163]
v_add_f32 v20, v180, v164
v_add_f32 v21, v181, v165
v_mfma_f32_16x16x32_bf16 a[164:167], v[72:75], v[188:191], a[164:167]
v_add_f32 v16, v16, v18
v_add_f32 v17, v17, v19
v_mfma_f32_16x16x32_bf16 a[172:175], v[72:75], v[192:195], a[172:175]
v_perm_b32 v184, v20, v16, s20
v_perm_b32 v185, v21, v17, s20
v_mfma_f32_16x16x32_bf16 a[168:171], v[68:71], v[192:195], a[168:171]
v_lshlrev_b64 v[22:23], 16, v[182:183]
v_lshlrev_b64 v[24:25], 16, v[166:167]
v_mfma_f32_16x16x32_bf16 a[176:179], v[68:71], v[108:111], a[176:179]
v_add_f32 v26, v182, v166
v_add_f32 v27, v183, v167
v_mfma_f32_16x16x32_bf16 a[180:183], v[72:75], v[108:111], a[180:183]
v_add_f32 v22, v22, v24
v_add_f32 v23, v23, v25
v_mfma_f32_16x16x32_bf16 a[188:191], v[72:75], v[128:131], a[188:191]
v_cvt_pk_bf16_f32 v186, v22, v26
v_perm_b32 v187, v27, v23, s20
v_mfma_f32_16x16x32_bf16 a[184:187], v[68:71], v[128:131], a[184:187]
s_waitcnt lgkmcnt(2)
v_lshlrev_b64 v[16:17], 16, v[140:141]
v_lshlrev_b64 v[18:19], 16, v[116:117]
v_mfma_f32_16x16x32_bf16 a[0:3], v[28:31], v[104:107], a[0:3]
v_add_f32 v20, v140, v116
v_add_f32 v21, v141, v117
v_mfma_f32_16x16x32_bf16 a[4:7], v[32:35], v[104:107], a[4:7]
s_barrier
ds_read_b64_tr_b16 v[36:37], v3 offset:24576
v_mfma_f32_16x16x32_bf16 a[12:15], v[32:35], v[88:91], a[12:15]
ds_read_b64_tr_b16 v[38:39], v3 offset:25088
v_add_f32 v16, v16, v18
v_mfma_f32_16x16x32_bf16 a[8:11], v[28:31], v[88:91], a[8:11]
ds_read_b64_tr_b16 v[40:41], v4 offset:24576
v_add_f32 v17, v17, v19
v_mfma_f32_16x16x32_bf16 a[16:19], v[28:31], v[152:155], a[16:19]
ds_read_b64_tr_b16 v[42:43], v4 offset:25088
v_perm_b32 v160, v20, v16, s20
v_mfma_f32_16x16x32_bf16 a[20:23], v[32:35], v[152:155], a[20:23]
ds_read_b64_tr_b16 v[52:53], v3 offset:28672
v_perm_b32 v161, v21, v17, s20
v_mfma_f32_16x16x32_bf16 a[28:31], v[32:35], v[228:231], a[28:31]
ds_read_b64_tr_b16 v[54:55], v3 offset:29184
v_mov_b32_dpp v220, v104 row_shl:1 row_mask:0xf bank_mask:0xf bound_ctrl:0
v_mfma_f32_16x16x32_bf16 a[24:27], v[28:31], v[228:231], a[24:27]
ds_read_b64_tr_b16 v[56:57], v4 offset:28672
v_mov_b32_dpp v221, v105 row_shl:1 row_mask:0xf bank_mask:0xf bound_ctrl:0
v_mfma_f32_16x16x32_bf16 a[32:35], v[28:31], v[232:235], a[32:35]
ds_read_b64_tr_b16 v[58:59], v4 offset:29184
v_mov_b32_dpp v222, v106 row_shl:1 row_mask:0xf bank_mask:0xf bound_ctrl:0
v_mfma_f32_16x16x32_bf16 a[36:39], v[32:35], v[232:235], a[36:39]
global_load_dwordx2 a[194:195], v83, s[52:53]
v_mfma_f32_16x16x32_bf16 a[44:47], v[32:35], v[76:79], a[44:47]
s_add_u32 s36, s36, s33
ds_read_b128 v[144:147], v1 offset:38656
v_mov_b32_dpp v223, v107 row_shl:1 row_mask:0xf bank_mask:0xf bound_ctrl:0
v_mfma_f32_16x16x32_bf16 a[40:43], v[28:31], v[76:79], a[40:43]
s_add_u32 m0, s30, 16384
ds_read_b128 v[124:127], v1 offset:38912
v_lshlrev_b64 v[22:23], 16, v[142:143]
v_mfma_f32_16x16x32_bf16 a[48:51], v[28:31], v[212:215], a[48:51]
buffer_load_dwordx4 v7, s[8:11], s36 offen offset:0 lds
v_mfma_f32_16x16x32_bf16 a[52:55], v[32:35], v[212:215], a[52:55]
v_lshlrev_b64 v[24:25], 16, v[118:119]
v_add_f32 v26, v142, v118
v_mfma_f32_16x16x32_bf16 a[60:63], v[32:35], v[216:219], a[60:63]
v_add_f32 v27, v143, v119
v_add_f32 v22, v22, v24
v_mfma_f32_16x16x32_bf16 a[56:59], v[28:31], v[216:219], a[56:59]
v_add_f32 v23, v23, v25
v_cvt_pk_bf16_f32 v162, v22, v26
v_mfma_f32_16x16x32_bf16 a[64:67], v[44:47], v[92:95], a[64:67]
global_load_dwordx2 a[196:197], v83, s[54:55]
v_mfma_f32_16x16x32_bf16 a[68:71], v[48:51], v[92:95], a[68:71]
v_perm_b32 v163, v27, v23, s20
v_mov_b32_dpp v208, v92 row_shl:1 row_mask:0xf bank_mask:0xf bound_ctrl:0
v_mfma_f32_16x16x32_bf16 a[76:79], v[48:51], v[100:103], a[76:79]
buffer_load_dwordx4 v8, s[8:11], s36 offen offset:1024 lds
v_mfma_f32_16x16x32_bf16 a[72:75], v[44:47], v[100:103], a[72:75]
v_mov_b32_dpp v209, v93 row_shl:1 row_mask:0xf bank_mask:0xf bound_ctrl:0
v_mov_b32_dpp v210, v94 row_shl:1 row_mask:0xf bank_mask:0xf bound_ctrl:0
v_mfma_f32_16x16x32_bf16 a[80:83], v[44:47], v[172:175], a[80:83]
ds_read_b128 v[112:115], v1 offset:39168
v_mov_b32_dpp v211, v95 row_shl:1 row_mask:0xf bank_mask:0xf bound_ctrl:0
v_mfma_f32_16x16x32_bf16 a[84:87], v[48:51], v[172:175], a[84:87]
s_waitcnt lgkmcnt(5)
ds_read_b128 v[104:107], v1 offset:39424
v_lshlrev_b64 v[16:17], 16, v[36:37]
v_mfma_f32_16x16x32_bf16 a[92:95], v[48:51], v[84:87], a[92:95]
s_add_u32 s36, s36, s33
global_load_dwordx2 a[198:199], v83, s[56:57]
v_mfma_f32_16x16x32_bf16 a[88:91], v[44:47], v[84:87], a[88:91]
s_add_u32 m0, s30, 20480
v_lshlrev_b64 v[18:19], 16, v[52:53]
v_add_f32 v20, v36, v52
v_mfma_f32_16x16x32_bf16 a[96:99], v[44:47], v[156:159], a[96:99]
buffer_load_dwordx4 v7, s[8:11], s36 offen offset:0 lds
v_mfma_f32_16x16x32_bf16 a[100:103], v[48:51], v[156:159], a[100:103]
v_add_f32 v21, v37, v53
v_add_f32 v16, v16, v18
v_mfma_f32_16x16x32_bf16 a[108:111], v[48:51], v[196:199], a[108:111]
v_add_f32 v17, v17, v19
v_perm_b32 v68, v20, v16, s20
v_mfma_f32_16x16x32_bf16 a[104:107], v[44:47], v[196:199], a[104:107]
v_perm_b32 v69, v21, v17, s20
v_lshlrev_b64 v[22:23], 16, v[38:39]
v_mfma_f32_16x16x32_bf16 a[112:115], v[44:47], v[200:203], a[112:115]
buffer_store_dwordx4 a[200:203], v80, s[12:15], 0 offen sc1
v_mfma_f32_16x16x32_bf16 a[116:119], v[48:51], v[200:203], a[116:119]
v_lshlrev_b64 v[24:25], 16, v[54:55]
v_add_f32 v26, v38, v54
v_mfma_f32_16x16x32_bf16 a[124:127], v[48:51], v[204:207], a[124:127]
buffer_load_dwordx4 v8, s[8:11], s36 offen offset:1024 lds
v_mfma_f32_16x16x32_bf16 a[120:123], v[44:47], v[204:207], a[120:123]
v_add_f32 v27, v39, v55
v_add_f32 v22, v22, v24
v_mfma_f32_16x16x32_bf16 a[128:131], v[60:63], v[224:227], a[128:131]
ds_read_b128 v[92:95], v1 offset:39680
v_add_f32 v23, v23, v25
v_mfma_f32_16x16x32_bf16 a[132:135], v[64:67], v[224:227], a[132:135]
ds_read_b128 v[80:83], v1 offset:39936
v_cvt_pk_bf16_f32 v70, v22, v26
v_mfma_f32_16x16x32_bf16 a[140:143], v[64:67], v[96:99], a[140:143]
s_waitcnt lgkmcnt(6)
v_perm_b32 v71, v27, v23, s20
v_lshlrev_b64 v[16:17], 16, v[40:41]
v_mfma_f32_16x16x32_bf16 a[136:139], v[60:63], v[96:99], a[136:139]
s_lshl_b32 s0, s24, 13
v_lshlrev_b64 v[18:19], 16, v[56:57]
v_add_f32 v20, v40, v56
v_mfma_f32_16x16x32_bf16 a[144:147], v[60:63], v[176:179], a[144:147]
v_add_f32 v21, v41, v57
v_add_f32 v16, v16, v18
v_mfma_f32_16x16x32_bf16 a[148:151], v[64:67], v[176:179], a[148:151]
v_add_f32 v17, v17, v19
v_perm_b32 v72, v20, v16, s20
v_mfma_f32_16x16x32_bf16 a[156:159], v[64:67], v[188:191], a[156:159]
v_perm_b32 v73, v21, v17, s20
v_lshlrev_b64 v[22:23], 16, v[42:43]
v_mfma_f32_16x16x32_bf16 a[152:155], v[60:63], v[188:191], a[152:155]
s_add_u32 s0, s0, 4096
v_lshlrev_b64 v[24:25], 16, v[58:59]
v_add_f32 v26, v42, v58
v_mfma_f32_16x16x32_bf16 a[160:163], v[60:63], v[192:195], a[160:163]
buffer_load_dword a193, off, s[96:99], s0 offset:3840 sc1
v_mfma_f32_16x16x32_bf16 a[164:167], v[64:67], v[192:195], a[164:167]
v_add_f32 v27, v43, v59
v_add_f32 v22, v22, v24
v_mfma_f32_16x16x32_bf16 a[172:175], v[64:67], v[108:111], a[172:175]
v_add_f32 v23, v23, v25
v_cvt_pk_bf16_f32 v74, v22, v26
v_mfma_f32_16x16x32_bf16 a[168:171], v[60:63], v[108:111], a[168:171]
v_perm_b32 v75, v27, v23, s20
v_mov_b32_dpp v168, v224 row_shl:1 row_mask:0xf bank_mask:0xf bound_ctrl:0
v_mfma_f32_16x16x32_bf16 a[176:179], v[60:63], v[128:131], a[176:179]
v_mov_b32_dpp v169, v225 row_shl:1 row_mask:0xf bank_mask:0xf bound_ctrl:0
v_mov_b32_dpp v170, v226 row_shl:1 row_mask:0xf bank_mask:0xf bound_ctrl:0
v_mfma_f32_16x16x32_bf16 a[180:183], v[64:67], v[128:131], a[180:183]
v_mov_b32_dpp v171, v227 row_shl:1 row_mask:0xf bank_mask:0xf bound_ctrl:0
v_lshlrev_b64 v[16:17], 16, v[132:133]
v_mfma_f32_16x16x32_bf16 a[188:191], v[64:67], v[136:139], a[188:191]
v_lshlrev_b64 v[18:19], 16, v[120:121]
v_add_f32 v20, v132, v120
v_mfma_f32_16x16x32_bf16 a[184:187], v[60:63], v[136:139], a[184:187]
v_add_f32 v21, v133, v121
v_add_f32 v16, v16, v18
v_mfma_f32_16x16x32_bf16 a[0:3], v[36:39], v[88:91], a[0:3]
s_waitcnt vmcnt(13)
v_add_f32 v17, v17, v19
v_perm_b32 v148, v20, v16, s20
v_mfma_f32_16x16x32_bf16 a[4:7], v[40:43], v[88:91], a[4:7]
s_barrier
ds_read_b64_tr_b16 v[28:29], v3 offset:0
v_mfma_f32_16x16x32_bf16 a[12:15], v[40:43], v[152:155], a[12:15]
ds_read_b64_tr_b16 v[30:31], v3 offset:512
v_perm_b32 v149, v21, v17, s20
v_mfma_f32_16x16x32_bf16 a[8:11], v[36:39], v[152:155], a[8:11]
ds_read_b64_tr_b16 v[32:33], v4 offset:0
v_lshlrev_b64 v[22:23], 16, v[134:135]
v_mfma_f32_16x16x32_bf16 a[16:19], v[36:39], v[228:231], a[16:19]
ds_read_b64_tr_b16 v[34:35], v4 offset:512
v_lshlrev_b64 v[24:25], 16, v[122:123]
v_mfma_f32_16x16x32_bf16 a[20:23], v[40:43], v[228:231], a[20:23]
ds_read_b64_tr_b16 v[44:45], v3 offset:4096
v_add_f32 v26, v134, v122
v_mfma_f32_16x16x32_bf16 a[28:31], v[40:43], v[232:235], a[28:31]
ds_read_b64_tr_b16 v[46:47], v3 offset:4608
v_add_f32 v27, v135, v123
v_mfma_f32_16x16x32_bf16 a[24:27], v[36:39], v[232:235], a[24:27]
ds_read_b64_tr_b16 v[48:49], v4 offset:4096
v_add_f32 v22, v22, v24
v_mfma_f32_16x16x32_bf16 a[32:35], v[36:39], v[76:79], a[32:35]
ds_read_b64_tr_b16 v[50:51], v4 offset:4608
v_add_f32 v23, v23, v25
v_mfma_f32_16x16x32_bf16 a[36:39], v[40:43], v[76:79], a[36:39]
s_add_u32 s36, s36, s33
ds_read_b128 v[88:91], v1 offset:40192
v_cvt_pk_bf16_f32 v150, v22, v26
v_mfma_f32_16x16x32_bf16 a[44:47], v[40:43], v[212:215], a[44:47]
s_add_u32 m0, s30, 24576
ds_read_b128 v[76:79], v1 offset:40448
v_perm_b32 v151, v27, v23, s20
v_mfma_f32_16x16x32_bf16 a[40:43], v[36:39], v[212:215], a[40:43]
s_waitcnt lgkmcnt(14)
v_lshlrev_b64 v[16:17], 16, v[144:145]
v_lshlrev_b64 v[18:19], 16, v[124:125]
v_mfma_f32_16x16x32_bf16 a[48:51], v[36:39], v[216:219], a[48:51]
buffer_load_dwordx4 v7, s[8:11], s36 offen offset:0 lds
v_mfma_f32_16x16x32_bf16 a[52:55], v[40:43], v[216:219], a[52:55]
v_add_f32 v20, v144, v124
v_add_f32 v21, v145, v125
v_mfma_f32_16x16x32_bf16 a[60:63], v[40:43], v[220:223], a[60:63]
v_add_f32 v16, v16, v18
v_add_f32 v17, v17, v19
v_mfma_f32_16x16x32_bf16 a[56:59], v[36:39], v[220:223], a[56:59]
v_perm_b32 v152, v20, v16, s20
v_perm_b32 v153, v21, v17, s20
v_mfma_f32_16x16x32_bf16 a[64:67], v[52:55], v[100:103], a[64:67]
v_lshlrev_b64 v[22:23], 16, v[146:147]
v_lshlrev_b64 v[24:25], 16, v[126:127]
v_mfma_f32_16x16x32_bf16 a[68:71], v[56:59], v[100:103], a[68:71]
v_add_f32 v26, v146, v126
v_add_f32 v27, v147, v127
v_mfma_f32_16x16x32_bf16 a[76:79], v[56:59], v[172:175], a[76:79]
buffer_load_dwordx4 v8, s[8:11], s36 offen offset:1024 lds
v_mfma_f32_16x16x32_bf16 a[72:75], v[52:55], v[172:175], a[72:75]
v_add_f32 v22, v22, v24
v_add_f32 v23, v23, v25
v_mfma_f32_16x16x32_bf16 a[80:83], v[52:55], v[84:87], a[80:83]
ds_read_b128 v[100:103], v1 offset:40704
v_cvt_pk_bf16_f32 v154, v22, v26
v_mfma_f32_16x16x32_bf16 a[84:87], v[56:59], v[84:87], a[84:87]
s_waitcnt lgkmcnt(13)
v_perm_b32 v155, v27, v23, s20
v_lshlrev_b64 v[16:17], 16, v[112:113]
v_mfma_f32_16x16x32_bf16 a[92:95], v[56:59], v[156:159], a[92:95]
s_add_u32 s36, s36, s33
ds_read_b128 v[84:87], v2 offset:36864
v_lshlrev_b64 v[18:19], 16, v[104:105]
v_mfma_f32_16x16x32_bf16 a[88:91], v[52:55], v[156:159], a[88:91]
s_add_u32 m0, s30, 28672
v_add_f32 v20, v112, v104
v_add_f32 v21, v113, v105
v_mfma_f32_16x16x32_bf16 a[96:99], v[52:55], v[196:199], a[96:99]
buffer_load_dwordx4 v7, s[8:11], s36 offen offset:0 lds
v_mfma_f32_16x16x32_bf16 a[100:103], v[56:59], v[196:199], a[100:103]
v_add_f32 v16, v16, v18
v_add_f32 v17, v17, v19
v_mfma_f32_16x16x32_bf16 a[108:111], v[56:59], v[200:203], a[108:111]
v_perm_b32 v172, v20, v16, s20
v_perm_b32 v173, v21, v17, s20
v_mfma_f32_16x16x32_bf16 a[104:107], v[52:55], v[200:203], a[104:107]
v_lshlrev_b64 v[22:23], 16, v[114:115]
v_lshlrev_b64 v[24:25], 16, v[106:107]
v_mfma_f32_16x16x32_bf16 a[112:115], v[52:55], v[204:207], a[112:115]
v_add_f32 v26, v114, v106
v_add_f32 v27, v115, v107
v_mfma_f32_16x16x32_bf16 a[116:119], v[56:59], v[204:207], a[116:119]
v_add_f32 v22, v22, v24
v_add_f32 v23, v23, v25
v_mfma_f32_16x16x32_bf16 a[124:127], v[56:59], v[208:211], a[124:127]
buffer_load_dwordx4 v8, s[8:11], s36 offen offset:1024 lds
v_mfma_f32_16x16x32_bf16 a[120:123], v[52:55], v[208:211], a[120:123]
v_cvt_pk_bf16_f32 v174, v22, v26
v_perm_b32 v175, v27, v23, s20
v_mfma_f32_16x16x32_bf16 a[128:131], v[68:71], v[96:99], a[128:131]
s_waitcnt lgkmcnt(12)
v_lshlrev_b64 v[16:17], 16, v[92:93]
v_lshlrev_b64 v[18:19], 16, v[80:81]
v_mfma_f32_16x16x32_bf16 a[132:135], v[72:75], v[96:99], a[132:135]
v_add_f32 v20, v92, v80
v_add_f32 v21, v93, v81
v_mfma_f32_16x16x32_bf16 a[140:143], v[72:75], v[176:179], a[140:143]
s_add_u32 s101, s23, 0
v_add_f32 v16, v16, v18
v_add_f32 v17, v17, v19
v_mfma_f32_16x16x32_bf16 a[136:139], v[68:71], v[176:179], a[136:139]
s_add_u32 m0, s41, 0
v_perm_b32 v156, v20, v16, s20
v_perm_b32 v157, v21, v17, s20
v_mfma_f32_16x16x32_bf16 a[144:147], v[68:71], v[188:191], a[144:147]
buffer_load_dwordx4 v9, s[4:7], s101 offen lds
v_mfma_f32_16x16x32_bf16 a[148:151], v[72:75], v[188:191], a[148:151]
v_lshlrev_b64 v[22:23], 16, v[94:95]
v_lshlrev_b64 v[24:25], 16, v[82:83]
v_mfma_f32_16x16x32_bf16 a[156:159], v[72:75], v[192:195], a[156:159]
v_add_f32 v26, v94, v82
v_add_f32 v27, v95, v83
v_mfma_f32_16x16x32_bf16 a[152:155], v[68:71], v[192:195], a[152:155]
s_add_u32 s101, s23, 8192
v_add_f32 v22, v22, v24
v_add_f32 v23, v23, v25
v_mfma_f32_16x16x32_bf16 a[160:163], v[68:71], v[108:111], a[160:163]
s_add_u32 m0, s41, 1024
v_cvt_pk_bf16_f32 v158, v22, v26
v_perm_b32 v159, v27, v23, s20
v_mfma_f32_16x16x32_bf16 a[164:167], v[72:75], v[108:111], a[164:167]
s_waitcnt lgkmcnt(2)
v_lshlrev_b64 v[16:17], 16, v[88:89]
v_lshlrev_b64 v[18:19], 16, v[76:77]
v_mfma_f32_16x16x32_bf16 a[172:175], v[72:75], v[128:131], a[172:175]
buffer_load_dwordx4 v9, s[4:7], s101 offen lds
v_mfma_f32_16x16x32_bf16 a[168:171], v[68:71], v[128:131], a[168:171]
v_add_f32 v20, v88, v76
v_add_f32 v21, v89, v77
v_mfma_f32_16x16x32_bf16 a[176:179], v[68:71], v[136:139], a[176:179]
v_add_f32 v16, v16, v18
v_add_f32 v17, v17, v19
v_mfma_f32_16x16x32_bf16 a[180:183], v[72:75], v[136:139], a[180:183]
v_perm_b32 v96, v20, v16, s20
v_perm_b32 v97, v21, v17, s20
v_mfma_f32_16x16x32_bf16 a[188:191], v[72:75], v[168:171], a[188:191]
v_lshlrev_b64 v[22:23], 16, v[90:91]
v_lshlrev_b64 v[24:25], 16, v[78:79]
v_add_f32 v26, v90, v78
v_add_f32 v27, v91, v79
v_mfma_f32_16x16x32_bf16 a[184:187], v[68:71], v[168:171], a[184:187]
v_add_f32 v22, v22, v24
v_add_f32 v23, v23, v25
v_cvt_pk_bf16_f32 v98, v22, v26
v_perm_b32 v99, v27, v23, s20
L_u1:
v_mfma_f32_16x16x32_bf16 a[0:3], v[28:31], a[204:207], a[0:3]
s_waitcnt vmcnt(10)
v_lshlrev_b64 v[16:17], 16, v[28:29]
v_lshlrev_b64 v[18:19], 16, v[44:45]
v_mfma_f32_16x16x32_bf16 a[4:7], v[32:35], a[204:207], a[4:7]
s_barrier
ds_read_b64_tr_b16 v[36:37], v3 offset:8192
v_mfma_f32_16x16x32_bf16 a[12:15], v[32:35], v[164:167], a[12:15]
ds_read_b64_tr_b16 v[38:39], v3 offset:8704
v_add_f32 v20, v28, v44
v_mfma_f32_16x16x32_bf16 a[8:11], v[28:31], v[164:167], a[8:11]
ds_read_b64_tr_b16 v[40:41], v4 offset:8192
v_add_f32 v21, v29, v45
v_mfma_f32_16x16x32_bf16 a[16:19], v[28:31], v[116:119], a[16:19]
ds_read_b64_tr_b16 v[42:43], v4 offset:8704
v_add_f32 v16, v16, v18
v_mfma_f32_16x16x32_bf16 a[20:23], v[32:35], v[116:119], a[20:23]
ds_read_b64_tr_b16 v[52:53], v3 offset:12288
v_add_f32 v17, v17, v19
v_mfma_f32_16x16x32_bf16 a[28:31], v[32:35], v[120:123], a[28:31]
ds_read_b64_tr_b16 v[54:55], v3 offset:12800
v_perm_b32 v60, v20, v16, s20
v_mfma_f32_16x16x32_bf16 a[24:27], v[28:31], v[120:123], a[24:27]
ds_read_b64_tr_b16 v[56:57], v4 offset:12288
v_perm_b32 v61, v21, v17, s20
v_mfma_f32_16x16x32_bf16 a[32:35], v[28:31], v[124:127], a[32:35]
ds_read_b64_tr_b16 v[58:59], v4 offset:12800
v_lshlrev_b64 v[22:23], 16, v[30:31]
v_mfma_f32_16x16x32_bf16 a[36:39], v[32:35], v[124:127], a[36:39]
v_lshlrev_b64 v[24:25], 16, v[46:47]
v_add_f32 v26, v30, v46
v_mfma_f32_16x16x32_bf16 a[44:47], v[32:35], v[104:107], a[44:47]
s_add_u32 s36, s35, 8912896
ds_read_b128 v[192:195], v2 offset:37120
v_add_f32 v27, v31, v47
v_mfma_f32_16x16x32_bf16 a[40:43], v[28:31], v[104:107], a[40:43]
s_add_u32 m0, s30, 0
ds_read_b128 v[196:199], v2 offset:37376
v_add_f32 v22, v22, v24
v_mfma_f32_16x16x32_bf16 a[48:51], v[28:31], v[80:83], a[48:51]
L_pad2:
s_cbranch_execz L_pad6
buffer_load_dwordx4 v5, s[8:11], s36 offen offset:0 lds
v_mfma_f32_16x16x32_bf16 a[52:55], v[32:35], v[80:83], a[52:55]
v_add_f32 v23, v23, v25
v_cvt_pk_bf16_f32 v62, v22, v26
v_mfma_f32_16x16x32_bf16 a[60:63], v[32:35], v[76:79], a[60:63]
v_perm_b32 v63, v27, v23, s20
v_lshlrev_b64 v[16:17], 16, v[32:33]
v_mfma_f32_16x16x32_bf16 a[56:59], v[28:31], v[76:79], a[56:59]
v_lshlrev_b64 v[18:19], 16, v[48:49]
v_add_f32 v20, v32, v48
v_mfma_f32_16x16x32_bf16 a[64:67], v[44:47], v[180:183], a[64:67]
v_add_f32 v21, v33, v49
v_add_f32 v16, v16, v18
v_mfma_f32_16x16x32_bf16 a[68:71], v[48:51], v[180:183], a[68:71]
v_add_f32 v17, v17, v19
v_perm_b32 v64, v20, v16, s20
v_mfma_f32_16x16x32_bf16 a[76:79], v[48:51], v[140:143], a[76:79]
buffer_load_dwordx4 v6, s[8:11], s36 offen offset:1024 lds
v_mfma_f32_16x16x32_bf16 a[72:75], v[44:47], v[140:143], a[72:75]
v_perm_b32 v65, v21, v17, s20
v_lshlrev_b64 v[22:23], 16, v[34:35]
v_mfma_f32_16x16x32_bf16 a[80:83], v[44:47], v[132:135], a[80:83]
v_lshlrev_b64 v[24:25], 16, v[50:51]
v_add_f32 v26, v34, v50
v_mfma_f32_16x16x32_bf16 a[84:87], v[48:51], v[132:135], a[84:87]
s_add_u32 s36, s35, 9961472
v_add_f32 v27, v35, v51
v_add_f32 v22, v22, v24
v_mfma_f32_16x16x32_bf16 a[92:95], v[48:51], v[144:147], a[92:95]
s_add_u32 m0, s30, 4096
v_add_f32 v23, v23, v25
v_cvt_pk_bf16_f32 v66, v22, v26
v_mfma_f32_16x16x32_bf16 a[88:91], v[44:47], v[144:147], a[88:91]
s_waitcnt lgkmcnt(10)
v_perm_b32 v67, v27, v23, s20
v_lshlrev_b64 v[16:17], 16, v[100:101]
v_mfma_f32_16x16x32_bf16 a[96:99], v[44:47], v[112:115], a[96:99]
buffer_load_dwordx4 v5, s[8:11], s36 offen offset:0 lds
v_mfma_f32_16x16x32_bf16 a[100:103], v[48:51], v[112:115], a[100:103]
v_lshlrev_b64 v[18:19], 16, v[84:85]
v_add_f32 v20, v100, v84
v_mfma_f32_16x16x32_bf16 a[108:111], v[48:51], v[92:95], a[108:111]
v_add_f32 v21, v101, v85
v_add_f32 v16, v16, v18
v_mfma_f32_16x16x32_bf16 a[104:107], v[44:47], v[92:95], a[104:107]
v_add_f32 v17, v17, v19
v_perm_b32 v224, v20, v16, s20
v_mfma_f32_16x16x32_bf16 a[112:115], v[44:47], v[88:91], a[112:115]
v_perm_b32 v225, v21, v17, s20
v_lshlrev_b64 v[22:23], 16, v[102:103]
v_mfma_f32_16x16x32_bf16 a[116:119], v[48:51], v[88:91], a[116:119]
v_lshlrev_b64 v[24:25], 16, v[86:87]
v_add_f32 v26, v102, v86
v_mfma_f32_16x16x32_bf16 a[124:127], v[48:51], v[100:103], a[124:127]
buffer_load_dwordx4 v6, s[8:11], s36 offen offset:1024 lds
v_mfma_f32_16x16x32_bf16 a[120:123], v[44:47], v[100:103], a[120:123]
v_add_f32 v27, v103, v87
v_add_f32 v22, v22, v24
v_mfma_f32_16x16x32_bf16 a[128:131], v[60:63], v[184:187], a[128:131]
s_add_u32 s2, s35, s21
v_add_f32 v23, v23, v25
v_cvt_pk_bf16_f32 v226, v22, v26
v_mfma_f32_16x16x32_bf16 a[132:135], v[64:67], v[184:187], a[132:135]
s_waitcnt lgkmcnt(4)
v_perm_b32 v227, v27, v23, s20
v_lshlrev_b64 v[16:17], 16, v[36:37]
v_mfma_f32_16x16x32_bf16 a[140:143], v[64:67], v[160:163], a[140:143]
s_add_u32 s101, s3, 16512
buffer_load_dword a192, v11, s[8:11], s2 offen
v_mfma_f32_16x16x32_bf16 a[136:139], v[60:63], v[160:163], a[136:139]
s_add_u32 m0, s41, 2048
v_lshlrev_b64 v[18:19], 16, v[52:53]
v_add_f32 v20, v36, v52
v_mfma_f32_16x16x32_bf16 a[144:147], v[60:63], v[148:151], a[144:147]
buffer_load_dwordx4 v9, s[4:7], s101 offen lds
v_mfma_f32_16x16x32_bf16 a[148:151], v[64:67], v[148:151], a[148:151]
v_add_f32 v21, v37, v53
v_add_f32 v16, v16, v18
v_mfma_f32_16x16x32_bf16 a[156:159], v[64:67], v[152:155], a[156:159]
ds_read_b128 v[216:219], v2 offset:37632
v_add_f32 v17, v17, v19
v_mfma_f32_16x16x32_bf16 a[152:155], v[60:63], v[152:155], a[152:155]
ds_read_b128 v[208:211], v2 offset:37888
v_perm_b32 v68, v20, v16, s20
v_mfma_f32_16x16x32_bf16 a[160:163], v[60:63], v[172:175], a[160:163]
s_add_u32 s101, s3, 24704
v_perm_b32 v69, v21, v17, s20
v_lshlrev_b64 v[22:23], 16, v[38:39]
v_mfma_f32_16x16x32_bf16 a[164:167], v[64:67], v[172:175], a[164:167]
s_add_u32 m0, s41, 3072
v_lshlrev_b64 v[24:25], 16, v[54:55]
v_add_f32 v26, v38, v54
v_mfma_f32_16x16x32_bf16 a[172:175], v[64:67], v[156:159], a[172:175]
buffer_load_dwordx4 v9, s[4:7], s101 offen lds
v_mfma_f32_16x16x32_bf16 a[168:171], v[60:63], v[156:159], a[168:171]
v_add_f32 v27, v39, v55
v_add_f32 v22, v22, v24
v_mfma_f32_16x16x32_bf16 a[176:179], v[60:63], v[96:99], a[176:179]
v_add_f32 v23, v23, v25
v_cvt_pk_bf16_f32 v70, v22, v26
v_mfma_f32_16x16x32_bf16 a[180:183], v[64:67], v[96:99], a[180:183]
s_waitcnt lgkmcnt(4)
v_perm_b32 v71, v27, v23, s20
v_lshlrev_b64 v[16:17], 16, v[40:41]
v_mfma_f32_16x16x32_bf16 a[188:191], v[64:67], v[224:227], a[188:191]
v_lshlrev_b64 v[18:19], 16, v[56:57]
v_add_f32 v20, v40, v56
v_mfma_f32_16x16x32_bf16 a[184:187], v[60:63], v[224:227], a[184:187]
v_add_f32 v21, v41, v57
v_add_f32 v16, v16, v18
v_mfma_f32_16x16x32_bf16 a[0:3], v[36:39], v[164:167], a[0:3]
s_waitcnt vmcnt(13)
v_add_f32 v17, v17, v19
v_perm_b32 v72, v20, v16, s20
v_mfma_f32_16x16x32_bf16 a[4:7], v[40:43], v[164:167], a[4:7]
s_barrier
ds_read_b64_tr_b16 v[28:29], v3 offset:16384
v_mfma_f32_16x16x32_bf16 a[12:15], v[40:43], v[116:119], a[12:15]
ds_read_b64_tr_b16 v[30:31], v3 offset:16896
v_perm_b32 v73, v21, v17, s20
v_mfma_f32_16x16x32_bf16 a[8:11], v[36:39], v[116:119], a[8:11]
ds_read_b64_tr_b16 v[32:33], v4 offset:16384
v_lshlrev_b64 v[22:23], 16, v[42:43]
v_mfma_f32_16x16x32_bf16 a[16:19], v[36:39], v[120:123], a[16:19]
ds_read_b64_tr_b16 v[34:35], v4 offset:16896
v_lshlrev_b64 v[24:25], 16, v[58:59]
v_mfma_f32_16x16x32_bf16 a[20:23], v[40:43], v[120:123], a[20:23]
ds_read_b64_tr_b16 v[44:45], v3 offset:20480
v_add_f32 v26, v42, v58
v_mfma_f32_16x16x32_bf16 a[28:31], v[40:43], v[124:127], a[28:31]
ds_read_b64_tr_b16 v[46:47], v3 offset:20992
v_add_f32 v27, v43, v59
v_mfma_f32_16x16x32_bf16 a[24:27], v[36:39], v[124:127], a[24:27]
ds_read_b64_tr_b16 v[48:49], v4 offset:20480
v_add_f32 v22, v22, v24
v_mfma_f32_16x16x32_bf16 a[32:35], v[36:39], v[104:107], a[32:35]
ds_read_b64_tr_b16 v[50:51], v4 offset:20992
v_add_f32 v23, v23, v25
v_mfma_f32_16x16x32_bf16 a[36:39], v[40:43], v[104:107], a[36:39]
s_add_u32 s36, s35, 11010048
v_cvt_pk_bf16_f32 v74, v22, v26
v_perm_b32 v75, v27, v23, s20
v_mfma_f32_16x16x32_bf16 a[44:47], v[40:43], v[80:83], a[44:47]
s_waitcnt lgkmcnt(10)
ds_read_b128 v[220:223], v2 offset:38144
v_lshlrev_b64 v[16:17], 16, v[192:193]
v_mfma_f32_16x16x32_bf16 a[40:43], v[36:39], v[80:83], a[40:43]
s_add_u32 m0, s30, 8192
ds_read_b128 v[212:215], v2 offset:38400
v_lshlrev_b64 v[18:19], 16, v[196:197]
v_mfma_f32_16x16x32_bf16 a[48:51], v[36:39], v[76:79], a[48:51]
buffer_load_dwordx4 v5, s[8:11], s36 offen offset:0 lds
v_mfma_f32_16x16x32_bf16 a[52:55], v[40:43], v[76:79], a[52:55]
v_add_f32 v20, v192, v196
v_add_f32 v21, v193, v197
v_mfma_f32_16x16x32_bf16 a[60:63], v[40:43], v[84:87], a[60:63]
v_add_f32 v16, v16, v18
v_add_f32 v17, v17, v19
v_mfma_f32_16x16x32_bf16 a[56:59], v[36:39], v[84:87], a[56:59]
v_perm_b32 v200, v20, v16, s20
v_perm_b32 v201, v21, v17, s20
v_mfma_f32_16x16x32_bf16 a[64:67], v[52:55], v[140:143], a[64:67]
v_lshlrev_b64 v[22:23], 16, v[194:195]
v_lshlrev_b64 v[24:25], 16, v[198:199]
v_mfma_f32_16x16x32_bf16 a[68:71], v[56:59], v[140:143], a[68:71]
v_add_f32 v26, v194, v198
v_add_f32 v27, v195, v199
v_mfma_f32_16x16x32_bf16 a[76:79], v[56:59], v[132:135], a[76:79]
buffer_load_dwordx4 v6, s[8:11], s36 offen offset:1024 lds
v_mfma_f32_16x16x32_bf16 a[72:75], v[52:55], v[132:135], a[72:75]
v_add_f32 v22, v22, v24
v_add_f32 v23, v23, v25
v_mfma_f32_16x16x32_bf16 a[80:83], v[52:55], v[144:147], a[80:83]
v_cvt_pk_bf16_f32 v202, v22, v26
v_perm_b32 v203, v27, v23, s20
v_mfma_f32_16x16x32_bf16 a[84:87], v[56:59], v[144:147], a[84:87]
s_waitcnt lgkmcnt(4)
v_lshlrev_b64 v[16:17], 16, v[28:29]
v_lshlrev_b64 v[18:19], 16, v[44:45]
v_mfma_f32_16x16x32_bf16 a[92:95], v[56:59], v[112:115], a[92:95]
s_add_u32 s36, s35, 12058624
v_add_f32 v20, v28, v44
v_add_f32 v21, v29, v45
v_mfma_f32_16x16x32_bf16 a[88:91], v[52:55], v[112:115], a[88:91]
s_add_u32 m0, s30, 12288
v_add_f32 v16, v16, v18
v_add_f32 v17, v17, v19
v_mfma_f32_16x16x32_bf16 a[96:99], v[52:55], v[92:95], a[96:99]
buffer_load_dwordx4 v5, s[8:11], s36 offen offset:0 lds
v_mfma_f32_16x16x32_bf16 a[100:103], v[56:59], v[92:95], a[100:103]
v_perm_b32 v60, v20, v16, s20
v_perm_b32 v61, v21, v17, s20
v_mfma_f32_16x16x32_bf16 a[108:111], v[56:59], v[88:91], a[108:111]
v_lshlrev_b64 v[22:23], 16, v[30:31]
v_lshlrev_b64 v[24:25], 16, v[46:47]
v_mfma_f32_16x16x32_bf16 a[104:107], v[52:55], v[88:91], a[104:107]
v_add_f32 v26, v30, v46
v_add_f32 v27, v31, v47
v_mfma_f32_16x16x32_bf16 a[112:115], v[52:55], v[100:103], a[112:115]
v_add_f32 v22, v22, v24
v_add_f32 v23, v23, v25
v_mfma_f32_16x16x32_bf16 a[116:119], v[56:59], v[100:103], a[116:119]
v_cvt_pk_bf16_f32 v62, v22, v26
v_perm_b32 v63, v27, v23, s20
v_mfma_f32_16x16x32_bf16 a[124:127], v[56:59], v[192:195], a[124:127]
buffer_load_dwordx4 v6, s[8:11], s36 offen offset:1024 lds
v_mfma_f32_16x16x32_bf16 a[120:123], v[52:55], v[192:195], a[120:123]
s_waitcnt lgkmcnt(2)
v_lshlrev_b64 v[16:17], 16, v[32:33]
v_lshlrev_b64 v[18:19], 16, v[48:49]
v_mfma_f32_16x16x32_bf16 a[128:131], v[68:71], v[160:163], a[128:131]
v_add_f32 v20, v32, v48
v_add_f32 v21, v33, v49
v_mfma_f32_16x16x32_bf16 a[132:135], v[72:75], v[160:163], a[132:135]
v_add_f32 v16, v16, v18
v_add_f32 v17, v17, v19
v_mfma_f32_16x16x32_bf16 a[140:143], v[72:75], v[148:151], a[140:143]
s_add_u32 s101, s3, 262272
v_perm_b32 v64, v20, v16, s20
v_perm_b32 v65, v21, v17, s20
v_mfma_f32_16x16x32_bf16 a[136:139], v[68:71], v[148:151], a[136:139]
s_add_u32 m0, s41, 16384
v_lshlrev_b64 v[22:23], 16, v[34:35]
v_lshlrev_b64 v[24:25], 16, v[50:51]
v_mfma_f32_16x16x32_bf16 a[144:147], v[68:71], v[152:155], a[144:147]
buffer_load_dwordx4 v9, s[4:7], s101 offen lds
v_mfma_f32_16x16x32_bf16 a[148:151], v[72:75], v[152:155], a[148:151]
v_add_f32 v26, v34, v50
v_add_f32 v27, v35, v51
v_mfma_f32_16x16x32_bf16 a[156:159], v[72:75], v[172:175], a[156:159]
ds_read_b128 v[228:231], v2 offset:38656
v_add_f32 v22, v22, v24
v_mfma_f32_16x16x32_bf16 a[152:155], v[68:71], v[172:175], a[152:155]
v_add_f32 v23, v23, v25
v_cvt_pk_bf16_f32 v66, v22, v26
v_mfma_f32_16x16x32_bf16 a[160:163], v[68:71], v[156:159], a[160:163]
s_add_u32 s101, s3, 270464
v_perm_b32 v67, v27, v23, s20
v_lshlrev_b64 v[16:17], 16, v[216:217]
v_mfma_f32_16x16x32_bf16 a[164:167], v[72:75], v[156:159], a[164:167]
s_add_u32 m0, s41, 17408
v_lshlrev_b64 v[18:19], 16, v[208:209]
v_add_f32 v20, v216, v208
v_mfma_f32_16x16x32_bf16 a[172:175], v[72:75], v[96:99], a[172:175]
buffer_load_dwordx4 v9, s[4:7], s101 offen lds
v_mfma_f32_16x16x32_bf16 a[168:171], v[68:71], v[96:99], a[168:171]
v_add_f32 v21, v217, v209
v_add_f32 v16, v16, v18
v_mfma_f32_16x16x32_bf16 a[176:179], v[68:71], v[224:227], a[176:179]
v_add_f32 v17, v17, v19
v_perm_b32 v204, v20, v16, s20
v_mfma_f32_16x16x32_bf16 a[180:183], v[72:75], v[224:227], a[180:183]
v_perm_b32 v205, v21, v17, s20
v_lshlrev_b64 v[22:23], 16, v[218:219]
v_mfma_f32_16x16x32_bf16 a[188:191], v[72:75], v[200:203], a[188:191]
v_lshlrev_b64 v[24:25], 16, v[210:211]
v_add_f32 v26, v218, v210
v_mfma_f32_16x16x32_bf16 a[184:187], v[68:71], v[200:203], a[184:187]
v_add_f32 v27, v219, v211
v_add_f32 v22, v22, v24
v_mfma_f32_16x16x32_bf16 a[0:3], v[28:31], v[116:119], a[0:3]
s_waitcnt vmcnt(15)
v_add_f32 v23, v23, v25
v_cvt_pk_bf16_f32 v206, v22, v26
v_mfma_f32_16x16x32_bf16 a[4:7], v[32:35], v[116:119], a[4:7]
s_barrier
ds_read_b64_tr_b16 v[36:37], v3 offset:24576
v_mfma_f32_16x16x32_bf16 a[12:15], v[32:35], v[120:123], a[12:15]
ds_read_b64_tr_b16 v[38:39], v3 offset:25088
v_perm_b32 v207, v27, v23, s20
v_mfma_f32_16x16x32_bf16 a[8:11], v[28:31], v[120:123], a[8:11]
s_waitcnt lgkmcnt(3)
ds_read_b64_tr_b16 v[40:41], v4 offset:24576
v_lshlrev_b64 v[16:17], 16, v[220:221]
v_mfma_f32_16x16x32_bf16 a[16:19], v[28:31], v[124:127], a[16:19]
ds_read_b64_tr_b16 v[42:43], v4 offset:25088
v_lshlrev_b64 v[18:19], 16, v[212:213]
v_mfma_f32_16x16x32_bf16 a[20:23], v[32:35], v[124:127], a[20:23]
ds_read_b64_tr_b16 v[52:53], v3 offset:28672
v_add_f32 v20, v220, v212
v_mfma_f32_16x16x32_bf16 a[28:31], v[32:35], v[104:107], a[28:31]
ds_read_b64_tr_b16 v[54:55], v3 offset:29184
v_add_f32 v21, v221, v213
v_mfma_f32_16x16x32_bf16 a[24:27], v[28:31], v[104:107], a[24:27]
ds_read_b64_tr_b16 v[56:57], v4 offset:28672
v_add_f32 v16, v16, v18
v_mfma_f32_16x16x32_bf16 a[32:35], v[28:31], v[80:83], a[32:35]
ds_read_b64_tr_b16 v[58:59], v4 offset:29184
v_add_f32 v17, v17, v19
v_mfma_f32_16x16x32_bf16 a[36:39], v[32:35], v[80:83], a[36:39]
v_perm_b32 v136, v20, v16, s20
v_perm_b32 v137, v21, v17, s20
v_mfma_f32_16x16x32_bf16 a[44:47], v[32:35], v[76:79], a[44:47]
s_add_u32 s36, s35, 13107200
v_lshlrev_b64 v[22:23], 16, v[222:223]
v_lshlrev_b64 v[24:25], 16, v[214:215]
v_mfma_f32_16x16x32_bf16 a[40:43], v[28:31], v[76:79], a[40:43]
s_add_u32 m0, s30, 16384
v_add_f32 v26, v222, v214
v_add_f32 v27, v223, v215
v_mfma_f32_16x16x32_bf16 a[48:51], v[28:31], v[84:87], a[48:51]
buffer_load_dwordx4 v5, s[8:11], s36 offen offset:0 lds
v_mfma_f32_16x16x32_bf16 a[52:55], v[32:35], v[84:87], a[52:55]
v_add_f32 v22, v22, v24
v_add_f32 v23, v23, v25
v_mfma_f32_16x16x32_bf16 a[60:63], v[32:35], v[196:199], a[60:63]
v_cvt_pk_bf16_f32 v138, v22, v26
v_perm_b32 v139, v27, v23, s20
v_mfma_f32_16x16x32_bf16 a[56:59], v[28:31], v[196:199], a[56:59]
s_waitcnt lgkmcnt(2)
v_lshlrev_b64 v[16:17], 16, v[36:37]
v_lshlrev_b64 v[18:19], 16, v[52:53]
v_mfma_f32_16x16x32_bf16 a[64:67], v[44:47], v[132:135], a[64:67]
v_add_f32 v20, v36, v52
v_add_f32 v21, v37, v53
v_mfma_f32_16x16x32_bf16 a[68:71], v[48:51], v[132:135], a[68:71]
v_add_f32 v16, v16, v18
v_add_f32 v17, v17, v19
v_mfma_f32_16x16x32_bf16 a[76:79], v[48:51], v[144:147], a[76:79]
buffer_load_dwordx4 v6, s[8:11], s36 offen offset:1024 lds
v_mfma_f32_16x16x32_bf16 a[72:75], v[44:47], v[144:147], a[72:75]
v_perm_b32 v68, v20, v16, s20
v_perm_b32 v69, v21, v17, s20
v_mfma_f32_16x16x32_bf16 a[80:83], v[44:47], v[112:115], a[80:83]
v_lshlrev_b64 v[22:23], 16, v[38:39]
v_lshlrev_b64 v[24:25], 16, v[54:55]
v_mfma_f32_16x16x32_bf16 a[84:87], v[48:51], v[112:115], a[84:87]
v_add_f32 v26, v38, v54
v_add_f32 v27, v39, v55
v_mfma_f32_16x16x32_bf16 a[92:95], v[48:51], v[92:95], a[92:95]
s_add_u32 s36, s35, 14155776
v_add_f32 v22, v22, v24
v_add_f32 v23, v23, v25
v_mfma_f32_16x16x32_bf16 a[88:91], v[44:47], v[92:95], a[88:91]
s_add_u32 m0, s30, 20480
v_cvt_pk_bf16_f32 v70, v22, v26
v_perm_b32 v71, v27, v23, s20
v_mfma_f32_16x16x32_bf16 a[96:99], v[44:47], v[88:91], a[96:99]
buffer_load_dwordx4 v5, s[8:11], s36 offen offset:0 lds
v_mfma_f32_16x16x32_bf16 a[100:103], v[48:51], v[88:91], a[100:103]
s_waitcnt lgkmcnt(0)
v_lshlrev_b64 v[16:17], 16, v[40:41]
v_lshlrev_b64 v[18:19], 16, v[56:57]
v_mfma_f32_16x16x32_bf16 a[108:111], v[48:51], v[100:103], a[108:111]
v_add_f32 v20, v40, v56
v_add_f32 v21, v41, v57
v_mfma_f32_16x16x32_bf16 a[104:107], v[44:47], v[100:103], a[104:107]
v_add_f32 v16, v16, v18
v_add_f32 v17, v17, v19
v_mfma_f32_16x16x32_bf16 a[112:115], v[44:47], v[192:195], a[112:115]
v_perm_b32 v72, v20, v16, s20
v_perm_b32 v73, v21, v17, s20
v_mfma_f32_16x16x32_bf16 a[116:119], v[48:51], v[192:195], a[116:119]
v_lshlrev_b64 v[22:23], 16, v[42:43]
v_lshlrev_b64 v[24:25], 16, v[58:59]
v_mfma_f32_16x16x32_bf16 a[124:127], v[48:51], v[216:219], a[124:127]
buffer_load_dwordx4 v6, s[8:11], s36 offen offset:1024 lds
v_mfma_f32_16x16x32_bf16 a[120:123], v[44:47], v[216:219], a[120:123]
v_add_f32 v26, v42, v58
v_add_f32 v27, v43, v59
v_mfma_f32_16x16x32_bf16 a[128:131], v[60:63], v[148:151], a[128:131]
v_add_f32 v22, v22, v24
v_add_f32 v23, v23, v25
v_mfma_f32_16x16x32_bf16 a[132:135], v[64:67], v[148:151], a[132:135]
v_cvt_pk_bf16_f32 v74, v22, v26
v_perm_b32 v75, v27, v23, s20
v_mfma_f32_16x16x32_bf16 a[140:143], v[64:67], v[152:155], a[140:143]
s_add_u32 s101, s3, 278656
v_mfma_f32_16x16x32_bf16 a[136:139], v[60:63], v[152:155], a[136:139]
s_add_u32 m0, s41, 18432
v_mfma_f32_16x16x32_bf16 a[144:147], v[60:63], v[172:175], a[144:147]
buffer_load_dwordx4 v9, s[4:7], s101 offen lds
v_mfma_f32_16x16x32_bf16 a[148:151], v[64:67], v[172:175], a[148:151]
v_mfma_f32_16x16x32_bf16 a[156:159], v[64:67], v[156:159], a[156:159]
v_mfma_f32_16x16x32_bf16 a[152:155], v[60:63], v[156:159], a[152:155]
v_mfma_f32_16x16x32_bf16 a[160:163], v[60:63], v[96:99], a[160:163]
s_add_u32 s101, s3, 286848
v_mfma_f32_16x16x32_bf16 a[164:167], v[64:67], v[96:99], a[164:167]
s_add_u32 m0, s41, 19456
v_mfma_f32_16x16x32_bf16 a[172:175], v[64:67], v[224:227], a[172:175]
buffer_load_dwordx4 v9, s[4:7], s101 offen lds
v_mfma_f32_16x16x32_bf16 a[168:171], v[60:63], v[224:227], a[168:171]
v_mfma_f32_16x16x32_bf16 a[176:179], v[60:63], v[200:203], a[176:179]
v_mfma_f32_16x16x32_bf16 a[180:183], v[64:67], v[200:203], a[180:183]
v_mfma_f32_16x16x32_bf16 a[188:191], v[64:67], v[204:207], a[188:191]
v_mfma_f32_16x16x32_bf16 a[184:187], v[60:63], v[204:207], a[184:187]
v_mfma_f32_16x16x32_bf16 a[0:3], v[36:39], v[120:123], a[0:3]
s_waitcnt vmcnt(15)
v_mfma_f32_16x16x32_bf16 a[4:7], v[40:43], v[120:123], a[4:7]
s_barrier
ds_read_b64_tr_b16 v[28:29], v3 offset:0
v_mfma_f32_16x16x32_bf16 a[12:15], v[40:43], v[124:127], a[12:15]
ds_read_b64_tr_b16 v[30:31], v3 offset:512
v_mfma_f32_16x16x32_bf16 a[8:11], v[36:39], v[124:127], a[8:11]
ds_read_b64_tr_b16 v[32:33], v4 offset:0
v_mfma_f32_16x16x32_bf16 a[16:19], v[36:39], v[104:107], a[16:19]
ds_read_b64_tr_b16 v[34:35], v4 offset:512
v_mfma_f32_16x16x32_bf16 a[20:23], v[40:43], v[104:107], a[20:23]
ds_read_b64_tr_b16 v[44:45], v3 offset:4096
v_mfma_f32_16x16x32_bf16 a[28:31], v[40:43], v[80:83], a[28:31]
ds_read_b64_tr_b16 v[46:47], v3 offset:4608
v_mfma_f32_16x16x32_bf16 a[24:27], v[36:39], v[80:83], a[24:27]
ds_read_b64_tr_b16 v[48:49], v4 offset:4096
v_mfma_f32_16x16x32_bf16 a[32:35], v[36:39], v[76:79], a[32:35]
ds_read_b64_tr_b16 v[50:51], v4 offset:4608
v_mfma_f32_16x16x32_bf16 a[36:39], v[40:43], v[76:79], a[36:39]
v_mfma_f32_16x16x32_bf16 a[44:47], v[40:43], v[84:87], a[44:47]
s_add_u32 s36, s35, 15204352
v_mfma_f32_16x16x32_bf16 a[40:43], v[36:39], v[84:87], a[40:43]
s_add_u32 m0, s30, 24576
v_mfma_f32_16x16x32_bf16 a[48:51], v[36:39], v[196:199], a[48:51]
buffer_load_dwordx4 v5, s[8:11], s36 offen offset:0 lds
v_mfma_f32_16x16x32_bf16 a[52:55], v[40:43], v[196:199], a[52:55]
v_mfma_f32_16x16x32_bf16 a[60:63], v[40:43], v[208:211], a[60:63]
s_waitcnt lgkmcnt(2)
v_lshlrev_b64 v[16:17], 16, v[28:29]
v_lshlrev_b64 v[18:19], 16, v[44:45]
v_mfma_f32_16x16x32_bf16 a[56:59], v[36:39], v[208:211], a[56:59]
v_add_f32 v20, v28, v44
v_add_f32 v21, v29, v45
v_mfma_f32_16x16x32_bf16 a[64:67], v[52:55], v[144:147], a[64:67]
v_add_f32 v16, v16, v18
v_add_f32 v17, v17, v19
v_mfma_f32_16x16x32_bf16 a[68:71], v[56:59], v[144:147], a[68:71]
v_perm_b32 v60, v20, v16, s20
v_perm_b32 v61, v21, v17, s20
v_mfma_f32_16x16x32_bf16 a[76:79], v[56:59], v[112:115], a[76:79]
buffer_load_dwordx4 v6, s[8:11], s36 offen offset:1024 lds
v_mfma_f32_16x16x32_bf16 a[72:75], v[52:55], v[112:115], a[72:75]
v_lshlrev_b64 v[22:23], 16, v[30:31]
v_lshlrev_b64 v[24:25], 16, v[46:47]
v_mfma_f32_16x16x32_bf16 a[80:83], v[52:55], v[92:95], a[80:83]
v_add_f32 v26, v30, v46
v_add_f32 v27, v31, v47
v_mfma_f32_16x16x32_bf16 a[84:87], v[56:59], v[92:95], a[84:87]
v_add_f32 v22, v22, v24
v_add_f32 v23, v23, v25
v_mfma_f32_16x16x32_bf16 a[92:95], v[56:59], v[88:91], a[92:95]
v_cvt_pk_bf16_f32 v62, v22, v26
v_perm_b32 v63, v27, v23, s20
v_mfma_f32_16x16x32_bf16 a[88:91], v[52:55], v[88:91], a[88:91]
s_waitcnt lgkmcnt(0)
v_lshlrev_b64 v[16:17], 16, v[32:33]
v_lshlrev_b64 v[18:19], 16, v[48:49]
v_mfma_f32_16x16x32_bf16 a[96:99], v[52:55], v[100:103], a[96:99]
v_add_f32 v20, v32, v48
v_add_f32 v21, v33, v49
v_mfma_f32_16x16x32_bf16 a[100:103], v[56:59], v[100:103], a[100:103]
v_add_f32 v16, v16, v18
v_add_f32 v17, v17, v19
v_mfma_f32_16x16x32_bf16 a[108:111], v[56:59], v[192:195], a[108:111]
v_perm_b32 v64, v20, v16, s20
v_perm_b32 v65, v21, v17, s20
v_mfma_f32_16x16x32_bf16 a[104:107], v[52:55], v[192:195], a[104:107]
v_lshlrev_b64 v[22:23], 16, v[34:35]
v_lshlrev_b64 v[24:25], 16, v[50:51]
v_mfma_f32_16x16x32_bf16 a[112:115], v[52:55], v[216:219], a[112:115]
v_add_f32 v26, v34, v50
v_add_f32 v27, v35, v51
v_mfma_f32_16x16x32_bf16 a[116:119], v[56:59], v[216:219], a[116:119]
v_add_f32 v22, v22, v24
v_add_f32 v23, v23, v25
v_mfma_f32_16x16x32_bf16 a[124:127], v[56:59], v[220:223], a[124:127]
v_cvt_pk_bf16_f32 v66, v22, v26
v_perm_b32 v67, v27, v23, s20
v_mfma_f32_16x16x32_bf16 a[120:123], v[52:55], v[220:223], a[120:123]
v_mfma_f32_16x16x32_bf16 a[128:131], v[68:71], v[152:155], a[128:131]
v_mfma_f32_16x16x32_bf16 a[132:135], v[72:75], v[152:155], a[132:135]
v_mov_b32_dpp v168, v152 row_shl:1 row_mask:0xf bank_mask:0xf bound_ctrl:0
v_mov_b32_dpp v169, v153 row_shl:1 row_mask:0xf bank_mask:0xf bound_ctrl:0
v_mfma_f32_16x16x32_bf16 a[140:143], v[72:75], v[172:175], a[140:143]
s_add_u32 s101, s3, 128
v_mov_b32_dpp v170, v154 row_shl:1 row_mask:0xf bank_mask:0xf bound_ctrl:0
v_mov_b32_dpp v171, v155 row_shl:1 row_mask:0xf bank_mask:0xf bound_ctrl:0
v_mfma_f32_16x16x32_bf16 a[136:139], v[68:71], v[172:175], a[136:139]
s_add_u32 m0, s46, 32768
v_mfma_f32_16x16x32_bf16 a[144:147], v[68:71], v[156:159], a[144:147]
buffer_load_dwordx4 v10, s[4:7], s101 offen lds
v_mfma_f32_16x16x32_bf16 a[148:151], v[72:75], v[156:159], a[148:151]
v_mfma_f32_16x16x32_bf16 a[156:159], v[72:75], v[96:99], a[156:159]
v_mfma_f32_16x16x32_bf16 a[152:155], v[68:71], v[96:99], a[152:155]
v_mfma_f32_16x16x32_bf16 a[160:163], v[68:71], v[224:227], a[160:163]
v_mfma_f32_16x16x32_bf16 a[164:167], v[72:75], v[224:227], a[164:167]
v_mfma_f32_16x16x32_bf16 a[172:175], v[72:75], v[200:203], a[172:175]
v_mfma_f32_16x16x32_bf16 a[168:171], v[68:71], v[200:203], a[168:171]
v_mfma_f32_16x16x32_bf16 a[176:179], v[68:71], v[204:207], a[176:179]
v_mfma_f32_16x16x32_bf16 a[180:183], v[72:75], v[204:207], a[180:183]
v_mfma_f32_16x16x32_bf16 a[188:191], v[72:75], v[136:139], a[188:191]
v_mfma_f32_16x16x32_bf16 a[184:187], v[68:71], v[136:139], a[184:187]
v_mfma_f32_16x16x32_bf16 a[0:3], v[28:31], v[124:127], a[0:3]
s_waitcnt vmcnt(11)
v_mfma_f32_16x16x32_bf16 a[4:7], v[32:35], v[124:127], a[4:7]
s_barrier
ds_read_b64_tr_b16 v[36:37], v3 offset:8192
v_mfma_f32_16x16x32_bf16 a[12:15], v[32:35], v[104:107], a[12:15]
ds_read_b64_tr_b16 v[38:39], v3 offset:8704
v_mov_b32_dpp v152, v124 row_shl:1 row_mask:0xf bank_mask:0xf bound_ctrl:0
v_mfma_f32_16x16x32_bf16 a[8:11], v[28:31], v[104:107], a[8:11]
ds_read_b64_tr_b16 v[40:41], v4 offset:8192
v_mov_b32_dpp v153, v125 row_shl:1 row_mask:0xf bank_mask:0xf bound_ctrl:0
v_mfma_f32_16x16x32_bf16 a[16:19], v[28:31], v[80:83], a[16:19]
ds_read_b64_tr_b16 v[42:43], v4 offset:8704
v_mov_b32_dpp v154, v126 row_shl:1 row_mask:0xf bank_mask:0xf bound_ctrl:0
v_mfma_f32_16x16x32_bf16 a[20:23], v[32:35], v[80:83], a[20:23]
ds_read_b64_tr_b16 v[52:53], v3 offset:12288
v_mov_b32_dpp v155, v127 row_shl:1 row_mask:0xf bank_mask:0xf bound_ctrl:0
v_mfma_f32_16x16x32_bf16 a[28:31], v[32:35], v[76:79], a[28:31]
ds_read_b64_tr_b16 v[54:55], v3 offset:12800
v_mfma_f32_16x16x32_bf16 a[24:27], v[28:31], v[76:79], a[24:27]
ds_read_b64_tr_b16 v[56:57], v4 offset:12288
v_mfma_f32_16x16x32_bf16 a[32:35], v[28:31], v[84:87], a[32:35]
ds_read_b64_tr_b16 v[58:59], v4 offset:12800
v_mfma_f32_16x16x32_bf16 a[36:39], v[32:35], v[84:87], a[36:39]
v_mfma_f32_16x16x32_bf16 a[44:47], v[32:35], v[196:199], a[44:47]
s_add_u32 s36, s35, 65536
v_mfma_f32_16x16x32_bf16 a[40:43], v[28:31], v[196:199], a[40:43]
s_add_u32 m0, s30, 0
v_mfma_f32_16x16x32_bf16 a[48:51], v[28:31], v[208:211], a[48:51]
buffer_load_dwordx4 v5, s[8:11], s36 offen offset:0 lds
v_mfma_f32_16x16x32_bf16 a[52:55], v[32:35], v[208:211], a[52:55]
v_mfma_f32_16x16x32_bf16 a[60:63], v[32:35], v[212:215], a[60:63]
s_waitcnt lgkmcnt(2)
v_lshlrev_b64 v[16:17], 16, v[36:37]
v_lshlrev_b64 v[18:19], 16, v[52:53]
v_mfma_f32_16x16x32_bf16 a[56:59], v[28:31], v[212:215], a[56:59]
v_add_f32 v20, v36, v52
v_add_f32 v21, v37, v53
v_mfma_f32_16x16x32_bf16 a[64:67], v[44:47], v[112:115], a[64:67]
v_add_f32 v16, v16, v18
v_add_f32 v17, v17, v19
v_mfma_f32_16x16x32_bf16 a[68:71], v[48:51], v[112:115], a[68:71]
v_perm_b32 v68, v20, v16, s20
v_perm_b32 v69, v21, v17, s20
v_mfma_f32_16x16x32_bf16 a[76:79], v[48:51], v[92:95], a[76:79]
buffer_load_dwordx4 v6, s[8:11], s36 offen offset:1024 lds
v_mfma_f32_16x16x32_bf16 a[72:75], v[44:47], v[92:95], a[72:75]
v_mov_b32_dpp v120, v112 row_shl:1 row_mask:0xf bank_mask:0xf bound_ctrl:0
v_mov_b32_dpp v121, v113 row_shl:1 row_mask:0xf bank_mask:0xf bound_ctrl:0
v_mfma_f32_16x16x32_bf16 a[80:83], v[44:47], v[88:91], a[80:83]
v_mov_b32_dpp v122, v114 row_shl:1 row_mask:0xf bank_mask:0xf bound_ctrl:0
v_mov_b32_dpp v123, v115 row_shl:1 row_mask:0xf bank_mask:0xf bound_ctrl:0
v_mfma_f32_16x16x32_bf16 a[84:87], v[48:51], v[88:91], a[84:87]
v_lshlrev_b64 v[22:23], 16, v[38:39]
v_lshlrev_b64 v[24:25], 16, v[54:55]
v_mfma_f32_16x16x32_bf16 a[92:95], v[48:51], v[100:103], a[92:95]
s_add_u32 s36, s35, 1114112
v_add_f32 v26, v38, v54
v_add_f32 v27, v39, v55
v_mfma_f32_16x16x32_bf16 a[88:91], v[44:47], v[100:103], a[88:91]
s_add_u32 m0, s30, 4096
v_add_f32 v22, v22, v24
v_add_f32 v23, v23, v25
v_mfma_f32_16x16x32_bf16 a[96:99], v[44:47], v[192:195], a[96:99]
buffer_load_dwordx4 v5, s[8:11], s36 offen offset:0 lds
v_mfma_f32_16x16x32_bf16 a[100:103], v[48:51], v[192:195], a[100:103]
v_cvt_pk_bf16_f32 v70, v22, v26
v_perm_b32 v71, v27, v23, s20
v_mfma_f32_16x16x32_bf16 a[108:111], v[48:51], v[216:219], a[108:111]
s_waitcnt lgkmcnt(0)
v_lshlrev_b64 v[16:17], 16, v[40:41]
v_lshlrev_b64 v[18:19], 16, v[56:57]
v_mfma_f32_16x16x32_bf16 a[104:107], v[44:47], v[216:219], a[104:107]
v_add_f32 v20, v40, v56
v_add_f32 v21, v41, v57
v_mfma_f32_16x16x32_bf16 a[112:115], v[44:47], v[220:223], a[112:115]
v_add_f32 v16, v16, v18
v_add_f32 v17, v17, v19
v_mfma_f32_16x16x32_bf16 a[116:119], v[48:51], v[220:223], a[116:119]
v_perm_b32 v72, v20, v16, s20
v_perm_b32 v73, v21, v17, s20
v_mfma_f32_16x16x32_bf16 a[124:127], v[48:51], v[228:231], a[124:127]
buffer_load_dwordx4 v6, s[8:11], s36 offen offset:1024 lds
v_mfma_f32_16x16x32_bf16 a[120:123], v[44:47], v[228:231], a[120:123]
v_lshlrev_b64 v[22:23], 16, v[42:43]
v_lshlrev_b64 v[24:25], 16, v[58:59]
v_mfma_f32_16x16x32_bf16 a[128:131], v[60:63], v[172:175], a[128:131]
L_pad3:
s_cbranch_execz L_pad7
v_add_f32 v26, v42, v58
v_add_f32 v27, v43, v59
v_mfma_f32_16x16x32_bf16 a[132:135], v[64:67], v[172:175], a[132:135]
v_add_f32 v22, v22, v24
v_add_f32 v23, v23, v25
v_mfma_f32_16x16x32_bf16 a[140:143], v[64:67], v[156:159], a[140:143]
v_cvt_pk_bf16_f32 v74, v22, v26
v_perm_b32 v75, v27, v23, s20
v_mfma_f32_16x16x32_bf16 a[136:139], v[60:63], v[156:159], a[136:139]
v_mov_b32_dpp v176, v172 row_shl:1 row_mask:0xf bank_mask:0xf bound_ctrl:0
v_mov_b32_dpp v177, v173 row_shl:1 row_mask:0xf bank_mask:0xf bound_ctrl:0
v_mfma_f32_16x16x32_bf16 a[144:147], v[60:63], v[96:99], a[144:147]
v_mov_b32_dpp v178, v174 row_shl:1 row_mask:0xf bank_mask:0xf bound_ctrl:0
v_mov_b32_dpp v179, v175 row_shl:1 row_mask:0xf bank_mask:0xf bound_ctrl:0
v_mfma_f32_16x16x32_bf16 a[148:151], v[64:67], v[96:99], a[148:151]
v_mfma_f32_16x16x32_bf16 a[156:159], v[64:67], v[224:227], a[156:159]
v_mfma_f32_16x16x32_bf16 a[152:155], v[60:63], v[224:227], a[152:155]
v_mfma_f32_16x16x32_bf16 a[160:163], v[60:63], v[200:203], a[160:163]
buffer_load_dword a192, v12, s[96:99], 0 offen sc1
v_mfma_f32_16x16x32_bf16 a[164:167], v[64:67], v[200:203], a[164:167]
v_mfma_f32_16x16x32_bf16 a[172:175], v[64:67], v[204:207], a[172:175]
v_add_u32 v12, 128, v12
v_mfma_f32_16x16x32_bf16 a[168:171], v[60:63], v[204:207], a[168:171]
v_mfma_f32_16x16x32_bf16 a[176:179], v[60:63], v[136:139], a[176:179]
v_mfma_f32_16x16x32_bf16 a[180:183], v[64:67], v[136:139], a[180:183]
v_mfma_f32_16x16x32_bf16 a[188:191], v[64:67], v[168:171], a[188:191]
s_sub_u32 s37, s37, 1
v_mfma_f32_16x16x32_bf16 a[184:187], v[60:63], v[168:171], a[184:187]
s_add_u32 s3, s3, 128
v_mfma_f32_16x16x32_bf16 a[0:3], v[36:39], v[104:107], a[0:3]
s_waitcnt vmcnt(5)
v_mfma_f32_16x16x32_bf16 a[4:7], v[40:43], v[104:107], a[4:7]
s_barrier
ds_read_b64_tr_b16 v[28:29], v3 offset:16384
v_mfma_f32_16x16x32_bf16 a[12:15], v[40:43], v[80:83], a[12:15]
ds_read_b64_tr_b16 v[30:31], v3 offset:16896
v_mov_b32_dpp v232, v104 row_shl:1 row_mask:0xf bank_mask:0xf bound_ctrl:0
v_mfma_f32_16x16x32_bf16 a[8:11], v[36:39], v[80:83], a[8:11]
ds_read_b64_tr_b16 v[32:33], v4 offset:16384
v_mov_b32_dpp v233, v105 row_shl:1 row_mask:0xf bank_mask:0xf bound_ctrl:0
v_mfma_f32_16x16x32_bf16 a[16:19], v[36:39], v[76:79], a[16:19]
ds_read_b64_tr_b16 v[34:35], v4 offset:16896
v_mov_b32_dpp v234, v106 row_shl:1 row_mask:0xf bank_mask:0xf bound_ctrl:0
v_mfma_f32_16x16x32_bf16 a[20:23], v[40:43], v[76:79], a[20:23]
ds_read_b64_tr_b16 v[44:45], v3 offset:20480
v_mov_b32_dpp v235, v107 row_shl:1 row_mask:0xf bank_mask:0xf bound_ctrl:0
v_mfma_f32_16x16x32_bf16 a[28:31], v[40:43], v[84:87], a[28:31]
ds_read_b64_tr_b16 v[46:47], v3 offset:20992
v_mfma_f32_16x16x32_bf16 a[24:27], v[36:39], v[84:87], a[24:27]
ds_read_b64_tr_b16 v[48:49], v4 offset:20480
v_mfma_f32_16x16x32_bf16 a[32:35], v[36:39], v[196:199], a[32:35]
ds_read_b64_tr_b16 v[50:51], v4 offset:20992
v_mfma_f32_16x16x32_bf16 a[36:39], v[40:43], v[196:199], a[36:39]
v_mfma_f32_16x16x32_bf16 a[44:47], v[40:43], v[208:211], a[44:47]
s_add_u32 s36, s35, 2162688
ds_read_b128 a[204:207], v1 offset:0
v_mfma_f32_16x16x32_bf16 a[40:43], v[36:39], v[208:211], a[40:43]
s_add_u32 m0, s30, 8192
ds_read_b128 v[128:131], v1 offset:256
v_mfma_f32_16x16x32_bf16 a[48:51], v[36:39], v[212:215], a[48:51]
buffer_load_dwordx4 v5, s[8:11], s36 offen offset:0 lds
v_mfma_f32_16x16x32_bf16 a[52:55], v[40:43], v[212:215], a[52:55]
ds_read_b128 v[108:111], v1 offset:512
v_mfma_f32_16x16x32_bf16 a[60:63], v[40:43], v[152:155], a[60:63]
s_waitcnt lgkmcnt(5)
v_lshlrev_b64 v[16:17], 16, v[28:29]
v_lshlrev_b64 v[18:19], 16, v[44:45]
v_mfma_f32_16x16x32_bf16 a[56:59], v[36:39], v[152:155], a[56:59]
v_add_f32 v20, v28, v44
v_add_f32 v21, v29, v45
v_mfma_f32_16x16x32_bf16 a[64:67], v[52:55], v[92:95], a[64:67]
v_add_f32 v16, v16, v18
v_add_f32 v17, v17, v19
v_mfma_f32_16x16x32_bf16 a[68:71], v[56:59], v[92:95], a[68:71]
v_perm_b32 v60, v20, v16, s20
v_perm_b32 v61, v21, v17, s20
v_mfma_f32_16x16x32_bf16 a[76:79], v[56:59], v[88:91], a[76:79]
buffer_load_dwordx4 v6, s[8:11], s36 offen offset:1024 lds
v_mfma_f32_16x16x32_bf16 a[72:75], v[52:55], v[88:91], a[72:75]
v_mov_b32_dpp v104, v92 row_shl:1 row_mask:0xf bank_mask:0xf bound_ctrl:0
v_mov_b32_dpp v105, v93 row_shl:1 row_mask:0xf bank_mask:0xf bound_ctrl:0
v_mfma_f32_16x16x32_bf16 a[80:83], v[52:55], v[100:103], a[80:83]
ds_read_b128 v[184:187], v1 offset:768
v_mov_b32_dpp v106, v94 row_shl:1 row_mask:0xf bank_mask:0xf bound_ctrl:0
v_mfma_f32_16x16x32_bf16 a[84:87], v[56:59], v[100:103], a[84:87]
ds_read_b128 v[164:167], v1 offset:1024
v_mov_b32_dpp v107, v95 row_shl:1 row_mask:0xf bank_mask:0xf bound_ctrl:0
v_mfma_f32_16x16x32_bf16 a[92:95], v[56:59], v[192:195], a[92:95]
s_add_u32 s36, s35, 3211264
v_lshlrev_b64 v[22:23], 16, v[30:31]
v_lshlrev_b64 v[24:25], 16, v[46:47]
v_mfma_f32_16x16x32_bf16 a[88:91], v[52:55], v[192:195], a[88:91]
s_add_u32 m0, s30, 12288
v_add_f32 v26, v30, v46
v_add_f32 v27, v31, v47
v_mfma_f32_16x16x32_bf16 a[96:99], v[52:55], v[216:219], a[96:99]
buffer_load_dwordx4 v5, s[8:11], s36 offen offset:0 lds
v_mfma_f32_16x16x32_bf16 a[100:103], v[56:59], v[216:219], a[100:103]
v_add_f32 v22, v22, v24
v_add_f32 v23, v23, v25
v_mfma_f32_16x16x32_bf16 a[108:111], v[56:59], v[220:223], a[108:111]
v_cvt_pk_bf16_f32 v62, v22, v26
v_perm_b32 v63, v27, v23, s20
v_mfma_f32_16x16x32_bf16 a[104:107], v[52:55], v[220:223], a[104:107]
s_waitcnt lgkmcnt(5)
v_lshlrev_b64 v[16:17], 16, v[32:33]
v_lshlrev_b64 v[18:19], 16, v[48:49]
v_mfma_f32_16x16x32_bf16 a[112:115], v[52:55], v[228:231], a[112:115]
v_add_f32 v20, v32, v48
v_add_f32 v21, v33, v49
v_mfma_f32_16x16x32_bf16 a[116:119], v[56:59], v[228:231], a[116:119]
v_add_f32 v16, v16, v18
v_add_f32 v17, v17, v19
v_mfma_f32_16x16x32_bf16 a[124:127], v[56:59], v[120:123], a[124:127]
buffer_load_dwordx4 v6, s[8:11], s36 offen offset:1024 lds
v_mfma_f32_16x16x32_bf16 a[120:123], v[52:55], v[120:123], a[120:123]
v_perm_b32 v64, v20, v16, s20
v_perm_b32 v65, v21, v17, s20
v_mfma_f32_16x16x32_bf16 a[128:131], v[68:71], v[156:159], a[128:131]
ds_read_b128 v[116:119], v1 offset:1280
v_lshlrev_b64 v[22:23], 16, v[34:35]
v_mfma_f32_16x16x32_bf16 a[132:135], v[72:75], v[156:159], a[132:135]
ds_read_b128 v[148:151], v1 offset:1536
v_lshlrev_b64 v[24:25], 16, v[50:51]
v_mfma_f32_16x16x32_bf16 a[140:143], v[72:75], v[96:99], a[140:143]
v_add_f32 v26, v34, v50
v_add_f32 v27, v35, v51
v_mfma_f32_16x16x32_bf16 a[136:139], v[68:71], v[96:99], a[136:139]
v_add_f32 v22, v22, v24
v_add_f32 v23, v23, v25
v_mfma_f32_16x16x32_bf16 a[144:147], v[68:71], v[224:227], a[144:147]
v_cvt_pk_bf16_f32 v66, v22, v26
v_perm_b32 v67, v27, v23, s20
v_mfma_f32_16x16x32_bf16 a[148:151], v[72:75], v[224:227], a[148:151]
v_mov_b32_dpp v188, v156 row_shl:1 row_mask:0xf bank_mask:0xf bound_ctrl:0
v_mov_b32_dpp v189, v157 row_shl:1 row_mask:0xf bank_mask:0xf bound_ctrl:0
v_mfma_f32_16x16x32_bf16 a[156:159], v[72:75], v[200:203], a[156:159]
v_mov_b32_dpp v190, v158 row_shl:1 row_mask:0xf bank_mask:0xf bound_ctrl:0
v_mov_b32_dpp v191, v159 row_shl:1 row_mask:0xf bank_mask:0xf bound_ctrl:0
v_mfma_f32_16x16x32_bf16 a[152:155], v[68:71], v[200:203], a[152:155]
s_waitcnt lgkmcnt(4)
v_lshlrev_b64 v[16:17], 16, v[128:129]
v_lshlrev_b64 v[18:19], 16, v[108:109]
v_mfma_f32_16x16x32_bf16 a[160:163], v[68:71], v[204:207], a[160:163]
v_add_f32 v20, v128, v108
v_add_f32 v21, v129, v109
v_mfma_f32_16x16x32_bf16 a[164:167], v[72:75], v[204:207], a[164:167]
v_add_f32 v16, v16, v18
v_add_f32 v17, v17, v19
v_mfma_f32_16x16x32_bf16 a[172:175], v[72:75], v[136:139], a[172:175]
v_perm_b32 v156, v20, v16, s20
v_perm_b32 v157, v21, v17, s20
v_mfma_f32_16x16x32_bf16 a[168:171], v[68:71], v[136:139], a[168:171]
v_lshlrev_b64 v[22:23], 16, v[130:131]
v_lshlrev_b64 v[24:25], 16, v[110:111]
v_mfma_f32_16x16x32_bf16 a[176:179], v[68:71], v[168:171], a[176:179]
v_add_f32 v26, v130, v110
v_add_f32 v27, v131, v111
v_mfma_f32_16x16x32_bf16 a[180:183], v[72:75], v[168:171], a[180:183]
v_add_f32 v22, v22, v24
v_add_f32 v23, v23, v25
v_mfma_f32_16x16x32_bf16 a[188:191], v[72:75], v[176:179], a[188:191]
v_cvt_pk_bf16_f32 v158, v22, v26
v_perm_b32 v159, v27, v23, s20
v_mfma_f32_16x16x32_bf16 a[184:187], v[68:71], v[176:179], a[184:187]
s_waitcnt lgkmcnt(2)
v_lshlrev_b64 v[16:17], 16, v[184:185]
v_lshlrev_b64 v[18:19], 16, v[164:165]
v_mfma_f32_16x16x32_bf16 a[0:3], v[28:31], v[80:83], a[0:3]
v_add_f32 v20, v184, v164
v_add_f32 v21, v185, v165
v_mfma_f32_16x16x32_bf16 a[4:7], v[32:35], v[80:83], a[4:7]
s_barrier
ds_read_b64_tr_b16 v[36:37], v3 offset:24576
v_mfma_f32_16x16x32_bf16 a[12:15], v[32:35], v[76:79], a[12:15]
ds_read_b64_tr_b16 v[38:39], v3 offset:25088
v_add_f32 v16, v16, v18
v_mfma_f32_16x16x32_bf16 a[8:11], v[28:31], v[76:79], a[8:11]
ds_read_b64_tr_b16 v[40:41], v4 offset:24576
v_add_f32 v17, v17, v19
v_mfma_f32_16x16x32_bf16 a[16:19], v[28:31], v[84:87], a[16:19]
ds_read_b64_tr_b16 v[42:43], v4 offset:25088
v_perm_b32 v180, v20, v16, s20
v_mfma_f32_16x16x32_bf16 a[20:23], v[32:35], v[84:87], a[20:23]
v_perm_b32 v181, v21, v17, s20
v_mov_b32_dpp v236, v80 row_shl:1 row_mask:0xf bank_mask:0xf bound_ctrl:0
v_mfma_f32_16x16x32_bf16 a[28:31], v[32:35], v[196:199], a[28:31]
v_mov_b32_dpp v237, v81 row_shl:1 row_mask:0xf bank_mask:0xf bound_ctrl:0
v_mov_b32_dpp v238, v82 row_shl:1 row_mask:0xf bank_mask:0xf bound_ctrl:0
v_mfma_f32_16x16x32_bf16 a[24:27], v[28:31], v[196:199], a[24:27]
v_mov_b32_dpp v239, v83 row_shl:1 row_mask:0xf bank_mask:0xf bound_ctrl:0
v_lshlrev_b64 v[22:23], 16, v[186:187]
v_mfma_f32_16x16x32_bf16 a[32:35], v[28:31], v[208:211], a[32:35]
v_lshlrev_b64 v[24:25], 16, v[166:167]
v_add_f32 v26, v186, v166
v_mfma_f32_16x16x32_bf16 a[36:39], v[32:35], v[208:211], a[36:39]
v_add_f32 v27, v187, v167
v_add_f32 v22, v22, v24
v_mfma_f32_16x16x32_bf16 a[44:47], v[32:35], v[212:215], a[44:47]
s_add_u32 s36, s35, 4259840
ds_read_b128 v[160:163], v1 offset:1792
v_add_f32 v23, v23, v25
v_mfma_f32_16x16x32_bf16 a[40:43], v[28:31], v[212:215], a[40:43]
s_add_u32 m0, s30, 16384
ds_read_b128 v[144:147], v1 offset:2048
v_cvt_pk_bf16_f32 v182, v22, v26
v_mfma_f32_16x16x32_bf16 a[48:51], v[28:31], v[152:155], a[48:51]
buffer_load_dwordx4 v5, s[8:11], s36 offen offset:0 lds
v_mfma_f32_16x16x32_bf16 a[52:55], v[32:35], v[152:155], a[52:55]
s_waitcnt lgkmcnt(6)
v_perm_b32 v183, v27, v23, s20
v_lshlrev_b64 v[16:17], 16, v[116:117]
v_mfma_f32_16x16x32_bf16 a[60:63], v[32:35], v[232:235], a[60:63]
v_lshlrev_b64 v[18:19], 16, v[148:149]
v_add_f32 v20, v116, v148
v_mfma_f32_16x16x32_bf16 a[56:59], v[28:31], v[232:235], a[56:59]
v_add_f32 v21, v117, v149
v_add_f32 v16, v16, v18
v_mfma_f32_16x16x32_bf16 a[64:67], v[44:47], v[88:91], a[64:67]
v_add_f32 v17, v17, v19
v_perm_b32 v140, v20, v16, s20
v_mfma_f32_16x16x32_bf16 a[68:71], v[48:51], v[88:91], a[68:71]
v_perm_b32 v141, v21, v17, s20
v_lshlrev_b64 v[22:23], 16, v[118:119]
v_mfma_f32_16x16x32_bf16 a[76:79], v[48:51], v[100:103], a[76:79]
buffer_load_dwordx4 v6, s[8:11], s36 offen offset:1024 lds
v_mfma_f32_16x16x32_bf16 a[72:75], v[44:47], v[100:103], a[72:75]
v_lshlrev_b64 v[24:25], 16, v[150:151]
v_add_f32 v26, v118, v150
v_mfma_f32_16x16x32_bf16 a[80:83], v[44:47], v[192:195], a[80:83]
ds_read_b128 v[132:135], v1 offset:2304
v_add_f32 v27, v119, v151
v_mfma_f32_16x16x32_bf16 a[84:87], v[48:51], v[192:195], a[84:87]
s_add_u32 s36, s35, 5308416
ds_read_b128 v[124:127], v1 offset:2560
v_add_f32 v22, v22, v24
v_mfma_f32_16x16x32_bf16 a[92:95], v[48:51], v[216:219], a[92:95]
s_add_u32 m0, s30, 20480
v_add_f32 v23, v23, v25
v_cvt_pk_bf16_f32 v142, v22, v26
v_mfma_f32_16x16x32_bf16 a[88:91], v[44:47], v[216:219], a[88:91]
s_waitcnt lgkmcnt(2)
v_perm_b32 v143, v27, v23, s20
v_lshlrev_b64 v[16:17], 16, v[160:161]
v_mfma_f32_16x16x32_bf16 a[96:99], v[44:47], v[220:223], a[96:99]
buffer_load_dwordx4 v5, s[8:11], s36 offen offset:0 lds
v_mfma_f32_16x16x32_bf16 a[100:103], v[48:51], v[220:223], a[100:103]
v_lshlrev_b64 v[18:19], 16, v[144:145]
v_add_f32 v20, v160, v144
v_mfma_f32_16x16x32_bf16 a[108:111], v[48:51], v[228:231], a[108:111]
v_add_f32 v21, v161, v145
v_add_f32 v16, v16, v18
v_mfma_f32_16x16x32_bf16 a[104:107], v[44:47], v[228:231], a[104:107]
v_add_f32 v17, v17, v19
v_perm_b32 v172, v20, v16, s20
v_mfma_f32_16x16x32_bf16 a[112:115], v[44:47], v[120:123], a[112:115]
v_perm_b32 v173, v21, v17, s20
v_lshlrev_b64 v[22:23], 16, v[162:163]
v_mfma_f32_16x16x32_bf16 a[116:119], v[48:51], v[120:123], a[116:119]
v_lshlrev_b64 v[24:25], 16, v[146:147]
v_add_f32 v26, v162, v146
v_mfma_f32_16x16x32_bf16 a[124:127], v[48:51], v[104:107], a[124:127]
buffer_load_dwordx4 v6, s[8:11], s36 offen offset:1024 lds
v_mfma_f32_16x16x32_bf16 a[120:123], v[44:47], v[104:107], a[120:123]
v_add_f32 v27, v163, v147
v_add_f32 v22, v22, v24
v_mfma_f32_16x16x32_bf16 a[128:131], v[60:63], v[96:99], a[128:131]
ds_read_b128 v[112:115], v1 offset:2816
v_add_f32 v23, v23, v25
v_mfma_f32_16x16x32_bf16 a[132:135], v[64:67], v[96:99], a[132:135]
ds_read_b128 v[92:95], v1 offset:3072
v_cvt_pk_bf16_f32 v174, v22, v26
v_mfma_f32_16x16x32_bf16 a[140:143], v[64:67], v[224:227], a[140:143]
v_perm_b32 v175, v27, v23, s20
v_mov_b32_dpp v192, v96 row_shl:1 row_mask:0xf bank_mask:0xf bound_ctrl:0
v_mfma_f32_16x16x32_bf16 a[136:139], v[60:63], v[224:227], a[136:139]
v_mov_b32_dpp v193, v97 row_shl:1 row_mask:0xf bank_mask:0xf bound_ctrl:0
v_mov_b32_dpp v194, v98 row_shl:1 row_mask:0xf bank_mask:0xf bound_ctrl:0
v_mfma_f32_16x16x32_bf16 a[144:147], v[60:63], v[200:203], a[144:147]
s_waitcnt lgkmcnt(2)
v_mov_b32_dpp v195, v99 row_shl:1 row_mask:0xf bank_mask:0xf bound_ctrl:0
v_lshlrev_b64 v[16:17], 16, v[132:133]
v_mfma_f32_16x16x32_bf16 a[148:151], v[64:67], v[200:203], a[148:151]
v_lshlrev_b64 v[18:19], 16, v[124:125]
v_add_f32 v20, v132, v124
v_mfma_f32_16x16x32_bf16 a[156:159], v[64:67], v[204:207], a[156:159]
v_add_f32 v21, v133, v125
v_add_f32 v16, v16, v18
v_mfma_f32_16x16x32_bf16 a[152:155], v[60:63], v[204:207], a[152:155]
v_add_f32 v17, v17, v19
v_perm_b32 v120, v20, v16, s20
v_mfma_f32_16x16x32_bf16 a[160:163], v[60:63], v[136:139], a[160:163]
v_perm_b32 v121, v21, v17, s20
v_lshlrev_b64 v[22:23], 16, v[134:135]
v_mfma_f32_16x16x32_bf16 a[164:167], v[64:67], v[136:139], a[164:167]
v_lshlrev_b64 v[24:25], 16, v[126:127]
v_add_f32 v26, v134, v126
v_mfma_f32_16x16x32_bf16 a[172:175], v[64:67], v[168:171], a[172:175]
v_add_f32 v27, v135, v127
v_add_f32 v22, v22, v24
v_mfma_f32_16x16x32_bf16 a[168:171], v[60:63], v[168:171], a[168:171]
v_add_f32 v23, v23, v25
v_cvt_pk_bf16_f32 v122, v22, v26
v_mfma_f32_16x16x32_bf16 a[176:179], v[60:63], v[176:179], a[176:179]
s_waitcnt lgkmcnt(0)
v_perm_b32 v123, v27, v23, s20
v_lshlrev_b64 v[16:17], 16, v[112:113]
v_mfma_f32_16x16x32_bf16 a[180:183], v[64:67], v[176:179], a[180:183]
v_lshlrev_b64 v[18:19], 16, v[92:93]
v_add_f32 v20, v112, v92
v_mfma_f32_16x16x32_bf16 a[188:191], v[64:67], v[188:191], a[188:191]
v_add_f32 v21, v113, v93
v_add_f32 v16, v16, v18
v_mfma_f32_16x16x32_bf16 a[184:187], v[60:63], v[188:191], a[184:187]
v_add_f32 v17, v17, v19
v_perm_b32 v104, v20, v16, s20
v_mfma_f32_16x16x32_bf16 a[0:3], v[36:39], v[76:79], a[0:3]
s_waitcnt vmcnt(9)
v_perm_b32 v105, v21, v17, s20
v_lshlrev_b64 v[22:23], 16, v[114:115]
v_mfma_f32_16x16x32_bf16 a[4:7], v[40:43], v[76:79], a[4:7]
s_barrier
ds_read_b64_tr_b16 v[28:29], v3 offset:0
v_mfma_f32_16x16x32_bf16 a[12:15], v[40:43], v[84:87], a[12:15]
ds_read_b64_tr_b16 v[30:31], v3 offset:512
v_lshlrev_b64 v[24:25], 16, v[94:95]
v_mfma_f32_16x16x32_bf16 a[8:11], v[36:39], v[84:87], a[8:11]
ds_read_b64_tr_b16 v[32:33], v4 offset:0
v_add_f32 v26, v114, v94
v_mfma_f32_16x16x32_bf16 a[16:19], v[36:39], v[196:199], a[16:19]
ds_read_b64_tr_b16 v[34:35], v4 offset:512
v_add_f32 v27, v115, v95
v_mfma_f32_16x16x32_bf16 a[20:23], v[40:43], v[196:199], a[20:23]
ds_read_b64_tr_b16 v[44:45], v3 offset:4096
v_add_f32 v22, v22, v24
v_mfma_f32_16x16x32_bf16 a[28:31], v[40:43], v[208:211], a[28:31]
ds_read_b64_tr_b16 v[46:47], v3 offset:4608
v_add_f32 v23, v23, v25
v_mfma_f32_16x16x32_bf16 a[24:27], v[36:39], v[208:211], a[24:27]
ds_read_b64_tr_b16 v[48:49], v4 offset:4096
v_cvt_pk_bf16_f32 v106, v22, v26
v_mfma_f32_16x16x32_bf16 a[32:35], v[36:39], v[212:215], a[32:35]
ds_read_b64_tr_b16 v[50:51], v4 offset:4608
v_perm_b32 v107, v27, v23, s20
v_mfma_f32_16x16x32_bf16 a[36:39], v[40:43], v[212:215], a[36:39]
ds_read_b128 v[80:83], v1 offset:3328
v_mfma_f32_16x16x32_bf16 a[44:47], v[40:43], v[152:155], a[44:47]
s_add_u32 s36, s35, 6356992
ds_read_b128 v[88:91], v1 offset:3584
v_mfma_f32_16x16x32_bf16 a[40:43], v[36:39], v[152:155], a[40:43]
s_add_u32 m0, s30, 24576
v_mfma_f32_16x16x32_bf16 a[48:51], v[36:39], v[232:235], a[48:51]
buffer_load_dwordx4 v5, s[8:11], s36 offen offset:0 lds
v_mfma_f32_16x16x32_bf16 a[52:55], v[40:43], v[232:235], a[52:55]
s_add_u32 s101, s3, 1024
v_mfma_f32_16x16x32_bf16 a[60:63], v[40:43], v[236:239], a[60:63]
s_add_u32 m0, s41, 36864
v_mfma_f32_16x16x32_bf16 a[56:59], v[36:39], v[236:239], a[56:59]
buffer_load_dwordx4 v9, s[4:7], s101 offen lds
v_mfma_f32_16x16x32_bf16 a[128:131], v[36:39], v[224:227], a[128:131]
v_mfma_f32_16x16x32_bf16 a[132:135], v[40:43], v[224:227], a[132:135]
s_add_u32 m0, s30, 24576
v_mfma_f32_16x16x32_bf16 a[140:143], v[40:43], v[200:203], a[140:143]
s_add_u32 s101, s3, 9216
buffer_load_dwordx4 v6, s[8:11], s36 offen offset:1024 lds
v_mfma_f32_16x16x32_bf16 a[136:139], v[36:39], v[200:203], a[136:139]
s_waitcnt lgkmcnt(0)
v_lshlrev_b64 v[16:17], 16, v[80:81]
v_lshlrev_b64 v[18:19], 16, v[88:89]
v_mfma_f32_16x16x32_bf16 a[144:147], v[36:39], v[204:207], a[144:147]
s_add_u32 m0, s41, 37888
ds_read_b128 v[100:103], v1 offset:3840
v_add_f32 v20, v80, v88
v_mfma_f32_16x16x32_bf16 a[148:151], v[40:43], v[204:207], a[148:151]
buffer_load_dwordx4 v9, s[4:7], s101 offen lds
v_mfma_f32_16x16x32_bf16 a[156:159], v[40:43], v[136:139], a[156:159]
s_add_u32 s36, s35, 7405568
ds_read_b128 v[224:227], v2 offset:0
v_add_f32 v21, v81, v89
v_mfma_f32_16x16x32_bf16 a[152:155], v[36:39], v[136:139], a[152:155]
s_add_u32 m0, s30, 28672
v_add_f32 v16, v16, v18
v_add_f32 v17, v17, v19
v_mfma_f32_16x16x32_bf16 a[160:163], v[36:39], v[168:171], a[160:163]
buffer_load_dwordx4 v5, s[8:11], s36 offen offset:0 lds
v_mfma_f32_16x16x32_bf16 a[164:167], v[40:43], v[168:171], a[164:167]
v_perm_b32 v152, v20, v16, s20
v_perm_b32 v153, v21, v17, s20
v_mfma_f32_16x16x32_bf16 a[172:175], v[40:43], v[176:179], a[172:175]
v_lshlrev_b64 v[22:23], 16, v[82:83]
v_lshlrev_b64 v[24:25], 16, v[90:91]
v_mfma_f32_16x16x32_bf16 a[168:171], v[36:39], v[176:179], a[168:171]
v_add_f32 v26, v82, v90
v_add_f32 v27, v83, v91
v_mfma_f32_16x16x32_bf16 a[176:179], v[36:39], v[188:191], a[176:179]
v_add_f32 v22, v22, v24
v_add_f32 v23, v23, v25
v_mfma_f32_16x16x32_bf16 a[180:183], v[40:43], v[188:191], a[180:183]
v_cvt_pk_bf16_f32 v154, v22, v26
v_perm_b32 v155, v27, v23, s20
v_mfma_f32_16x16x32_bf16 a[188:191], v[40:43], v[192:195], a[188:191]
buffer_load_dwordx4 v6, s[8:11], s36 offen offset:1024 lds
v_mfma_f32_16x16x32_bf16 a[184:187], v[36:39], v[192:195], a[184:187]
s_add_u32 s35, s35, 65536
s_cmp_eq_u32 s37, 0
s_cbranch_scc1 L_sw
L_loop:
v_mfma_f32_16x16x32_bf16 a[0:3], v[28:31], a[204:207], a[0:3]
s_waitcnt vmcnt(10)
v_lshlrev_b64 v[16:17], 16, v[28:29]
v_lshlrev_b64 v[18:19], 16, v[44:45]
v_mfma_f32_16x16x32_bf16 a[4:7], v[32:35], a[204:207], a[4:7]
s_barrier
ds_read_b64_tr_b16 v[36:37], v3 offset:8192
v_mfma_f32_16x16x32_bf16 a[12:15], v[32:35], v[108:111], a[12:15]
ds_read_b64_tr_b16 v[38:39], v3 offset:8704
v_add_f32 v20, v28, v44
v_mfma_f32_16x16x32_bf16 a[8:11], v[28:31], v[108:111], a[8:11]
ds_read_b64_tr_b16 v[40:41], v4 offset:8192
v_add_f32 v21, v29, v45
v_mfma_f32_16x16x32_bf16 a[16:19], v[28:31], v[164:167], a[16:19]
ds_read_b64_tr_b16 v[42:43], v4 offset:8704
v_add_f32 v16, v16, v18
v_mfma_f32_16x16x32_bf16 a[20:23], v[32:35], v[164:167], a[20:23]
ds_read_b64_tr_b16 v[52:53], v3 offset:12288
v_add_f32 v17, v17, v19
v_mfma_f32_16x16x32_bf16 a[28:31], v[32:35], v[148:151], a[28:31]
ds_read_b64_tr_b16 v[54:55], v3 offset:12800
v_perm_b32 v60, v20, v16, s20
v_mfma_f32_16x16x32_bf16 a[24:27], v[28:31], v[148:151], a[24:27]
ds_read_b64_tr_b16 v[56:57], v4 offset:12288
v_perm_b32 v61, v21, v17, s20
v_mfma_f32_16x16x32_bf16 a[32:35], v[28:31], v[144:147], a[32:35]
ds_read_b64_tr_b16 v[58:59], v4 offset:12800
v_lshlrev_b64 v[22:23], 16, v[30:31]
v_mfma_f32_16x16x32_bf16 a[36:39], v[32:35], v[144:147], a[36:39]
v_lshlrev_b64 v[24:25], 16, v[46:47]
v_add_f32 v26, v30, v46
v_mfma_f32_16x16x32_bf16 a[44:47], v[32:35], v[124:127], a[44:47]
s_add_u32 s36, s35, 8388608
ds_read_b128 v[212:215], v2 offset:256
v_add_f32 v27, v31, v47
v_mfma_f32_16x16x32_bf16 a[40:43], v[28:31], v[124:127], a[40:43]
s_add_u32 m0, s30, 0
ds_read_b128 v[228:231], v2 offset:512
v_add_f32 v22, v22, v24
v_mfma_f32_16x16x32_bf16 a[48:51], v[28:31], v[92:95], a[48:51]
buffer_load_dwordx4 v5, s[8:11], s36 offen offset:0 lds
v_mfma_f32_16x16x32_bf16 a[52:55], v[32:35], v[92:95], a[52:55]
v_add_f32 v23, v23, v25
v_cvt_pk_bf16_f32 v62, v22, v26
v_mfma_f32_16x16x32_bf16 a[60:63], v[32:35], v[88:91], a[60:63]
v_perm_b32 v63, v27, v23, s20
v_lshlrev_b64 v[16:17], 16, v[32:33]
v_mfma_f32_16x16x32_bf16 a[56:59], v[28:31], v[88:91], a[56:59]
v_lshlrev_b64 v[18:19], 16, v[48:49]
v_add_f32 v20, v32, v48
v_mfma_f32_16x16x32_bf16 a[64:67], v[44:47], v[128:131], a[64:67]
v_add_f32 v21, v33, v49
v_add_f32 v16, v16, v18
v_mfma_f32_16x16x32_bf16 a[68:71], v[48:51], v[128:131], a[68:71]
v_add_f32 v17, v17, v19
v_perm_b32 v64, v20, v16, s20
v_mfma_f32_16x16x32_bf16 a[76:79], v[48:51], v[184:187], a[76:79]
buffer_load_dwordx4 v6, s[8:11], s36 offen offset:1024 lds
v_mfma_f32_16x16x32_bf16 a[72:75], v[44:47], v[184:187], a[72:75]
v_perm_b32 v65, v21, v17, s20
v_lshlrev_b64 v[22:23], 16, v[34:35]
v_mfma_f32_16x16x32_bf16 a[80:83], v[44:47], v[116:119], a[80:83]
v_lshlrev_b64 v[24:25], 16, v[50:51]
v_add_f32 v26, v34, v50
v_mfma_f32_16x16x32_bf16 a[84:87], v[48:51], v[116:119], a[84:87]
s_add_u32 s36, s35, 9437184
v_add_f32 v27, v35, v51
v_add_f32 v22, v22, v24
v_mfma_f32_16x16x32_bf16 a[92:95], v[48:51], v[160:163], a[92:95]
s_add_u32 m0, s30, 4096
v_add_f32 v23, v23, v25
v_cvt_pk_bf16_f32 v66, v22, v26
v_mfma_f32_16x16x32_bf16 a[88:91], v[44:47], v[160:163], a[88:91]
s_waitcnt lgkmcnt(10)
v_perm_b32 v67, v27, v23, s20
v_lshlrev_b64 v[16:17], 16, v[100:101]
v_mfma_f32_16x16x32_bf16 a[96:99], v[44:47], v[132:135], a[96:99]
buffer_load_dwordx4 v5, s[8:11], s36 offen offset:0 lds
v_mfma_f32_16x16x32_bf16 a[100:103], v[48:51], v[132:135], a[100:103]
v_lshlrev_b64 v[18:19], 16, v[224:225]
v_add_f32 v20, v100, v224
v_mfma_f32_16x16x32_bf16 a[108:111], v[48:51], v[112:115], a[108:111]
v_add_f32 v21, v101, v225
v_add_f32 v16, v16, v18
v_mfma_f32_16x16x32_bf16 a[104:107], v[44:47], v[112:115], a[104:107]
v_add_f32 v17, v17, v19
v_perm_b32 v96, v20, v16, s20
v_mfma_f32_16x16x32_bf16 a[112:115], v[44:47], v[80:83], a[112:115]
v_perm_b32 v97, v21, v17, s20
v_lshlrev_b64 v[22:23], 16, v[102:103]
v_mfma_f32_16x16x32_bf16 a[116:119], v[48:51], v[80:83], a[116:119]
v_lshlrev_b64 v[24:25], 16, v[226:227]
v_add_f32 v26, v102, v226
v_mfma_f32_16x16x32_bf16 a[124:127], v[48:51], v[100:103], a[124:127]
buffer_load_dwordx4 v6, s[8:11], s36 offen offset:1024 lds
v_mfma_f32_16x16x32_bf16 a[120:123], v[44:47], v[100:103], a[120:123]
v_add_f32 v27, v103, v227
v_add_f32 v22, v22, v24
v_mfma_f32_16x16x32_bf16 a[128:131], v[60:63], v[156:159], a[128:131]
s_add_u32 s2, s35, s22
v_add_f32 v23, v23, v25
v_cvt_pk_bf16_f32 v98, v22, v26
v_mfma_f32_16x16x32_bf16 a[132:135], v[64:67], v[156:159], a[132:135]
s_waitcnt lgkmcnt(4)
v_perm_b32 v99, v27, v23, s20
v_lshlrev_b64 v[16:17], 16, v[36:37]
v_mfma_f32_16x16x32_bf16 a[140:143], v[64:67], v[180:183], a[140:143]
s_add_u32 s101, s3, 17408
buffer_load_dword a192, v11, s[8:11], s2 offen
v_mfma_f32_16x16x32_bf16 a[136:139], v[60:63], v[180:183], a[136:139]
s_add_u32 m0, s41, 38912
v_lshlrev_b64 v[18:19], 16, v[52:53]
v_add_f32 v20, v36, v52
v_mfma_f32_16x16x32_bf16 a[144:147], v[60:63], v[140:143], a[144:147]
buffer_load_dwordx4 v9, s[4:7], s101 offen lds
v_mfma_f32_16x16x32_bf16 a[148:151], v[64:67], v[140:143], a[148:151]
v_add_f32 v21, v37, v53
v_add_f32 v16, v16, v18
v_mfma_f32_16x16x32_bf16 a[156:159], v[64:67], v[172:175], a[156:159]
ds_read_b128 v[84:87], v2 offset:768
v_add_f32 v17, v17, v19
v_mfma_f32_16x16x32_bf16 a[152:155], v[60:63], v[172:175], a[152:155]
ds_read_b128 v[232:235], v2 offset:1024
v_perm_b32 v68, v20, v16, s20
v_mfma_f32_16x16x32_bf16 a[160:163], v[60:63], v[120:123], a[160:163]
s_add_u32 s101, s3, 25600
v_perm_b32 v69, v21, v17, s20
v_lshlrev_b64 v[22:23], 16, v[38:39]
v_mfma_f32_16x16x32_bf16 a[164:167], v[64:67], v[120:123], a[164:167]
s_add_u32 m0, s41, 39936
v_lshlrev_b64 v[24:25], 16, v[54:55]
v_add_f32 v26, v38, v54
v_mfma_f32_16x16x32_bf16 a[172:175], v[64:67], v[104:107], a[172:175]
buffer_load_dwordx4 v9, s[4:7], s101 offen lds
v_mfma_f32_16x16x32_bf16 a[168:171], v[60:63], v[104:107], a[168:171]
v_add_f32 v27, v39, v55
v_add_f32 v22, v22, v24
v_mfma_f32_16x16x32_bf16 a[176:179], v[60:63], v[152:155], a[176:179]
v_add_f32 v23, v23, v25
v_cvt_pk_bf16_f32 v70, v22, v26
v_mfma_f32_16x16x32_bf16 a[180:183], v[64:67], v[152:155], a[180:183]
s_waitcnt lgkmcnt(4)
v_perm_b32 v71, v27, v23, s20
v_lshlrev_b64 v[16:17], 16, v[40:41]
v_mfma_f32_16x16x32_bf16 a[188:191], v[64:67], v[96:99], a[188:191]
v_lshlrev_b64 v[18:19], 16, v[56:57]
v_add_f32 v20, v40, v56
v_mfma_f32_16x16x32_bf16 a[184:187], v[60:63], v[96:99], a[184:187]
v_add_f32 v21, v41, v57
v_add_f32 v16, v16, v18
v_mfma_f32_16x16x32_bf16 a[0:3], v[36:39], v[108:111], a[0:3]
s_waitcnt vmcnt(13)
v_add_f32 v17, v17, v19
v_perm_b32 v72, v20, v16, s20
v_mfma_f32_16x16x32_bf16 a[4:7], v[40:43], v[108:111], a[4:7]
s_barrier
ds_read_b64_tr_b16 v[28:29], v3 offset:16384
v_mfma_f32_16x16x32_bf16 a[12:15], v[40:43], v[164:167], a[12:15]
ds_read_b64_tr_b16 v[30:31], v3 offset:16896
v_perm_b32 v73, v21, v17, s20
v_mfma_f32_16x16x32_bf16 a[8:11], v[36:39], v[164:167], a[8:11]
ds_read_b64_tr_b16 v[32:33], v4 offset:16384
v_lshlrev_b64 v[22:23], 16, v[42:43]
v_mfma_f32_16x16x32_bf16 a[16:19], v[36:39], v[148:151], a[16:19]
ds_read_b64_tr_b16 v[34:35], v4 offset:16896
v_lshlrev_b64 v[24:25], 16, v[58:59]
v_mfma_f32_16x16x32_bf16 a[20:23], v[40:43], v[148:151], a[20:23]
ds_read_b64_tr_b16 v[44:45], v3 offset:20480
v_add_f32 v26, v42, v58
v_mfma_f32_16x16x32_bf16 a[28:31], v[40:43], v[144:147], a[28:31]
ds_read_b64_tr_b16 v[46:47], v3 offset:20992
v_add_f32 v27, v43, v59
v_mfma_f32_16x16x32_bf16 a[24:27], v[36:39], v[144:147], a[24:27]
ds_read_b64_tr_b16 v[48:49], v4 offset:20480
v_add_f32 v22, v22, v24
v_mfma_f32_16x16x32_bf16 a[32:35], v[36:39], v[124:127], a[32:35]
L_pad4:
s_cbranch_execz L_pad8
ds_read_b64_tr_b16 v[50:51], v4 offset:20992
v_add_f32 v23, v23, v25
v_mfma_f32_16x16x32_bf16 a[36:39], v[40:43], v[124:127], a[36:39]
s_add_u32 s36, s35, 10485760
v_cvt_pk_bf16_f32 v74, v22, v26
v_perm_b32 v75, v27, v23, s20
v_mfma_f32_16x16x32_bf16 a[44:47], v[40:43], v[92:95], a[44:47]
s_waitcnt lgkmcnt(10)
ds_read_b128 v[156:159], v2 offset:1280
v_lshlrev_b64 v[16:17], 16, v[212:213]
v_mfma_f32_16x16x32_bf16 a[40:43], v[36:39], v[92:95], a[40:43]
s_add_u32 m0, s30, 8192
ds_read_b128 v[76:79], v2 offset:1536
v_lshlrev_b64 v[18:19], 16, v[228:229]
v_mfma_f32_16x16x32_bf16 a[48:51], v[36:39], v[88:91], a[48:51]
buffer_load_dwordx4 v5, s[8:11], s36 offen offset:0 lds
v_mfma_f32_16x16x32_bf16 a[52:55], v[40:43], v[88:91], a[52:55]
v_add_f32 v20, v212, v228
v_add_f32 v21, v213, v229
v_mfma_f32_16x16x32_bf16 a[60:63], v[40:43], v[224:227], a[60:63]
v_add_f32 v16, v16, v18
v_add_f32 v17, v17, v19
v_mfma_f32_16x16x32_bf16 a[56:59], v[36:39], v[224:227], a[56:59]
v_perm_b32 v108, v20, v16, s20
v_perm_b32 v109, v21, v17, s20
v_mfma_f32_16x16x32_bf16 a[64:67], v[52:55], v[184:187], a[64:67]
v_lshlrev_b64 v[22:23], 16, v[214:215]
v_lshlrev_b64 v[24:25], 16, v[230:231]
v_mfma_f32_16x16x32_bf16 a[68:71], v[56:59], v[184:187], a[68:71]
v_add_f32 v26, v214, v230
v_add_f32 v27, v215, v231
v_mfma_f32_16x16x32_bf16 a[76:79], v[56:59], v[116:119], a[76:79]
buffer_load_dwordx4 v6, s[8:11], s36 offen offset:1024 lds
v_mfma_f32_16x16x32_bf16 a[72:75], v[52:55], v[116:119], a[72:75]
v_add_f32 v22, v22, v24
v_add_f32 v23, v23, v25
v_mfma_f32_16x16x32_bf16 a[80:83], v[52:55], v[160:163], a[80:83]
v_cvt_pk_bf16_f32 v110, v22, v26
v_perm_b32 v111, v27, v23, s20
v_mfma_f32_16x16x32_bf16 a[84:87], v[56:59], v[160:163], a[84:87]
s_waitcnt lgkmcnt(4)
v_lshlrev_b64 v[16:17], 16, v[28:29]
v_lshlrev_b64 v[18:19], 16, v[44:45]
v_mfma_f32_16x16x32_bf16 a[92:95], v[56:59], v[132:135], a[92:95]
s_add_u32 s36, s35, 11534336
v_add_f32 v20, v28, v44
v_add_f32 v21, v29, v45
v_mfma_f32_16x16x32_bf16 a[88:91], v[52:55], v[132:135], a[88:91]
s_add_u32 m0, s30, 12288
v_add_f32 v16, v16, v18
v_add_f32 v17, v17, v19
v_mfma_f32_16x16x32_bf16 a[96:99], v[52:55], v[112:115], a[96:99]
buffer_load_dwordx4 v5, s[8:11], s36 offen offset:0 lds
v_mfma_f32_16x16x32_bf16 a[100:103], v[56:59], v[112:115], a[100:103]
v_perm_b32 v60, v20, v16, s20
v_perm_b32 v61, v21, v17, s20
v_mfma_f32_16x16x32_bf16 a[108:111], v[56:59], v[80:83], a[108:111]
v_lshlrev_b64 v[22:23], 16, v[30:31]
v_lshlrev_b64 v[24:25], 16, v[46:47]
v_mfma_f32_16x16x32_bf16 a[104:107], v[52:55], v[80:83], a[104:107]
v_add_f32 v26, v30, v46
v_add_f32 v27, v31, v47
v_mfma_f32_16x16x32_bf16 a[112:115], v[52:55], v[100:103], a[112:115]
v_add_f32 v22, v22, v24
v_add_f32 v23, v23, v25
v_mfma_f32_16x16x32_bf16 a[116:119], v[56:59], v[100:103], a[116:119]
v_cvt_pk_bf16_f32 v62, v22, v26
v_perm_b32 v63, v27, v23, s20
v_mfma_f32_16x16x32_bf16 a[124:127], v[56:59], v[212:215], a[124:127]
buffer_load_dwordx4 v6, s[8:11], s36 offen offset:1024 lds
v_mfma_f32_16x16x32_bf16 a[120:123], v[52:55], v[212:215], a[120:123]
s_waitcnt lgkmcnt(2)
v_lshlrev_b64 v[16:17], 16, v[32:33]
v_lshlrev_b64 v[18:19], 16, v[48:49]
v_mfma_f32_16x16x32_bf16 a[128:131], v[68:71], v[180:183], a[128:131]
v_add_f32 v20, v32, v48
v_add_f32 v21, v33, v49
v_mfma_f32_16x16x32_bf16 a[132:135], v[72:75], v[180:183], a[132:135]
v_add_f32 v16, v16, v18
v_add_f32 v17, v17, v19
v_mfma_f32_16x16x32_bf16 a[140:143], v[72:75], v[140:143], a[140:143]
s_add_u32 s101, s3, 263168
v_perm_b32 v64, v20, v16, s20
v_perm_b32 v65, v21, v17, s20
v_mfma_f32_16x16x32_bf16 a[136:139], v[68:71], v[140:143], a[136:139]
s_add_u32 m0, s41, 53248
v_lshlrev_b64 v[22:23], 16, v[34:35]
v_lshlrev_b64 v[24:25], 16, v[50:51]
v_mfma_f32_16x16x32_bf16 a[144:147], v[68:71], v[172:175], a[144:147]
buffer_load_dwordx4 v9, s[4:7], s101 offen lds
v_mfma_f32_16x16x32_bf16 a[148:151], v[72:75], v[172:175], a[148:151]
v_add_f32 v26, v34, v50
v_add_f32 v27, v35, v51
v_mfma_f32_16x16x32_bf16 a[156:159], v[72:75], v[120:123], a[156:159]
ds_read_b128 v[208:211], v2 offset:1792
v_add_f32 v22, v22, v24
v_mfma_f32_16x16x32_bf16 a[152:155], v[68:71], v[120:123], a[152:155]
v_add_f32 v23, v23, v25
v_cvt_pk_bf16_f32 v66, v22, v26
v_mfma_f32_16x16x32_bf16 a[160:163], v[68:71], v[104:107], a[160:163]
s_add_u32 s101, s3, 271360
v_perm_b32 v67, v27, v23, s20
v_lshlrev_b64 v[16:17], 16, v[84:85]
v_mfma_f32_16x16x32_bf16 a[164:167], v[72:75], v[104:107], a[164:167]
s_add_u32 m0, s41, 54272
v_lshlrev_b64 v[18:19], 16, v[232:233]
v_add_f32 v20, v84, v232
v_mfma_f32_16x16x32_bf16 a[172:175], v[72:75], v[152:155], a[172:175]
buffer_load_dwordx4 v9, s[4:7], s101 offen lds
v_mfma_f32_16x16x32_bf16 a[168:171], v[68:71], v[152:155], a[168:171]
v_add_f32 v21, v85, v233
v_add_f32 v16, v16, v18
v_mfma_f32_16x16x32_bf16 a[176:179], v[68:71], v[96:99], a[176:179]
v_add_f32 v17, v17, v19
v_perm_b32 v128, v20, v16, s20
v_mfma_f32_16x16x32_bf16 a[180:183], v[72:75], v[96:99], a[180:183]
v_perm_b32 v129, v21, v17, s20
v_lshlrev_b64 v[22:23], 16, v[86:87]
v_mfma_f32_16x16x32_bf16 a[188:191], v[72:75], v[108:111], a[188:191]
v_lshlrev_b64 v[24:25], 16, v[234:235]
v_add_f32 v26, v86, v234
v_mfma_f32_16x16x32_bf16 a[184:187], v[68:71], v[108:111], a[184:187]
v_add_f32 v27, v87, v235
v_add_f32 v22, v22, v24
v_mfma_f32_16x16x32_bf16 a[0:3], v[28:31], v[164:167], a[0:3]
s_waitcnt vmcnt(13)
v_add_f32 v23, v23, v25
v_cvt_pk_bf16_f32 v130, v22, v26
v_mfma_f32_16x16x32_bf16 a[4:7], v[32:35], v[164:167], a[4:7]
s_barrier
ds_read_b64_tr_b16 v[36:37], v3 offset:24576
v_mfma_f32_16x16x32_bf16 a[12:15], v[32:35], v[148:151], a[12:15]
ds_read_b64_tr_b16 v[38:39], v3 offset:25088
v_perm_b32 v131, v27, v23, s20
v_mfma_f32_16x16x32_bf16 a[8:11], v[28:31], v[148:151], a[8:11]
s_waitcnt lgkmcnt(3)
ds_read_b64_tr_b16 v[40:41], v4 offset:24576
v_lshlrev_b64 v[16:17], 16, v[156:157]
v_mfma_f32_16x16x32_bf16 a[16:19], v[28:31], v[144:147], a[16:19]
ds_read_b64_tr_b16 v[42:43], v4 offset:25088
v_lshlrev_b64 v[18:19], 16, v[76:77]
v_mfma_f32_16x16x32_bf16 a[20:23], v[32:35], v[144:147], a[20:23]
ds_read_b64_tr_b16 v[52:53], v3 offset:28672
v_add_f32 v20, v156, v76
v_mfma_f32_16x16x32_bf16 a[28:31], v[32:35], v[124:127], a[28:31]
ds_read_b64_tr_b16 v[54:55], v3 offset:29184
v_add_f32 v21, v157, v77
v_mfma_f32_16x16x32_bf16 a[24:27], v[28:31], v[124:127], a[24:27]
ds_read_b64_tr_b16 v[56:57], v4 offset:28672
v_add_f32 v16, v16, v18
v_mfma_f32_16x16x32_bf16 a[32:35], v[28:31], v[92:95], a[32:35]
ds_read_b64_tr_b16 v[58:59], v4 offset:29184
v_add_f32 v17, v17, v19
v_mfma_f32_16x16x32_bf16 a[36:39], v[32:35], v[92:95], a[36:39]
v_perm_b32 v136, v20, v16, s20
v_perm_b32 v137, v21, v17, s20
v_mfma_f32_16x16x32_bf16 a[44:47], v[32:35], v[88:91], a[44:47]
s_add_u32 s36, s35, 12582912
v_lshlrev_b64 v[22:23], 16, v[158:159]
v_lshlrev_b64 v[24:25], 16, v[78:79]
v_mfma_f32_16x16x32_bf16 a[40:43], v[28:31], v[88:91], a[40:43]
s_add_u32 m0, s30, 16384
v_add_f32 v26, v158, v78
v_add_f32 v27, v159, v79
v_mfma_f32_16x16x32_bf16 a[48:51], v[28:31], v[224:227], a[48:51]
buffer_load_dwordx4 v5, s[8:11], s36 offen offset:0 lds
v_mfma_f32_16x16x32_bf16 a[52:55], v[32:35], v[224:227], a[52:55]
v_add_f32 v22, v22, v24
v_add_f32 v23, v23, v25
v_mfma_f32_16x16x32_bf16 a[60:63], v[32:35], v[228:231], a[60:63]
v_cvt_pk_bf16_f32 v138, v22, v26
v_perm_b32 v139, v27, v23, s20
v_mfma_f32_16x16x32_bf16 a[56:59], v[28:31], v[228:231], a[56:59]
s_waitcnt lgkmcnt(2)
v_lshlrev_b64 v[16:17], 16, v[36:37]
v_lshlrev_b64 v[18:19], 16, v[52:53]
v_mfma_f32_16x16x32_bf16 a[64:67], v[44:47], v[116:119], a[64:67]
v_add_f32 v20, v36, v52
v_add_f32 v21, v37, v53
v_mfma_f32_16x16x32_bf16 a[68:71], v[48:51], v[116:119], a[68:71]
v_add_f32 v16, v16, v18
v_add_f32 v17, v17, v19
v_mfma_f32_16x16x32_bf16 a[76:79], v[48:51], v[160:163], a[76:79]
buffer_load_dwordx4 v6, s[8:11], s36 offen offset:1024 lds
v_mfma_f32_16x16x32_bf16 a[72:75], v[44:47], v[160:163], a[72:75]
v_perm_b32 v68, v20, v16, s20
v_perm_b32 v69, v21, v17, s20
v_mfma_f32_16x16x32_bf16 a[80:83], v[44:47], v[132:135], a[80:83]
v_lshlrev_b64 v[22:23], 16, v[38:39]
v_lshlrev_b64 v[24:25], 16, v[54:55]
v_mfma_f32_16x16x32_bf16 a[84:87], v[48:51], v[132:135], a[84:87]
v_add_f32 v26, v38, v54
v_add_f32 v27, v39, v55
v_mfma_f32_16x16x32_bf16 a[92:95], v[48:51], v[112:115], a[92:95]
s_add_u32 s36, s35, 13631488
v_add_f32 v22, v22, v24
v_add_f32 v23, v23, v25
v_mfma_f32_16x16x32_bf16 a[88:91], v[44:47], v[112:115], a[88:91]
s_add_u32 m0, s30, 20480
v_cvt_pk_bf16_f32 v70, v22, v26
v_perm_b32 v71, v27, v23, s20
v_mfma_f32_16x16x32_bf16 a[96:99], v[44:47], v[80:83], a[96:99]
buffer_load_dwordx4 v5, s[8:11], s36 offen offset:0 lds
v_mfma_f32_16x16x32_bf16 a[100:103], v[48:51], v[80:83], a[100:103]
s_waitcnt lgkmcnt(0)
v_lshlrev_b64 v[16:17], 16, v[40:41]
v_lshlrev_b64 v[18:19], 16, v[56:57]
v_mfma_f32_16x16x32_bf16 a[108:111], v[48:51], v[100:103], a[108:111]
v_add_f32 v20, v40, v56
v_add_f32 v21, v41, v57
v_mfma_f32_16x16x32_bf16 a[104:107], v[44:47], v[100:103], a[104:107]
v_add_f32 v16, v16, v18
v_add_f32 v17, v17, v19
v_mfma_f32_16x16x32_bf16 a[112:115], v[44:47], v[212:215], a[112:115]
v_perm_b32 v72, v20, v16, s20
v_perm_b32 v73, v21, v17, s20
v_mfma_f32_16x16x32_bf16 a[116:119], v[48:51], v[212:215], a[116:119]
v_lshlrev_b64 v[22:23], 16, v[42:43]
v_lshlrev_b64 v[24:25], 16, v[58:59]
v_mfma_f32_16x16x32_bf16 a[124:127], v[48:51], v[84:87], a[124:127]
buffer_load_dwordx4 v6, s[8:11], s36 offen offset:1024 lds
v_mfma_f32_16x16x32_bf16 a[120:123], v[44:47], v[84:87], a[120:123]
v_add_f32 v26, v42, v58
v_add_f32 v27, v43, v59
v_mfma_f32_16x16x32_bf16 a[128:131], v[60:63], v[140:143], a[128:131]
v_add_f32 v22, v22, v24
v_add_f32 v23, v23, v25
v_mfma_f32_16x16x32_bf16 a[132:135], v[64:67], v[140:143], a[132:135]
v_cvt_pk_bf16_f32 v74, v22, v26
v_perm_b32 v75, v27, v23, s20
v_mfma_f32_16x16x32_bf16 a[140:143], v[64:67], v[172:175], a[140:143]
s_add_u32 s101, s3, 279552
v_mfma_f32_16x16x32_bf16 a[136:139], v[60:63], v[172:175], a[136:139]
s_add_u32 m0, s41, 55296
v_mfma_f32_16x16x32_bf16 a[144:147], v[60:63], v[120:123], a[144:147]
buffer_load_dwordx4 v9, s[4:7], s101 offen lds
v_mfma_f32_16x16x32_bf16 a[148:151], v[64:67], v[120:123], a[148:151]
v_mfma_f32_16x16x32_bf16 a[156:159], v[64:67], v[104:107], a[156:159]
v_mfma_f32_16x16x32_bf16 a[152:155], v[60:63], v[104:107], a[152:155]
v_mfma_f32_16x16x32_bf16 a[160:163], v[60:63], v[152:155], a[160:163]
s_add_u32 s101, s3, 287744
v_mfma_f32_16x16x32_bf16 a[164:167], v[64:67], v[152:155], a[164:167]
s_add_u32 m0, s41, 56320
v_mfma_f32_16x16x32_bf16 a[172:175], v[64:67], v[96:99], a[172:175]
buffer_load_dwordx4 v9, s[4:7], s101 offen lds
v_mfma_f32_16x16x32_bf16 a[168:171], v[60:63], v[96:99], a[168:171]
v_mfma_f32_16x16x32_bf16 a[176:179], v[60:63], v[108:111], a[176:179]
v_mfma_f32_16x16x32_bf16 a[180:183], v[64:67], v[108:111], a[180:183]
v_mfma_f32_16x16x32_bf16 a[188:191], v[64:67], v[128:131], a[188:191]
v_mfma_f32_16x16x32_bf16 a[184:187], v[60:63], v[128:131], a[184:187]
v_mfma_f32_16x16x32_bf16 a[0:3], v[36:39], v[148:151], a[0:3]
s_waitcnt vmcnt(15)
v_mfma_f32_16x16x32_bf16 a[4:7], v[40:43], v[148:151], a[4:7]
s_barrier
ds_read_b64_tr_b16 v[28:29], v3 offset:0
v_mfma_f32_16x16x32_bf16 a[12:15], v[40:43], v[144:147], a[12:15]
ds_read_b64_tr_b16 v[30:31], v3 offset:512
v_mfma_f32_16x16x32_bf16 a[8:11], v[36:39], v[144:147], a[8:11]
ds_read_b64_tr_b16 v[32:33], v4 offset:0
v_mfma_f32_16x16x32_bf16 a[16:19], v[36:39], v[124:127], a[16:19]
ds_read_b64_tr_b16 v[34:35], v4 offset:512
v_mfma_f32_16x16x32_bf16 a[20:23], v[40:43], v[124:127], a[20:23]
ds_read_b64_tr_b16 v[44:45], v3 offset:4096
v_mfma_f32_16x16x32_bf16 a[28:31], v[40:43], v[92:95], a[28:31]
ds_read_b64_tr_b16 v[46:47], v3 offset:4608
v_mfma_f32_16x16x32_bf16 a[24:27], v[36:39], v[92:95], a[24:27]
ds_read_b64_tr_b16 v[48:49], v4 offset:4096
v_mfma_f32_16x16x32_bf16 a[32:35], v[36:39], v[88:91], a[32:35]
ds_read_b64_tr_b16 v[50:51], v4 offset:4608
v_mfma_f32_16x16x32_bf16 a[36:39], v[40:43], v[88:91], a[36:39]
v_mfma_f32_16x16x32_bf16 a[44:47], v[40:43], v[224:227], a[44:47]
s_add_u32 s36, s35, 14680064
v_mfma_f32_16x16x32_bf16 a[40:43], v[36:39], v[224:227], a[40:43]
s_add_u32 m0, s30, 24576
v_mfma_f32_16x16x32_bf16 a[48:51], v[36:39], v[228:231], a[48:51]
buffer_load_dwordx4 v5, s[8:11], s36 offen offset:0 lds
v_mfma_f32_16x16x32_bf16 a[52:55], v[40:43], v[228:231], a[52:55]
v_mfma_f32_16x16x32_bf16 a[60:63], v[40:43], v[232:235], a[60:63]
s_waitcnt lgkmcnt(2)
v_lshlrev_b64 v[16:17], 16, v[28:29]
v_lshlrev_b64 v[18:19], 16, v[44:45]
v_mfma_f32_16x16x32_bf16 a[56:59], v[36:39], v[232:235], a[56:59]
v_add_f32 v20, v28, v44
v_add_f32 v21, v29, v45
v_mfma_f32_16x16x32_bf16 a[64:67], v[52:55], v[160:163], a[64:67]
v_add_f32 v16, v16, v18
v_add_f32 v17, v17, v19
v_mfma_f32_16x16x32_bf16 a[68:71], v[56:59], v[160:163], a[68:71]
v_perm_b32 v60, v20, v16, s20
v_perm_b32 v61, v21, v17, s20
v_mfma_f32_16x16x32_bf16 a[76:79], v[56:59], v[132:135], a[76:79]
buffer_load_dwordx4 v6, s[8:11], s36 offen offset:1024 lds
v_mfma_f32_16x16x32_bf16 a[72:75], v[52:55], v[132:135], a[72:75]
v_lshlrev_b64 v[22:23], 16, v[30:31]
v_lshlrev_b64 v[24:25], 16, v[46:47]
v_mfma_f32_16x16x32_bf16 a[80:83], v[52:55], v[112:115], a[80:83]
v_add_f32 v26, v30, v46
v_add_f32 v27, v31, v47
v_mfma_f32_16x16x32_bf16 a[84:87], v[56:59], v[112:115], a[84:87]
s_add_u32 s36, s35, 15728640
v_add_f32 v22, v22, v24
v_add_f32 v23, v23, v25
v_mfma_f32_16x16x32_bf16 a[92:95], v[56:59], v[80:83], a[92:95]
s_add_u32 m0, s30, 28672
v_cvt_pk_bf16_f32 v62, v22, v26
v_perm_b32 v63, v27, v23, s20
v_mfma_f32_16x16x32_bf16 a[88:91], v[52:55], v[80:83], a[88:91]
s_waitcnt lgkmcnt(0)
v_lshlrev_b64 v[16:17], 16, v[32:33]
v_lshlrev_b64 v[18:19], 16, v[48:49]
v_mfma_f32_16x16x32_bf16 a[96:99], v[52:55], v[100:103], a[96:99]
buffer_load_dwordx4 v5, s[8:11], s36 offen offset:0 lds
v_mfma_f32_16x16x32_bf16 a[100:103], v[56:59], v[100:103], a[100:103]
v_add_f32 v20, v32, v48
v_add_f32 v21, v33, v49
v_mfma_f32_16x16x32_bf16 a[108:111], v[56:59], v[212:215], a[108:111]
v_add_f32 v16, v16, v18
v_add_f32 v17, v17, v19
v_mfma_f32_16x16x32_bf16 a[104:107], v[52:55], v[212:215], a[104:107]
v_perm_b32 v64, v20, v16, s20
v_perm_b32 v65, v21, v17, s20
v_mfma_f32_16x16x32_bf16 a[112:115], v[52:55], v[84:87], a[112:115]
v_lshlrev_b64 v[22:23], 16, v[34:35]
v_lshlrev_b64 v[24:25], 16, v[50:51]
v_mfma_f32_16x16x32_bf16 a[116:119], v[56:59], v[84:87], a[116:119]
v_add_f32 v26, v34, v50
v_add_f32 v27, v35, v51
v_mfma_f32_16x16x32_bf16 a[124:127], v[56:59], v[156:159], a[124:127]
buffer_load_dwordx4 v6, s[8:11], s36 offen offset:1024 lds
v_mfma_f32_16x16x32_bf16 a[120:123], v[52:55], v[156:159], a[120:123]
v_add_f32 v22, v22, v24
v_add_f32 v23, v23, v25
v_mfma_f32_16x16x32_bf16 a[128:131], v[68:71], v[172:175], a[128:131]
v_cvt_pk_bf16_f32 v66, v22, v26
v_perm_b32 v67, v27, v23, s20
v_mfma_f32_16x16x32_bf16 a[132:135], v[72:75], v[172:175], a[132:135]
v_mov_b32_dpp v168, v172 row_shl:1 row_mask:0xf bank_mask:0xf bound_ctrl:0
v_mov_b32_dpp v169, v173 row_shl:1 row_mask:0xf bank_mask:0xf bound_ctrl:0
v_mfma_f32_16x16x32_bf16 a[140:143], v[72:75], v[120:123], a[140:143]
s_add_u32 s101, s3, 1024
v_mov_b32_dpp v170, v174 row_shl:1 row_mask:0xf bank_mask:0xf bound_ctrl:0
v_mov_b32_dpp v171, v175 row_shl:1 row_mask:0xf bank_mask:0xf bound_ctrl:0
v_mfma_f32_16x16x32_bf16 a[136:139], v[68:71], v[120:123], a[136:139]
s_add_u32 m0, s46, 69632
v_mfma_f32_16x16x32_bf16 a[144:147], v[68:71], v[104:107], a[144:147]
buffer_load_dwordx4 v10, s[4:7], s101 offen lds
v_mfma_f32_16x16x32_bf16 a[148:151], v[72:75], v[104:107], a[148:151]
v_mfma_f32_16x16x32_bf16 a[156:159], v[72:75], v[152:155], a[156:159]
v_mfma_f32_16x16x32_bf16 a[152:155], v[68:71], v[152:155], a[152:155]
v_mfma_f32_16x16x32_bf16 a[160:163], v[68:71], v[96:99], a[160:163]
v_mfma_f32_16x16x32_bf16 a[164:167], v[72:75], v[96:99], a[164:167]
v_mfma_f32_16x16x32_bf16 a[172:175], v[72:75], v[108:111], a[172:175]
v_mfma_f32_16x16x32_bf16 a[168:171], v[68:71], v[108:111], a[168:171]
v_mfma_f32_16x16x32_bf16 a[176:179], v[68:71], v[128:131], a[176:179]
v_mfma_f32_16x16x32_bf16 a[180:183], v[72:75], v[128:131], a[180:183]
v_mfma_f32_16x16x32_bf16 a[188:191], v[72:75], v[136:139], a[188:191]
v_mfma_f32_16x16x32_bf16 a[184:187], v[68:71], v[136:139], a[184:187]
v_mfma_f32_16x16x32_bf16 a[0:3], v[28:31], v[144:147], a[0:3]
s_waitcnt vmcnt(13)
v_mfma_f32_16x16x32_bf16 a[4:7], v[32:35], v[144:147], a[4:7]
s_barrier
ds_read_b64_tr_b16 v[36:37], v3 offset:8192
v_mfma_f32_16x16x32_bf16 a[12:15], v[32:35], v[124:127], a[12:15]
ds_read_b64_tr_b16 v[38:39], v3 offset:8704
v_mov_b32_dpp v172, v144 row_shl:1 row_mask:0xf bank_mask:0xf bound_ctrl:0
v_mfma_f32_16x16x32_bf16 a[8:11], v[28:31], v[124:127], a[8:11]
ds_read_b64_tr_b16 v[40:41], v4 offset:8192
v_mov_b32_dpp v173, v145 row_shl:1 row_mask:0xf bank_mask:0xf bound_ctrl:0
v_mfma_f32_16x16x32_bf16 a[16:19], v[28:31], v[92:95], a[16:19]
ds_read_b64_tr_b16 v[42:43], v4 offset:8704
v_mov_b32_dpp v174, v146 row_shl:1 row_mask:0xf bank_mask:0xf bound_ctrl:0
v_mfma_f32_16x16x32_bf16 a[20:23], v[32:35], v[92:95], a[20:23]
ds_read_b64_tr_b16 v[52:53], v3 offset:12288
v_mov_b32_dpp v175, v147 row_shl:1 row_mask:0xf bank_mask:0xf bound_ctrl:0
v_mfma_f32_16x16x32_bf16 a[28:31], v[32:35], v[88:91], a[28:31]
ds_read_b64_tr_b16 v[54:55], v3 offset:12800
v_mfma_f32_16x16x32_bf16 a[24:27], v[28:31], v[88:91], a[24:27]
ds_read_b64_tr_b16 v[56:57], v4 offset:12288
v_mfma_f32_16x16x32_bf16 a[32:35], v[28:31], v[224:227], a[32:35]
ds_read_b64_tr_b16 v[58:59], v4 offset:12800
v_mfma_f32_16x16x32_bf16 a[36:39], v[32:35], v[224:227], a[36:39]
v_mfma_f32_16x16x32_bf16 a[44:47], v[32:35], v[228:231], a[44:47]
s_add_u32 s36, s35, 524288
v_mfma_f32_16x16x32_bf16 a[40:43], v[28:31], v[228:231], a[40:43]
s_add_u32 m0, s30, 0
v_mfma_f32_16x16x32_bf16 a[48:51], v[28:31], v[232:235], a[48:51]
buffer_load_dwordx4 v7, s[8:11], s36 offen offset:0 lds
v_mfma_f32_16x16x32_bf16 a[52:55], v[32:35], v[232:235], a[52:55]
v_mfma_f32_16x16x32_bf16 a[60:63], v[32:35], v[76:79], a[60:63]
s_waitcnt lgkmcnt(2)
v_lshlrev_b64 v[16:17], 16, v[36:37]
v_lshlrev_b64 v[18:19], 16, v[52:53]
v_mfma_f32_16x16x32_bf16 a[56:59], v[28:31], v[76:79], a[56:59]
v_add_f32 v20, v36, v52
v_add_f32 v21, v37, v53
v_mfma_f32_16x16x32_bf16 a[64:67], v[44:47], v[132:135], a[64:67]
v_add_f32 v16, v16, v18
v_add_f32 v17, v17, v19
v_mfma_f32_16x16x32_bf16 a[68:71], v[48:51], v[132:135], a[68:71]
v_perm_b32 v68, v20, v16, s20
v_perm_b32 v69, v21, v17, s20
v_mfma_f32_16x16x32_bf16 a[76:79], v[48:51], v[112:115], a[76:79]
buffer_load_dwordx4 v8, s[8:11], s36 offen offset:1024 lds
v_mfma_f32_16x16x32_bf16 a[72:75], v[44:47], v[112:115], a[72:75]
v_mov_b32_dpp v196, v132 row_shl:1 row_mask:0xf bank_mask:0xf bound_ctrl:0
v_mov_b32_dpp v197, v133 row_shl:1 row_mask:0xf bank_mask:0xf bound_ctrl:0
v_mfma_f32_16x16x32_bf16 a[80:83], v[44:47], v[80:83], a[80:83]
v_mov_b32_dpp v198, v134 row_shl:1 row_mask:0xf bank_mask:0xf bound_ctrl:0
v_mov_b32_dpp v199, v135 row_shl:1 row_mask:0xf bank_mask:0xf bound_ctrl:0
v_mfma_f32_16x16x32_bf16 a[84:87], v[48:51], v[80:83], a[84:87]
v_lshlrev_b64 v[22:23], 16, v[38:39]
v_lshlrev_b64 v[24:25], 16, v[54:55]
v_mfma_f32_16x16x32_bf16 a[92:95], v[48:51], v[100:103], a[92:95]
s_add_u32 s36, s36, s33
v_add_f32 v26, v38, v54
v_add_f32 v27, v39, v55
v_mfma_f32_16x16x32_bf16 a[88:91], v[44:47], v[100:103], a[88:91]
s_add_u32 m0, s30, 4096
v_add_f32 v22, v22, v24
v_add_f32 v23, v23, v25
v_mfma_f32_16x16x32_bf16 a[96:99], v[44:47], v[212:215], a[96:99]
buffer_load_dwordx4 v7, s[8:11], s36 offen offset:0 lds
v_mfma_f32_16x16x32_bf16 a[100:103], v[48:51], v[212:215], a[100:103]
v_cvt_pk_bf16_f32 v70, v22, v26
v_perm_b32 v71, v27, v23, s20
v_mfma_f32_16x16x32_bf16 a[108:111], v[48:51], v[84:87], a[108:111]
s_waitcnt lgkmcnt(0)
v_lshlrev_b64 v[16:17], 16, v[40:41]
v_lshlrev_b64 v[18:19], 16, v[56:57]
v_mfma_f32_16x16x32_bf16 a[104:107], v[44:47], v[84:87], a[104:107]
v_add_f32 v20, v40, v56
v_add_f32 v21, v41, v57
v_mfma_f32_16x16x32_bf16 a[112:115], v[44:47], v[156:159], a[112:115]
v_add_f32 v16, v16, v18
v_add_f32 v17, v17, v19
v_mfma_f32_16x16x32_bf16 a[116:119], v[48:51], v[156:159], a[116:119]
v_perm_b32 v72, v20, v16, s20
v_perm_b32 v73, v21, v17, s20
v_mfma_f32_16x16x32_bf16 a[124:127], v[48:51], v[208:211], a[124:127]
buffer_load_dwordx4 v8, s[8:11], s36 offen offset:1024 lds
v_mfma_f32_16x16x32_bf16 a[120:123], v[44:47], v[208:211], a[120:123]
v_lshlrev_b64 v[22:23], 16, v[42:43]
v_lshlrev_b64 v[24:25], 16, v[58:59]
v_mfma_f32_16x16x32_bf16 a[128:131], v[60:63], v[120:123], a[128:131]
v_add_f32 v26, v42, v58
v_add_f32 v27, v43, v59
v_mfma_f32_16x16x32_bf16 a[132:135], v[64:67], v[120:123], a[132:135]
v_add_f32 v22, v22, v24
v_add_f32 v23, v23, v25
v_mfma_f32_16x16x32_bf16 a[140:143], v[64:67], v[104:107], a[140:143]
v_cvt_pk_bf16_f32 v74, v22, v26
v_perm_b32 v75, v27, v23, s20
v_mfma_f32_16x16x32_bf16 a[136:139], v[60:63], v[104:107], a[136:139]
v_mov_b32_dpp v176, v120 row_shl:1 row_mask:0xf bank_mask:0xf bound_ctrl:0
v_mov_b32_dpp v177, v121 row_shl:1 row_mask:0xf bank_mask:0xf bound_ctrl:0
v_mfma_f32_16x16x32_bf16 a[144:147], v[60:63], v[152:155], a[144:147]
v_mov_b32_dpp v178, v122 row_shl:1 row_mask:0xf bank_mask:0xf bound_ctrl:0
v_mov_b32_dpp v179, v123 row_shl:1 row_mask:0xf bank_mask:0xf bound_ctrl:0
v_mfma_f32_16x16x32_bf16 a[148:151], v[64:67], v[152:155], a[148:151]
v_mfma_f32_16x16x32_bf16 a[156:159], v[64:67], v[96:99], a[156:159]
v_mfma_f32_16x16x32_bf16 a[152:155], v[60:63], v[96:99], a[152:155]
v_mfma_f32_16x16x32_bf16 a[160:163], v[60:63], v[108:111], a[160:163]
buffer_load_dword a192, v12, s[96:99], 0 offen sc1
v_mfma_f32_16x16x32_bf16 a[164:167], v[64:67], v[108:111], a[164:167]
v_mfma_f32_16x16x32_bf16 a[172:175], v[64:67], v[128:131], a[172:175]
v_add_u32 v12, 128, v12
v_mfma_f32_16x16x32_bf16 a[168:171], v[60:63], v[128:131], a[168:171]
v_mfma_f32_16x16x32_bf16 a[176:179], v[60:63], v[136:139], a[176:179]
v_mfma_f32_16x16x32_bf16 a[180:183], v[64:67], v[136:139], a[180:183]
v_mfma_f32_16x16x32_bf16 a[188:191], v[64:67], v[168:171], a[188:191]
v_mfma_f32_16x16x32_bf16 a[184:187], v[60:63], v[168:171], a[184:187]
s_add_u32 s23, s3, s34
v_mfma_f32_16x16x32_bf16 a[0:3], v[36:39], v[124:127], a[0:3]
s_waitcnt vmcnt(5)
v_mfma_f32_16x16x32_bf16 a[4:7], v[40:43], v[124:127], a[4:7]
s_barrier
ds_read_b64_tr_b16 v[28:29], v3 offset:16384
v_mfma_f32_16x16x32_bf16 a[12:15], v[40:43], v[92:95], a[12:15]
ds_read_b64_tr_b16 v[30:31], v3 offset:16896
v_mov_b32_dpp v220, v124 row_shl:1 row_mask:0xf bank_mask:0xf bound_ctrl:0
v_mfma_f32_16x16x32_bf16 a[8:11], v[36:39], v[92:95], a[8:11]
ds_read_b64_tr_b16 v[32:33], v4 offset:16384
v_mov_b32_dpp v221, v125 row_shl:1 row_mask:0xf bank_mask:0xf bound_ctrl:0
v_mfma_f32_16x16x32_bf16 a[16:19], v[36:39], v[88:91], a[16:19]
ds_read_b64_tr_b16 v[34:35], v4 offset:16896
v_mov_b32_dpp v222, v126 row_shl:1 row_mask:0xf bank_mask:0xf bound_ctrl:0
v_mfma_f32_16x16x32_bf16 a[20:23], v[40:43], v[88:91], a[20:23]
ds_read_b64_tr_b16 v[44:45], v3 offset:20480
v_mov_b32_dpp v223, v127 row_shl:1 row_mask:0xf bank_mask:0xf bound_ctrl:0
v_mfma_f32_16x16x32_bf16 a[28:31], v[40:43], v[224:227], a[28:31]
ds_read_b64_tr_b16 v[46:47], v3 offset:20992
v_mfma_f32_16x16x32_bf16 a[24:27], v[36:39], v[224:227], a[24:27]
ds_read_b64_tr_b16 v[48:49], v4 offset:20480
v_mfma_f32_16x16x32_bf16 a[32:35], v[36:39], v[228:231], a[32:35]
ds_read_b64_tr_b16 v[50:51], v4 offset:20992
v_mfma_f32_16x16x32_bf16 a[36:39], v[40:43], v[228:231], a[36:39]
v_mfma_f32_16x16x32_bf16 a[44:47], v[40:43], v[232:235], a[44:47]
s_add_u32 s36, s36, s33
ds_read_b128 a[204:207], v1 offset:36864
v_mfma_f32_16x16x32_bf16 a[40:43], v[36:39], v[232:235], a[40:43]
s_add_u32 m0, s30, 8192
ds_read_b128 v[180:183], v1 offset:37120
v_mfma_f32_16x16x32_bf16 a[48:51], v[36:39], v[76:79], a[48:51]
buffer_load_dwordx4 v7, s[8:11], s36 offen offset:0 lds
v_mfma_f32_16x16x32_bf16 a[52:55], v[40:43], v[76:79], a[52:55]
ds_read_b128 v[164:167], v1 offset:37376
v_mfma_f32_16x16x32_bf16 a[60:63], v[40:43], v[172:175], a[60:63]
s_waitcnt lgkmcnt(5)
v_lshlrev_b64 v[16:17], 16, v[28:29]
v_lshlrev_b64 v[18:19], 16, v[44:45]
v_mfma_f32_16x16x32_bf16 a[56:59], v[36:39], v[172:175], a[56:59]
v_add_f32 v20, v28, v44
v_add_f32 v21, v29, v45
v_mfma_f32_16x16x32_bf16 a[64:67], v[52:55], v[112:115], a[64:67]
v_add_f32 v16, v16, v18
v_add_f32 v17, v17, v19
v_mfma_f32_16x16x32_bf16 a[68:71], v[56:59], v[112:115], a[68:71]
v_perm_b32 v60, v20, v16, s20
v_perm_b32 v61, v21, v17, s20
v_mfma_f32_16x16x32_bf16 a[76:79], v[56:59], v[80:83], a[76:79]
buffer_load_dwordx4 v8, s[8:11], s36 offen offset:1024 lds
v_mfma_f32_16x16x32_bf16 a[72:75], v[52:55], v[80:83], a[72:75]
v_mov_b32_dpp v200, v112 row_shl:1 row_mask:0xf bank_mask:0xf bound_ctrl:0
v_mov_b32_dpp v201, v113 row_shl:1 row_mask:0xf bank_mask:0xf bound_ctrl:0
v_mfma_f32_16x16x32_bf16 a[80:83], v[52:55], v[100:103], a[80:83]
ds_read_b128 v[140:143], v1 offset:37632
v_mov_b32_dpp v202, v114 row_shl:1 row_mask:0xf bank_mask:0xf bound_ctrl:0
v_mfma_f32_16x16x32_bf16 a[84:87], v[56:59], v[100:103], a[84:87]
ds_read_b128 v[116:119], v1 offset:37888
v_mov_b32_dpp v203, v115 row_shl:1 row_mask:0xf bank_mask:0xf bound_ctrl:0
v_mfma_f32_16x16x32_bf16 a[92:95], v[56:59], v[212:215], a[92:95]
s_add_u32 s36, s36, s33
v_lshlrev_b64 v[22:23], 16, v[30:31]
v_lshlrev_b64 v[24:25], 16, v[46:47]
v_mfma_f32_16x16x32_bf16 a[88:91], v[52:55], v[212:215], a[88:91]
s_add_u32 m0, s30, 12288
v_add_f32 v26, v30, v46
v_add_f32 v27, v31, v47
v_mfma_f32_16x16x32_bf16 a[96:99], v[52:55], v[84:87], a[96:99]
buffer_load_dwordx4 v7, s[8:11], s36 offen offset:0 lds
v_mfma_f32_16x16x32_bf16 a[100:103], v[56:59], v[84:87], a[100:103]
v_add_f32 v22, v22, v24
v_add_f32 v23, v23, v25
v_mfma_f32_16x16x32_bf16 a[108:111], v[56:59], v[156:159], a[108:111]
v_cvt_pk_bf16_f32 v62, v22, v26
v_perm_b32 v63, v27, v23, s20
v_mfma_f32_16x16x32_bf16 a[104:107], v[52:55], v[156:159], a[104:107]
s_waitcnt lgkmcnt(5)
v_lshlrev_b64 v[16:17], 16, v[32:33]
v_lshlrev_b64 v[18:19], 16, v[48:49]
v_mfma_f32_16x16x32_bf16 a[112:115], v[52:55], v[208:211], a[112:115]
v_add_f32 v20, v32, v48
v_add_f32 v21, v33, v49
v_mfma_f32_16x16x32_bf16 a[116:119], v[56:59], v[208:211], a[116:119]
v_add_f32 v16, v16, v18
v_add_f32 v17, v17, v19
v_mfma_f32_16x16x32_bf16 a[124:127], v[56:59], v[196:199], a[124:127]
buffer_load_dwordx4 v8, s[8:11], s36 offen offset:1024 lds
v_mfma_f32_16x16x32_bf16 a[120:123], v[52:55], v[196:199], a[120:123]
v_perm_b32 v64, v20, v16, s20
v_perm_b32 v65, v21, v17, s20
v_mfma_f32_16x16x32_bf16 a[128:131], v[68:71], v[104:107], a[128:131]
ds_read_b128 v[132:135], v1 offset:38144
v_lshlrev_b64 v[22:23], 16, v[34:35]
v_mfma_f32_16x16x32_bf16 a[132:135], v[72:75], v[104:107], a[132:135]
ds_read_b128 v[120:123], v1 offset:38400
v_lshlrev_b64 v[24:25], 16, v[50:51]
v_mfma_f32_16x16x32_bf16 a[140:143], v[72:75], v[152:155], a[140:143]
v_add_f32 v26, v34, v50
v_add_f32 v27, v35, v51
v_mfma_f32_16x16x32_bf16 a[136:139], v[68:71], v[152:155], a[136:139]
v_add_f32 v22, v22, v24
v_add_f32 v23, v23, v25
v_mfma_f32_16x16x32_bf16 a[144:147], v[68:71], v[96:99], a[144:147]
v_cvt_pk_bf16_f32 v66, v22, v26
v_perm_b32 v67, v27, v23, s20
v_mfma_f32_16x16x32_bf16 a[148:151], v[72:75], v[96:99], a[148:151]
L_pad5:
s_cbranch_execz L_pad9
v_mov_b32_dpp v188, v104 row_shl:1 row_mask:0xf bank_mask:0xf bound_ctrl:0
v_mov_b32_dpp v189, v105 row_shl:1 row_mask:0xf bank_mask:0xf bound_ctrl:0
v_mfma_f32_16x16x32_bf16 a[156:159], v[72:75], v[108:111], a[156:159]
v_mov_b32_dpp v190, v106 row_shl:1 row_mask:0xf bank_mask:0xf bound_ctrl:0
v_mov_b32_dpp v191, v107 row_shl:1 row_mask:0xf bank_mask:0xf bound_ctrl:0
v_mfma_f32_16x16x32_bf16 a[152:155], v[68:71], v[108:111], a[152:155]
s_waitcnt lgkmcnt(4)
v_lshlrev_b64 v[16:17], 16, v[180:181]
v_lshlrev_b64 v[18:19], 16, v[164:165]
v_mfma_f32_16x16x32_bf16 a[160:163], v[68:71], v[128:131], a[160:163]
v_add_f32 v20, v180, v164
v_add_f32 v21, v181, v165
v_mfma_f32_16x16x32_bf16 a[164:167], v[72:75], v[128:131], a[164:167]
v_add_f32 v16, v16, v18
v_add_f32 v17, v17, v19
v_mfma_f32_16x16x32_bf16 a[172:175], v[72:75], v[136:139], a[172:175]
v_perm_b32 v184, v20, v16, s20
v_perm_b32 v185, v21, v17, s20
v_mfma_f32_16x16x32_bf16 a[168:171], v[68:71], v[136:139], a[168:171]
v_lshlrev_b64 v[22:23], 16, v[182:183]
v_lshlrev_b64 v[24:25], 16, v[166:167]
v_mfma_f32_16x16x32_bf16 a[176:179], v[68:71], v[168:171], a[176:179]
v_add_f32 v26, v182, v166
v_add_f32 v27, v183, v167
v_mfma_f32_16x16x32_bf16 a[180:183], v[72:75], v[168:171], a[180:183]
v_add_f32 v22, v22, v24
v_add_f32 v23, v23, v25
v_mfma_f32_16x16x32_bf16 a[188:191], v[72:75], v[176:179], a[188:191]
v_cvt_pk_bf16_f32 v186, v22, v26
v_perm_b32 v187, v27, v23, s20
v_mfma_f32_16x16x32_bf16 a[184:187], v[68:71], v[176:179], a[184:187]
s_waitcnt lgkmcnt(2)
v_lshlrev_b64 v[16:17], 16, v[140:141]
v_lshlrev_b64 v[18:19], 16, v[116:117]
v_mfma_f32_16x16x32_bf16 a[0:3], v[28:31], v[92:95], a[0:3]
v_add_f32 v20, v140, v116
v_add_f32 v21, v141, v117
v_mfma_f32_16x16x32_bf16 a[4:7], v[32:35], v[92:95], a[4:7]
s_barrier
ds_read_b64_tr_b16 v[36:37], v3 offset:24576
v_mfma_f32_16x16x32_bf16 a[12:15], v[32:35], v[88:91], a[12:15]
ds_read_b64_tr_b16 v[38:39], v3 offset:25088
v_add_f32 v16, v16, v18
v_mfma_f32_16x16x32_bf16 a[8:11], v[28:31], v[88:91], a[8:11]
ds_read_b64_tr_b16 v[40:41], v4 offset:24576
v_add_f32 v17, v17, v19
v_mfma_f32_16x16x32_bf16 a[16:19], v[28:31], v[224:227], a[16:19]
ds_read_b64_tr_b16 v[42:43], v4 offset:25088
v_perm_b32 v160, v20, v16, s20
v_mfma_f32_16x16x32_bf16 a[20:23], v[32:35], v[224:227], a[20:23]
ds_read_b64_tr_b16 v[52:53], v3 offset:28672
v_perm_b32 v161, v21, v17, s20
v_mfma_f32_16x16x32_bf16 a[28:31], v[32:35], v[228:231], a[28:31]
ds_read_b64_tr_b16 v[54:55], v3 offset:29184
v_mov_b32_dpp v216, v92 row_shl:1 row_mask:0xf bank_mask:0xf bound_ctrl:0
v_mfma_f32_16x16x32_bf16 a[24:27], v[28:31], v[228:231], a[24:27]
ds_read_b64_tr_b16 v[56:57], v4 offset:28672
v_mov_b32_dpp v217, v93 row_shl:1 row_mask:0xf bank_mask:0xf bound_ctrl:0
v_mfma_f32_16x16x32_bf16 a[32:35], v[28:31], v[232:235], a[32:35]
ds_read_b64_tr_b16 v[58:59], v4 offset:29184
v_mov_b32_dpp v218, v94 row_shl:1 row_mask:0xf bank_mask:0xf bound_ctrl:0
v_mfma_f32_16x16x32_bf16 a[36:39], v[32:35], v[232:235], a[36:39]
v_mov_b32_dpp v219, v95 row_shl:1 row_mask:0xf bank_mask:0xf bound_ctrl:0
v_lshlrev_b64 v[22:23], 16, v[142:143]
v_mfma_f32_16x16x32_bf16 a[44:47], v[32:35], v[76:79], a[44:47]
s_add_u32 s36, s36, s33
ds_read_b128 v[144:147], v1 offset:38656
v_lshlrev_b64 v[24:25], 16, v[118:119]
v_mfma_f32_16x16x32_bf16 a[40:43], v[28:31], v[76:79], a[40:43]
s_add_u32 m0, s30, 16384
ds_read_b128 v[124:127], v1 offset:38912
v_add_f32 v26, v142, v118
v_mfma_f32_16x16x32_bf16 a[48:51], v[28:31], v[172:175], a[48:51]
buffer_load_dwordx4 v7, s[8:11], s36 offen offset:0 lds
v_mfma_f32_16x16x32_bf16 a[52:55], v[32:35], v[172:175], a[52:55]
v_add_f32 v27, v143, v119
v_add_f32 v22, v22, v24
v_mfma_f32_16x16x32_bf16 a[60:63], v[32:35], v[220:223], a[60:63]
v_add_f32 v23, v23, v25
v_cvt_pk_bf16_f32 v162, v22, v26
v_mfma_f32_16x16x32_bf16 a[56:59], v[28:31], v[220:223], a[56:59]
s_waitcnt lgkmcnt(4)
v_perm_b32 v163, v27, v23, s20
v_lshlrev_b64 v[16:17], 16, v[36:37]
v_mfma_f32_16x16x32_bf16 a[64:67], v[44:47], v[80:83], a[64:67]
v_lshlrev_b64 v[18:19], 16, v[52:53]
v_add_f32 v20, v36, v52
v_mfma_f32_16x16x32_bf16 a[68:71], v[48:51], v[80:83], a[68:71]
v_add_f32 v21, v37, v53
v_add_f32 v16, v16, v18
v_mfma_f32_16x16x32_bf16 a[76:79], v[48:51], v[100:103], a[76:79]
buffer_load_dwordx4 v8, s[8:11], s36 offen offset:1024 lds
v_mfma_f32_16x16x32_bf16 a[72:75], v[44:47], v[100:103], a[72:75]
v_add_f32 v17, v17, v19
v_perm_b32 v68, v20, v16, s20
v_mfma_f32_16x16x32_bf16 a[80:83], v[44:47], v[212:215], a[80:83]
ds_read_b128 v[112:115], v1 offset:39168
v_perm_b32 v69, v21, v17, s20
v_mfma_f32_16x16x32_bf16 a[84:87], v[48:51], v[212:215], a[84:87]
ds_read_b128 v[104:107], v1 offset:39424
v_mov_b32_dpp v204, v80 row_shl:1 row_mask:0xf bank_mask:0xf bound_ctrl:0
v_mfma_f32_16x16x32_bf16 a[92:95], v[48:51], v[84:87], a[92:95]
s_add_u32 s36, s36, s33
v_mov_b32_dpp v205, v81 row_shl:1 row_mask:0xf bank_mask:0xf bound_ctrl:0
v_mov_b32_dpp v206, v82 row_shl:1 row_mask:0xf bank_mask:0xf bound_ctrl:0
v_mfma_f32_16x16x32_bf16 a[88:91], v[44:47], v[84:87], a[88:91]
s_add_u32 m0, s30, 20480
v_mov_b32_dpp v207, v83 row_shl:1 row_mask:0xf bank_mask:0xf bound_ctrl:0
v_lshlrev_b64 v[22:23], 16, v[38:39]
v_mfma_f32_16x16x32_bf16 a[96:99], v[44:47], v[156:159], a[96:99]
buffer_load_dwordx4 v7, s[8:11], s36 offen offset:0 lds
v_mfma_f32_16x16x32_bf16 a[100:103], v[48:51], v[156:159], a[100:103]
v_lshlrev_b64 v[24:25], 16, v[54:55]
v_add_f32 v26, v38, v54
v_mfma_f32_16x16x32_bf16 a[108:111], v[48:51], v[208:211], a[108:111]
v_add_f32 v27, v39, v55
v_add_f32 v22, v22, v24
v_mfma_f32_16x16x32_bf16 a[104:107], v[44:47], v[208:211], a[104:107]
v_add_f32 v23, v23, v25
v_cvt_pk_bf16_f32 v70, v22, v26
v_mfma_f32_16x16x32_bf16 a[112:115], v[44:47], v[196:199], a[112:115]
s_waitcnt lgkmcnt(4)
v_perm_b32 v71, v27, v23, s20
v_lshlrev_b64 v[16:17], 16, v[40:41]
v_mfma_f32_16x16x32_bf16 a[116:119], v[48:51], v[196:199], a[116:119]
v_lshlrev_b64 v[18:19], 16, v[56:57]
v_add_f32 v20, v40, v56
v_mfma_f32_16x16x32_bf16 a[124:127], v[48:51], v[200:203], a[124:127]
buffer_load_dwordx4 v8, s[8:11], s36 offen offset:1024 lds
v_mfma_f32_16x16x32_bf16 a[120:123], v[44:47], v[200:203], a[120:123]
v_add_f32 v21, v41, v57
v_add_f32 v16, v16, v18
v_mfma_f32_16x16x32_bf16 a[128:131], v[60:63], v[152:155], a[128:131]
ds_read_b128 v[92:95], v1 offset:39680
v_add_f32 v17, v17, v19
v_mfma_f32_16x16x32_bf16 a[132:135], v[64:67], v[152:155], a[132:135]
ds_read_b128 v[80:83], v1 offset:39936
v_perm_b32 v72, v20, v16, s20
v_mfma_f32_16x16x32_bf16 a[140:143], v[64:67], v[96:99], a[140:143]
v_perm_b32 v73, v21, v17, s20
v_lshlrev_b64 v[22:23], 16, v[42:43]
v_mfma_f32_16x16x32_bf16 a[136:139], v[60:63], v[96:99], a[136:139]
v_lshlrev_b64 v[24:25], 16, v[58:59]
v_add_f32 v26, v42, v58
v_mfma_f32_16x16x32_bf16 a[144:147], v[60:63], v[108:111], a[144:147]
v_add_f32 v27, v43, v59
v_add_f32 v22, v22, v24
v_mfma_f32_16x16x32_bf16 a[148:151], v[64:67], v[108:111], a[148:151]
v_add_f32 v23, v23, v25
v_cvt_pk_bf16_f32 v74, v22, v26
v_mfma_f32_16x16x32_bf16 a[156:159], v[64:67], v[128:131], a[156:159]
v_perm_b32 v75, v27, v23, s20
v_mov_b32_dpp v192, v152 row_shl:1 row_mask:0xf bank_mask:0xf bound_ctrl:0
v_mfma_f32_16x16x32_bf16 a[152:155], v[60:63], v[128:131], a[152:155]
v_mov_b32_dpp v193, v153 row_shl:1 row_mask:0xf bank_mask:0xf bound_ctrl:0
v_mov_b32_dpp v194, v154 row_shl:1 row_mask:0xf bank_mask:0xf bound_ctrl:0
v_mfma_f32_16x16x32_bf16 a[160:163], v[60:63], v[136:139], a[160:163]
v_mov_b32_dpp v195, v155 row_shl:1 row_mask:0xf bank_mask:0xf bound_ctrl:0
v_lshlrev_b64 v[16:17], 16, v[132:133]
v_mfma_f32_16x16x32_bf16 a[164:167], v[64:67], v[136:139], a[164:167]
v_lshlrev_b64 v[18:19], 16, v[120:121]
v_add_f32 v20, v132, v120
v_mfma_f32_16x16x32_bf16 a[172:175], v[64:67], v[168:171], a[172:175]
v_add_f32 v21, v133, v121
v_add_f32 v16, v16, v18
v_mfma_f32_16x16x32_bf16 a[168:171], v[60:63], v[168:171], a[168:171]
v_add_f32 v17, v17, v19
v_perm_b32 v148, v20, v16, s20
v_mfma_f32_16x16x32_bf16 a[176:179], v[60:63], v[176:179], a[176:179]
v_perm_b32 v149, v21, v17, s20
v_lshlrev_b64 v[22:23], 16, v[134:135]
v_mfma_f32_16x16x32_bf16 a[180:183], v[64:67], v[176:179], a[180:183]
v_lshlrev_b64 v[24:25], 16, v[122:123]
v_add_f32 v26, v134, v122
v_mfma_f32_16x16x32_bf16 a[188:191], v[64:67], v[188:191], a[188:191]
v_add_f32 v27, v135, v123
v_add_f32 v22, v22, v24
v_mfma_f32_16x16x32_bf16 a[184:187], v[60:63], v[188:191], a[184:187]
v_add_f32 v23, v23, v25
v_cvt_pk_bf16_f32 v150, v22, v26
v_mfma_f32_16x16x32_bf16 a[0:3], v[36:39], v[88:91], a[0:3]
s_waitcnt vmcnt(9) lgkmcnt(4)
v_perm_b32 v151, v27, v23, s20
v_lshlrev_b64 v[16:17], 16, v[144:145]
v_mfma_f32_16x16x32_bf16 a[4:7], v[40:43], v[88:91], a[4:7]
s_barrier
ds_read_b64_tr_b16 v[28:29], v3 offset:0
v_mfma_f32_16x16x32_bf16 a[12:15], v[40:43], v[224:227], a[12:15]
ds_read_b64_tr_b16 v[30:31], v3 offset:512
v_lshlrev_b64 v[18:19], 16, v[124:125]
v_mfma_f32_16x16x32_bf16 a[8:11], v[36:39], v[224:227], a[8:11]
ds_read_b64_tr_b16 v[32:33], v4 offset:0
v_add_f32 v20, v144, v124
v_mfma_f32_16x16x32_bf16 a[16:19], v[36:39], v[228:231], a[16:19]
ds_read_b64_tr_b16 v[34:35], v4 offset:512
v_add_f32 v21, v145, v125
v_mfma_f32_16x16x32_bf16 a[20:23], v[40:43], v[228:231], a[20:23]
ds_read_b64_tr_b16 v[44:45], v3 offset:4096
v_add_f32 v16, v16, v18
v_mfma_f32_16x16x32_bf16 a[28:31], v[40:43], v[232:235], a[28:31]
ds_read_b64_tr_b16 v[46:47], v3 offset:4608
v_add_f32 v17, v17, v19
v_mfma_f32_16x16x32_bf16 a[24:27], v[36:39], v[232:235], a[24:27]
ds_read_b64_tr_b16 v[48:49], v4 offset:4096
v_perm_b32 v152, v20, v16, s20
v_mfma_f32_16x16x32_bf16 a[32:35], v[36:39], v[76:79], a[32:35]
ds_read_b64_tr_b16 v[50:51], v4 offset:4608
v_perm_b32 v153, v21, v17, s20
v_mfma_f32_16x16x32_bf16 a[36:39], v[40:43], v[76:79], a[36:39]
ds_read_b128 v[88:91], v1 offset:40192
v_lshlrev_b64 v[22:23], 16, v[146:147]
v_mfma_f32_16x16x32_bf16 a[44:47], v[40:43], v[172:175], a[44:47]
s_add_u32 s36, s36, s33
ds_read_b128 v[76:79], v1 offset:40448
v_lshlrev_b64 v[24:25], 16, v[126:127]
v_mfma_f32_16x16x32_bf16 a[40:43], v[36:39], v[172:175], a[40:43]
s_add_u32 m0, s30, 24576
v_add_f32 v26, v146, v126
v_add_f32 v27, v147, v127
v_mfma_f32_16x16x32_bf16 a[48:51], v[36:39], v[220:223], a[48:51]
buffer_load_dwordx4 v7, s[8:11], s36 offen offset:0 lds
v_mfma_f32_16x16x32_bf16 a[52:55], v[40:43], v[220:223], a[52:55]
v_add_f32 v22, v22, v24
v_add_f32 v23, v23, v25
v_mfma_f32_16x16x32_bf16 a[60:63], v[40:43], v[216:219], a[60:63]
v_cvt_pk_bf16_f32 v154, v22, v26
v_perm_b32 v155, v27, v23, s20
v_mfma_f32_16x16x32_bf16 a[56:59], v[36:39], v[216:219], a[56:59]
s_waitcnt lgkmcnt(12)
v_lshlrev_b64 v[16:17], 16, v[112:113]
v_lshlrev_b64 v[18:19], 16, v[104:105]
v_mfma_f32_16x16x32_bf16 a[64:67], v[52:55], v[100:103], a[64:67]
v_add_f32 v20, v112, v104
v_add_f32 v21, v113, v105
v_mfma_f32_16x16x32_bf16 a[68:71], v[56:59], v[100:103], a[68:71]
v_add_f32 v16, v16, v18
v_add_f32 v17, v17, v19
v_mfma_f32_16x16x32_bf16 a[76:79], v[56:59], v[212:215], a[76:79]
buffer_load_dwordx4 v8, s[8:11], s36 offen offset:1024 lds
v_mfma_f32_16x16x32_bf16 a[72:75], v[52:55], v[212:215], a[72:75]
v_perm_b32 v172, v20, v16, s20
v_perm_b32 v173, v21, v17, s20
v_mfma_f32_16x16x32_bf16 a[80:83], v[52:55], v[84:87], a[80:83]
ds_read_b128 v[100:103], v1 offset:40704
v_lshlrev_b64 v[22:23], 16, v[114:115]
v_mfma_f32_16x16x32_bf16 a[84:87], v[56:59], v[84:87], a[84:87]
v_lshlrev_b64 v[24:25], 16, v[106:107]
v_add_f32 v26, v114, v106
v_mfma_f32_16x16x32_bf16 a[92:95], v[56:59], v[156:159], a[92:95]
s_add_u32 s36, s36, s33
ds_read_b128 v[84:87], v2 offset:36864
v_add_f32 v27, v115, v107
v_mfma_f32_16x16x32_bf16 a[88:91], v[52:55], v[156:159], a[88:91]
s_add_u32 m0, s30, 28672
v_add_f32 v22, v22, v24
v_add_f32 v23, v23, v25
v_mfma_f32_16x16x32_bf16 a[96:99], v[52:55], v[208:211], a[96:99]
buffer_load_dwordx4 v7, s[8:11], s36 offen offset:0 lds
v_mfma_f32_16x16x32_bf16 a[100:103], v[56:59], v[208:211], a[100:103]
v_cvt_pk_bf16_f32 v174, v22, v26
v_perm_b32 v175, v27, v23, s20
v_mfma_f32_16x16x32_bf16 a[108:111], v[56:59], v[196:199], a[108:111]
s_waitcnt lgkmcnt(12)
v_lshlrev_b64 v[16:17], 16, v[92:93]
v_lshlrev_b64 v[18:19], 16, v[80:81]
v_mfma_f32_16x16x32_bf16 a[104:107], v[52:55], v[196:199], a[104:107]
v_add_f32 v20, v92, v80
v_add_f32 v21, v93, v81
v_mfma_f32_16x16x32_bf16 a[112:115], v[52:55], v[200:203], a[112:115]
v_add_f32 v16, v16, v18
v_add_f32 v17, v17, v19
v_mfma_f32_16x16x32_bf16 a[116:119], v[56:59], v[200:203], a[116:119]
v_perm_b32 v156, v20, v16, s20
v_perm_b32 v157, v21, v17, s20
v_mfma_f32_16x16x32_bf16 a[124:127], v[56:59], v[204:207], a[124:127]
buffer_load_dwordx4 v8, s[8:11], s36 offen offset:1024 lds
v_mfma_f32_16x16x32_bf16 a[120:123], v[52:55], v[204:207], a[120:123]
v_lshlrev_b64 v[22:23], 16, v[94:95]
v_lshlrev_b64 v[24:25], 16, v[82:83]
v_mfma_f32_16x16x32_bf16 a[128:131], v[68:71], v[96:99], a[128:131]
v_add_f32 v26, v94, v82
v_add_f32 v27, v95, v83
v_mfma_f32_16x16x32_bf16 a[132:135], v[72:75], v[96:99], a[132:135]
s_add_u32 s101, s23, 0
v_add_f32 v22, v22, v24
v_add_f32 v23, v23, v25
v_mfma_f32_16x16x32_bf16 a[140:143], v[72:75], v[108:111], a[140:143]
s_add_u32 m0, s41, 0
v_cvt_pk_bf16_f32 v158, v22, v26
v_perm_b32 v159, v27, v23, s20
v_mfma_f32_16x16x32_bf16 a[136:139], v[68:71], v[108:111], a[136:139]
s_waitcnt lgkmcnt(2)
v_lshlrev_b64 v[16:17], 16, v[88:89]
v_lshlrev_b64 v[18:19], 16, v[76:77]
v_mfma_f32_16x16x32_bf16 a[144:147], v[68:71], v[128:131], a[144:147]
buffer_load_dwordx4 v9, s[4:7], s101 offen lds
v_mfma_f32_16x16x32_bf16 a[148:151], v[72:75], v[128:131], a[148:151]
v_add_f32 v20, v88, v76
v_add_f32 v21, v89, v77
v_mfma_f32_16x16x32_bf16 a[156:159], v[72:75], v[136:139], a[156:159]
v_add_f32 v16, v16, v18
v_add_f32 v17, v17, v19
v_mfma_f32_16x16x32_bf16 a[152:155], v[68:71], v[136:139], a[152:155]
v_perm_b32 v96, v20, v16, s20
v_perm_b32 v97, v21, v17, s20
v_mfma_f32_16x16x32_bf16 a[160:163], v[68:71], v[168:171], a[160:163]
s_add_u32 s101, s23, 8192
v_lshlrev_b64 v[22:23], 16, v[90:91]
v_lshlrev_b64 v[24:25], 16, v[78:79]
v_mfma_f32_16x16x32_bf16 a[164:167], v[72:75], v[168:171], a[164:167]
s_add_u32 m0, s41, 1024
v_add_f32 v26, v90, v78
v_add_f32 v27, v91, v79
v_mfma_f32_16x16x32_bf16 a[172:175], v[72:75], v[176:179], a[172:175]
buffer_load_dwordx4 v9, s[4:7], s101 offen lds
v_mfma_f32_16x16x32_bf16 a[168:171], v[68:71], v[176:179], a[168:171]
v_add_f32 v22, v22, v24
v_add_f32 v23, v23, v25
v_mfma_f32_16x16x32_bf16 a[176:179], v[68:71], v[188:191], a[176:179]
v_cvt_pk_bf16_f32 v98, v22, v26
v_perm_b32 v99, v27, v23, s20
v_mfma_f32_16x16x32_bf16 a[180:183], v[72:75], v[188:191], a[180:183]
v_mfma_f32_16x16x32_bf16 a[188:191], v[72:75], v[192:195], a[188:191]
v_mfma_f32_16x16x32_bf16 a[184:187], v[68:71], v[192:195], a[184:187]
s_cmp_lg_u32 s37, 0
s_cbranch_scc1 L_u1
L_final:
v_mfma_f32_16x16x32_bf16 a[4:7], v[28:31], a[204:207], a[4:7]
s_waitcnt vmcnt(10)
v_lshlrev_b64 v[16:17], 16, v[28:29]
v_lshlrev_b64 v[18:19], 16, v[32:33]
v_mfma_f32_16x16x32_bf16 a[12:15], v[28:31], v[164:167], a[12:15]
s_barrier
ds_read_b64_tr_b16 v[36:37], v3 offset:8192
v_add_f32 v20, v28, v32
v_mfma_f32_16x16x32_bf16 a[20:23], v[28:31], v[116:119], a[20:23]
ds_read_b64_tr_b16 v[38:39], v3 offset:8704
v_add_f32 v21, v29, v33
v_mfma_f32_16x16x32_bf16 a[28:31], v[28:31], v[120:123], a[28:31]
ds_read_b64_tr_b16 v[40:41], v4 offset:8192
v_add_f32 v16, v16, v18
v_mfma_f32_16x16x32_bf16 a[36:39], v[28:31], v[124:127], a[36:39]
s_lshl_b32 s40, s28, 4
ds_read_b64_tr_b16 v[42:43], v4 offset:8704
v_add_f32 v17, v17, v19
v_mfma_f32_16x16x32_bf16 a[44:47], v[28:31], v[104:107], a[44:47]
s_lshl_b32 s39, s24, 12
ds_read_b64_tr_b16 v[52:53], v3 offset:12288
v_perm_b32 v60, v20, v16, s20
v_mfma_f32_16x16x32_bf16 a[52:55], v[28:31], v[80:83], a[52:55]
s_mul_i32 s38, s24, 9216
ds_read_b64_tr_b16 v[54:55], v3 offset:12800
v_perm_b32 v61, v21, v17, s20
v_mfma_f32_16x16x32_bf16 a[60:63], v[28:31], v[76:79], a[60:63]
ds_read_b64_tr_b16 v[56:57], v4 offset:12288
v_lshlrev_b64 v[22:23], 16, v[30:31]
v_mfma_f32_16x16x32_bf16 a[68:71], v[32:35], v[180:183], a[68:71]
ds_read_b64_tr_b16 v[58:59], v4 offset:12800
v_lshlrev_b64 v[24:25], 16, v[34:35]
v_mfma_f32_16x16x32_bf16 a[76:79], v[32:35], v[140:143], a[76:79]
ds_read_b128 v[168:171], v2 offset:37120
v_add_f32 v26, v30, v34
v_mfma_f32_16x16x32_bf16 a[84:87], v[32:35], v[132:135], a[84:87]
s_add_u32 s36, s35, 524288
ds_read_b128 v[136:139], v2 offset:37376
v_add_f32 v27, v31, v35
v_mfma_f32_16x16x32_bf16 a[92:95], v[32:35], v[144:147], a[92:95]
s_add_u32 m0, s30, 0
v_add_f32 v22, v22, v24
v_add_f32 v23, v23, v25
v_mfma_f32_16x16x32_bf16 a[100:103], v[32:35], v[112:115], a[100:103]
buffer_load_dwordx4 v14, s[8:11], s36 offen offset:0 lds
v_mfma_f32_16x16x32_bf16 a[108:111], v[32:35], v[92:95], a[108:111]
v_cvt_pk_bf16_f32 v62, v22, v26
v_perm_b32 v63, v27, v23, s20
v_mfma_f32_16x16x32_bf16 a[116:119], v[32:35], v[88:91], a[116:119]
s_waitcnt lgkmcnt(10)
v_lshlrev_b64 v[16:17], 16, v[100:101]
v_lshlrev_b64 v[18:19], 16, v[84:85]
v_mfma_f32_16x16x32_bf16 a[124:127], v[32:35], v[100:103], a[124:127]
v_add_f32 v20, v100, v84
v_add_f32 v21, v101, v85
v_mfma_f32_16x16x32_bf16 a[132:135], v[60:63], v[184:187], a[132:135]
v_add_f32 v16, v16, v18
v_add_f32 v17, v17, v19
v_mfma_f32_16x16x32_bf16 a[140:143], v[60:63], v[160:163], a[140:143]
v_perm_b32 v108, v20, v16, s20
v_perm_b32 v109, v21, v17, s20
v_mfma_f32_16x16x32_bf16 a[148:151], v[60:63], v[148:151], a[148:151]
buffer_load_dwordx4 v15, s[8:11], s36 offen offset:1024 lds
v_mfma_f32_16x16x32_bf16 a[156:159], v[60:63], v[152:155], a[156:159]
v_lshlrev_b64 v[22:23], 16, v[102:103]
v_lshlrev_b64 v[24:25], 16, v[86:87]
v_mfma_f32_16x16x32_bf16 a[164:167], v[60:63], v[172:175], a[164:167]
v_add_f32 v26, v102, v86
v_add_f32 v27, v103, v87
v_mfma_f32_16x16x32_bf16 a[172:175], v[60:63], v[156:159], a[172:175]
v_add_f32 v22, v22, v24
v_add_f32 v23, v23, v25
v_cvt_pk_bf16_f32 v110, v22, v26
v_perm_b32 v111, v27, v23, s20
v_mfma_f32_16x16x32_bf16 a[180:183], v[60:63], v[96:99], a[180:183]
s_add_u32 s36, s35, 2621440
ds_read_b128 v[176:179], v2 offset:37632
v_lshlrev_b32 v9, 4, v0
v_mfma_f32_16x16x32_bf16 a[188:191], v[60:63], v[108:111], a[188:191]
s_add_u32 m0, s30, 4096
ds_read_b128 v[128:131], v2 offset:37888
v_mov_b32 v10, s40
v_mfma_f32_16x16x32_bf16 a[4:7], v[44:47], v[164:167], a[4:7]
buffer_load_dwordx4 v14, s[8:11], s36 offen offset:0 lds
v_mfma_f32_16x16x32_bf16 a[12:15], v[44:47], v[116:119], a[12:15]
v_add_u32 v5, s38, v9
v_add_u32 v6, s39, v9
v_mfma_f32_16x16x32_bf16 a[20:23], v[44:47], v[120:123], a[20:23]
v_xor_b32 v8, 8192, v6
v_add_u32 v6, 139264, v6
v_mfma_f32_16x16x32_bf16 a[28:31], v[44:47], v[124:127], a[28:31]
v_add_u32 v8, 139264, v8
v_lshlrev_b64 v[16:17], 16, v[44:45]
v_mfma_f32_16x16x32_bf16 a[36:39], v[44:47], v[104:107], a[36:39]
v_lshlrev_b64 v[18:19], 16, v[48:49]
v_add_f32 v20, v44, v48
v_mfma_f32_16x16x32_bf16 a[44:47], v[44:47], v[80:83], a[44:47]
v_add_f32 v21, v45, v49
v_add_f32 v16, v16, v18
v_mfma_f32_16x16x32_bf16 a[52:55], v[44:47], v[76:79], a[52:55]
buffer_load_dwordx4 v15, s[8:11], s36 offen offset:1024 lds
v_mfma_f32_16x16x32_bf16 a[60:63], v[44:47], v[84:87], a[60:63]
v_add_f32 v17, v17, v19
v_perm_b32 v64, v20, v16, s20
v_mfma_f32_16x16x32_bf16 a[68:71], v[48:51], v[140:143], a[68:71]
v_perm_b32 v65, v21, v17, s20
v_lshlrev_b64 v[22:23], 16, v[46:47]
v_mfma_f32_16x16x32_bf16 a[76:79], v[48:51], v[132:135], a[76:79]
v_lshlrev_b64 v[24:25], 16, v[50:51]
v_add_f32 v26, v46, v50
v_mfma_f32_16x16x32_bf16 a[84:87], v[48:51], v[144:147], a[84:87]
v_add_f32 v27, v47, v51
v_add_f32 v22, v22, v24
v_mfma_f32_16x16x32_bf16 a[92:95], v[48:51], v[112:115], a[92:95]
v_add_f32 v23, v23, v25
v_cvt_pk_bf16_f32 v66, v22, v26
v_mfma_f32_16x16x32_bf16 a[100:103], v[48:51], v[92:95], a[100:103]
ds_read_b128 v[180:183], v2 offset:38144
v_perm_b32 v67, v27, v23, s20
v_mfma_f32_16x16x32_bf16 a[108:111], v[48:51], v[88:91], a[108:111]
s_waitcnt lgkmcnt(3)
ds_read_b128 v[164:167], v2 offset:38400
v_lshlrev_b64 v[16:17], 16, v[168:169]
v_mfma_f32_16x16x32_bf16 a[116:119], v[48:51], v[100:103], a[116:119]
v_lshlrev_b64 v[18:19], 16, v[136:137]
v_add_f32 v20, v168, v136
v_mfma_f32_16x16x32_bf16 a[124:127], v[48:51], v[168:171], a[124:127]
s_lshl_b32 s39, s29, 2
v_add_f32 v21, v169, v137
v_add_f32 v16, v16, v18
v_mfma_f32_16x16x32_bf16 a[132:135], v[64:67], v[160:163], a[132:135]
s_xor_b32 s38, s24, 2
v_add_f32 v17, v17, v19
v_perm_b32 v140, v20, v16, s20
v_mfma_f32_16x16x32_bf16 a[140:143], v[64:67], v[148:151], a[140:143]
v_perm_b32 v141, v21, v17, s20
v_lshlrev_b64 v[22:23], 16, v[170:171]
v_mfma_f32_16x16x32_bf16 a[148:151], v[64:67], v[152:155], a[148:151]
v_lshlrev_b64 v[24:25], 16, v[138:139]
v_add_f32 v26, v170, v138
v_mfma_f32_16x16x32_bf16 a[156:159], v[64:67], v[172:175], a[156:159]
v_add_f32 v27, v171, v139
v_add_f32 v22, v22, v24
v_mfma_f32_16x16x32_bf16 a[164:167], v[64:67], v[156:159], a[164:167]
v_add_f32 v23, v23, v25
v_cvt_pk_bf16_f32 v142, v22, v26
v_mfma_f32_16x16x32_bf16 a[172:175], v[64:67], v[96:99], a[172:175]
s_add_u32 s39, s39, s24
v_perm_b32 v143, v27, v23, s20
v_lshlrev_b64 v[16:17], 16, v[36:37]
v_mfma_f32_16x16x32_bf16 a[180:183], v[64:67], v[108:111], a[180:183]
v_lshlrev_b64 v[18:19], 16, v[40:41]
v_add_f32 v20, v36, v40
v_mfma_f32_16x16x32_bf16 a[188:191], v[64:67], v[140:143], a[188:191]
s_mul_i32 s38, s38, 9216
v_add_f32 v21, v37, v41
v_add_f32 v16, v16, v18
v_mfma_f32_16x16x32_bf16 a[4:7], v[36:39], v[116:119], a[4:7]
s_waitcnt vmcnt(10)
v_add_f32 v17, v17, v19
v_perm_b32 v68, v20, v16, s20
v_mfma_f32_16x16x32_bf16 a[12:15], v[36:39], v[120:123], a[12:15]
s_barrier
ds_read_b64_tr_b16 v[28:29], v3 offset:16384
v_perm_b32 v69, v21, v17, s20
v_mfma_f32_16x16x32_bf16 a[20:23], v[36:39], v[124:127], a[20:23]
s_lshl_b32 s39, s39, 13
ds_read_b64_tr_b16 v[30:31], v3 offset:16896
v_lshlrev_b64 v[22:23], 16, v[38:39]
v_mfma_f32_16x16x32_bf16 a[28:31], v[36:39], v[104:107], a[28:31]
ds_read_b64_tr_b16 v[32:33], v4 offset:16384
v_lshlrev_b64 v[24:25], 16, v[42:43]
v_mfma_f32_16x16x32_bf16 a[36:39], v[36:39], v[80:83], a[36:39]
ds_read_b64_tr_b16 v[34:35], v4 offset:16896
v_add_f32 v26, v38, v42
v_mfma_f32_16x16x32_bf16 a[44:47], v[36:39], v[76:79], a[44:47]
ds_read_b64_tr_b16 v[44:45], v3 offset:20480
v_add_f32 v27, v39, v43
v_mfma_f32_16x16x32_bf16 a[52:55], v[36:39], v[84:87], a[52:55]
ds_read_b64_tr_b16 v[46:47], v3 offset:20992
v_add_f32 v22, v22, v24
v_mfma_f32_16x16x32_bf16 a[60:63], v[36:39], v[136:139], a[60:63]
ds_read_b64_tr_b16 v[48:49], v4 offset:20480
v_add_f32 v23, v23, v25
v_mfma_f32_16x16x32_bf16 a[68:71], v[40:43], v[132:135], a[68:71]
ds_read_b64_tr_b16 v[50:51], v4 offset:20992
v_cvt_pk_bf16_f32 v70, v22, v26
v_mfma_f32_16x16x32_bf16 a[76:79], v[40:43], v[144:147], a[76:79]
s_add_u32 s36, s35, 4718592
ds_read_b128 v[196:199], v2 offset:38656
v_perm_b32 v71, v27, v23, s20
v_mfma_f32_16x16x32_bf16 a[84:87], v[40:43], v[112:115], a[84:87]
s_waitcnt lgkmcnt(11)
ds_read_b128 v[192:195], v2 offset:38912
v_lshlrev_b64 v[16:17], 16, v[176:177]
v_mfma_f32_16x16x32_bf16 a[92:95], v[40:43], v[92:95], a[92:95]
s_add_u32 m0, s30, 8192
v_lshlrev_b64 v[18:19], 16, v[128:129]
v_add_f32 v20, v176, v128
v_mfma_f32_16x16x32_bf16 a[100:103], v[40:43], v[88:91], a[100:103]
s_lshl_b32 s33, s24, 13
buffer_load_dwordx4 v14, s[8:11], s36 offen offset:0 lds
v_mfma_f32_16x16x32_bf16 a[108:111], v[40:43], v[100:103], a[108:111]
v_add_f32 v21, v177, v129
v_add_f32 v16, v16, v18
v_mfma_f32_16x16x32_bf16 a[116:119], v[40:43], v[168:171], a[116:119]
v_add_f32 v17, v17, v19
v_perm_b32 v116, v20, v16, s20
v_mfma_f32_16x16x32_bf16 a[124:127], v[40:43], v[176:179], a[124:127]
v_perm_b32 v117, v21, v17, s20
v_lshlrev_b64 v[22:23], 16, v[178:179]
v_mfma_f32_16x16x32_bf16 a[132:135], v[68:71], v[148:151], a[132:135]
ds_read_b128 v[188:191], v2 offset:39168
v_lshlrev_b64 v[24:25], 16, v[130:131]
v_mfma_f32_16x16x32_bf16 a[140:143], v[68:71], v[152:155], a[140:143]
ds_read_b128 v[132:135], v2 offset:39424
v_add_f32 v26, v178, v130
v_mfma_f32_16x16x32_bf16 a[148:151], v[68:71], v[172:175], a[148:151]
buffer_load_dwordx4 v15, s[8:11], s36 offen offset:1024 lds
v_mfma_f32_16x16x32_bf16 a[156:159], v[68:71], v[156:159], a[156:159]
v_add_f32 v27, v179, v131
v_add_f32 v22, v22, v24
v_mfma_f32_16x16x32_bf16 a[164:167], v[68:71], v[96:99], a[164:167]
v_add_f32 v23, v23, v25
v_cvt_pk_bf16_f32 v118, v22, v26
v_mfma_f32_16x16x32_bf16 a[172:175], v[68:71], v[108:111], a[172:175]
v_perm_b32 v119, v27, v23, s20
v_lshlrev_b64 v[16:17], 16, v[52:53]
v_mfma_f32_16x16x32_bf16 a[180:183], v[68:71], v[140:143], a[180:183]
s_add_u32 s36, s35, 6815744
v_lshlrev_b64 v[18:19], 16, v[56:57]
v_add_f32 v20, v52, v56
v_mfma_f32_16x16x32_bf16 a[188:191], v[68:71], v[116:119], a[188:191]
s_add_u32 m0, s30, 12288
v_add_f32 v21, v53, v57
v_add_f32 v16, v16, v18
v_mfma_f32_16x16x32_bf16 a[4:7], v[52:55], v[120:123], a[4:7]
buffer_load_dwordx4 v14, s[8:11], s36 offen offset:0 lds
v_mfma_f32_16x16x32_bf16 a[12:15], v[52:55], v[124:127], a[12:15]
v_add_f32 v17, v17, v19
v_perm_b32 v72, v20, v16, s20
v_mfma_f32_16x16x32_bf16 a[20:23], v[52:55], v[104:107], a[20:23]
v_perm_b32 v73, v21, v17, s20
v_lshlrev_b64 v[22:23], 16, v[54:55]
v_mfma_f32_16x16x32_bf16 a[28:31], v[52:55], v[80:83], a[28:31]
v_lshlrev_b64 v[24:25], 16, v[58:59]
v_add_f32 v26, v54, v58
v_mfma_f32_16x16x32_bf16 a[36:39], v[52:55], v[76:79], a[36:39]
v_add_f32 v27, v55, v59
v_add_f32 v22, v22, v24
v_mfma_f32_16x16x32_bf16 a[44:47], v[52:55], v[84:87], a[44:47]
v_add_f32 v23, v23, v25
v_cvt_pk_bf16_f32 v74, v22, v26
v_mfma_f32_16x16x32_bf16 a[52:55], v[52:55], v[136:139], a[52:55]
buffer_load_dwordx4 v15, s[8:11], s36 offen offset:1024 lds
v_mfma_f32_16x16x32_bf16 a[60:63], v[52:55], v[128:131], a[60:63]
ds_read_b128 v[204:207], v2 offset:39680
v_perm_b32 v75, v27, v23, s20
v_mfma_f32_16x16x32_bf16 a[68:71], v[56:59], v[144:147], a[68:71]
s_waitcnt lgkmcnt(13)
ds_read_b128 v[200:203], v2 offset:39936
v_lshlrev_b64 v[16:17], 16, v[180:181]
v_mfma_f32_16x16x32_bf16 a[76:79], v[56:59], v[112:115], a[76:79]
v_lshlrev_b64 v[18:19], 16, v[164:165]
v_add_f32 v20, v180, v164
v_mfma_f32_16x16x32_bf16 a[84:87], v[56:59], v[92:95], a[84:87]
v_add_f32 v21, v181, v165
v_add_f32 v16, v16, v18
v_mfma_f32_16x16x32_bf16 a[92:95], v[56:59], v[88:91], a[92:95]
L_pad6:
s_cbranch_execz L_pad10
v_add_f32 v17, v17, v19
v_perm_b32 v120, v20, v16, s20
v_mfma_f32_16x16x32_bf16 a[100:103], v[56:59], v[100:103], a[100:103]
v_perm_b32 v121, v21, v17, s20
v_lshlrev_b64 v[22:23], 16, v[182:183]
v_mfma_f32_16x16x32_bf16 a[108:111], v[56:59], v[168:171], a[108:111]
v_lshlrev_b64 v[24:25], 16, v[166:167]
v_add_f32 v26, v182, v166
v_mfma_f32_16x16x32_bf16 a[116:119], v[56:59], v[176:179], a[116:119]
v_add_f32 v27, v183, v167
v_add_f32 v22, v22, v24
v_mfma_f32_16x16x32_bf16 a[124:127], v[56:59], v[180:183], a[124:127]
v_add_f32 v23, v23, v25
v_cvt_pk_bf16_f32 v122, v22, v26
v_mfma_f32_16x16x32_bf16 a[132:135], v[72:75], v[152:155], a[132:135]
v_perm_b32 v123, v27, v23, s20
v_add_u32 v7, s38, v9
v_mfma_f32_16x16x32_bf16 a[140:143], v[72:75], v[172:175], a[140:143]
v_add_u32 v9, s39, v9
v_accvgpr_read_b32 v144, a193
v_mfma_f32_16x16x32_bf16 a[148:151], v[72:75], v[156:159], a[148:151]
v_mov_b32 v145, 0
v_readfirstlane_b32 s0, v144
v_mfma_f32_16x16x32_bf16 a[156:159], v[72:75], v[96:99], a[156:159]
s_waitcnt lgkmcnt(10)
v_lshlrev_b64 v[16:17], 16, v[28:29]
v_lshlrev_b64 v[18:19], 16, v[32:33]
v_mfma_f32_16x16x32_bf16 a[164:167], v[72:75], v[108:111], a[164:167]
v_add_f32 v20, v28, v32
v_add_f32 v21, v29, v33
v_mfma_f32_16x16x32_bf16 a[172:175], v[72:75], v[140:143], a[172:175]
v_add_f32 v16, v16, v18
v_add_f32 v17, v17, v19
v_mfma_f32_16x16x32_bf16 a[180:183], v[72:75], v[116:119], a[180:183]
v_perm_b32 v60, v20, v16, s20
v_perm_b32 v61, v21, v17, s20
s_cmp_eq_u32 s31, 1
s_cbranch_scc1 L_ks1
v_mfma_f32_16x16x32_bf16 a[188:191], v[72:75], v[120:123], a[188:191]
v_lshlrev_b64 v[22:23], 16, v[30:31]
v_lshlrev_b64 v[24:25], 16, v[34:35]
v_mfma_f32_16x16x32_bf16 a[100:103], v[32:35], v[168:171], a[100:103]
s_waitcnt vmcnt(8) lgkmcnt(6)
v_add_f32 v26, v30, v34
v_add_f32 v27, v31, v35
v_mfma_f32_16x16x32_bf16 a[108:111], v[32:35], v[176:179], a[108:111]
s_barrier
ds_read_b64_tr_b16 v[36:37], v3 offset:24576
v_add_f32 v22, v22, v24
v_mfma_f32_16x16x32_bf16 a[116:119], v[32:35], v[180:183], a[116:119]
s_waitcnt lgkmcnt(6)
ds_read_b64_tr_b16 v[38:39], v3 offset:25088
v_add_f32 v23, v23, v25
v_mfma_f32_16x16x32_bf16 a[124:127], v[32:35], v[196:199], a[124:127]
ds_read_b64_tr_b16 v[40:41], v4 offset:24576
v_cvt_pk_bf16_f32 v62, v22, v26
v_mfma_f32_16x16x32_bf16 a[100:103], v[48:51], v[176:179], a[100:103]
ds_read_b64_tr_b16 v[42:43], v4 offset:25088
v_perm_b32 v63, v27, v23, s20
v_mfma_f32_16x16x32_bf16 a[108:111], v[48:51], v[180:183], a[108:111]
ds_read_b64_tr_b16 v[52:53], v3 offset:28672
v_lshlrev_b64 v[16:17], 16, v[44:45]
v_mfma_f32_16x16x32_bf16 a[116:119], v[48:51], v[196:199], a[116:119]
s_waitcnt lgkmcnt(8)
ds_read_b64_tr_b16 v[54:55], v3 offset:29184
v_lshlrev_b64 v[18:19], 16, v[48:49]
v_mfma_f32_16x16x32_bf16 a[124:127], v[48:51], v[188:191], a[124:127]
ds_read_b64_tr_b16 v[56:57], v4 offset:28672
v_add_f32 v20, v44, v48
v_mfma_f32_16x16x32_bf16 a[36:39], v[28:31], v[84:87], a[36:39]
s_mov_b32 s22, 0x3f800000
ds_read_b64_tr_b16 v[58:59], v4 offset:29184
v_add_f32 v21, v45, v49
v_mfma_f32_16x16x32_bf16 a[44:47], v[28:31], v[136:139], a[44:47]
s_mov_b32 s21, 0x3f80
v_add_f32 v16, v16, v18
v_add_f32 v17, v17, v19
v_mfma_f32_16x16x32_bf16 a[52:55], v[28:31], v[128:131], a[52:55]
s_add_u32 s36, s35, 8912896
v_perm_b32 v64, v20, v16, s20
v_perm_b32 v65, v21, v17, s20
v_mfma_f32_16x16x32_bf16 a[60:63], v[28:31], v[164:167], a[60:63]
s_add_u32 m0, s30, 16384
v_lshlrev_b64 v[22:23], 16, v[46:47]
v_lshlrev_b64 v[24:25], 16, v[50:51]
v_mfma_f32_16x16x32_bf16 a[4:7], v[28:31], v[124:127], a[4:7]
s_waitcnt lgkmcnt(4)
buffer_load_dwordx4 v14, s[8:11], s36 offen offset:0 lds
v_mfma_f32_16x16x32_bf16 a[100:103], v[40:43], v[180:183], a[100:103]
s_add_u32 s33, s33, 4096
v_add_f32 v26, v46, v50
v_add_f32 v27, v47, v51
v_mfma_f32_16x16x32_bf16 a[108:111], v[40:43], v[196:199], a[108:111]
s_add_u32 s0, s0, 1
v_add_f32 v22, v22, v24
v_add_f32 v23, v23, v25
v_mfma_f32_16x16x32_bf16 a[116:119], v[40:43], v[188:191], a[116:119]
v_cvt_pk_bf16_f32 v66, v22, v26
v_perm_b32 v67, v27, v23, s20
v_mfma_f32_16x16x32_bf16 a[124:127], v[40:43], v[204:207], a[124:127]
v_lshlrev_b64 v[16:17], 16, v[36:37]
v_lshlrev_b64 v[18:19], 16, v[40:41]
v_mfma_f32_16x16x32_bf16 a[36:39], v[44:47], v[136:139], a[36:39]
v_add_f32 v20, v36, v40
v_add_f32 v21, v37, v41
v_mfma_f32_16x16x32_bf16 a[44:47], v[44:47], v[128:131], a[44:47]
buffer_load_dwordx4 v15, s[8:11], s36 offen offset:1024 lds
v_mfma_f32_16x16x32_bf16 a[52:55], v[44:47], v[164:167], a[52:55]
ds_write_b128 v5, a[100:103] offset:0
v_add_f32 v16, v16, v18
v_mfma_f32_16x16x32_bf16 a[60:63], v[44:47], v[192:195], a[60:63]
s_add_u32 s36, s35, 11010048
v_add_f32 v17, v17, v19
v_perm_b32 v68, v20, v16, s20
v_mfma_f32_16x16x32_bf16 a[4:7], v[44:47], v[104:107], a[4:7]
s_xor_b32 s101, s29, 1
v_perm_b32 v69, v21, v17, s20
v_lshlrev_b64 v[22:23], 16, v[38:39]
v_mfma_f32_16x16x32_bf16 a[36:39], v[36:39], v[128:131], a[36:39]
s_add_u32 m0, s30, 20480
v_lshlrev_b64 v[24:25], 16, v[42:43]
v_add_f32 v26, v38, v42
v_mfma_f32_16x16x32_bf16 a[44:47], v[36:39], v[164:167], a[44:47]
s_waitcnt lgkmcnt(3)
ds_write_b128 v5, a[108:111] offset:1024
v_add_f32 v27, v39, v43
v_mfma_f32_16x16x32_bf16 a[36:39], v[52:55], v[164:167], a[36:39]
buffer_load_dwordx4 v14, s[8:11], s36 offen offset:0 lds
v_mfma_f32_16x16x32_bf16 a[44:47], v[52:55], v[192:195], a[44:47]
v_add_f32 v22, v22, v24
v_add_f32 v23, v23, v25
v_mfma_f32_16x16x32_bf16 a[52:55], v[36:39], v[192:195], a[52:55]
v_cvt_pk_bf16_f32 v70, v22, v26
v_perm_b32 v71, v27, v23, s20
v_mfma_f32_16x16x32_bf16 a[60:63], v[36:39], v[132:135], a[60:63]
s_lshl_b32 s101, s101, 2
ds_write_b128 v5, a[116:119] offset:2048
v_mov_b32_dpp v212, v152 row_shl:1 row_mask:0xf bank_mask:0xf bound_ctrl:0
v_mfma_f32_16x16x32_bf16 a[4:7], v[36:39], v[80:83], a[4:7]
v_mov_b32_dpp v213, v153 row_shl:1 row_mask:0xf bank_mask:0xf bound_ctrl:0
v_mov_b32_dpp v214, v154 row_shl:1 row_mask:0xf bank_mask:0xf bound_ctrl:0
v_mfma_f32_16x16x32_bf16 a[52:55], v[52:55], v[132:135], a[52:55]
v_mov_b32_dpp v215, v155 row_shl:1 row_mask:0xf bank_mask:0xf bound_ctrl:0
v_mov_b32_dpp v208, v172 row_shl:1 row_mask:0xf bank_mask:0xf bound_ctrl:0
v_mfma_f32_16x16x32_bf16 a[60:63], v[52:55], v[200:203], a[60:63]
buffer_load_dwordx4 v15, s[8:11], s36 offen offset:1024 lds
v_mfma_f32_16x16x32_bf16 a[4:7], v[52:55], v[76:79], a[4:7]
ds_write_b128 v5, a[124:127] offset:3072
v_mov_b32_dpp v209, v173 row_shl:1 row_mask:0xf bank_mask:0xf bound_ctrl:0
v_mfma_f32_16x16x32_bf16 a[164:167], v[60:63], v[140:143], a[164:167]
v_mov_b32_dpp v210, v174 row_shl:1 row_mask:0xf bank_mask:0xf bound_ctrl:0
v_mov_b32_dpp v211, v175 row_shl:1 row_mask:0xf bank_mask:0xf bound_ctrl:0
v_mfma_f32_16x16x32_bf16 a[172:175], v[60:63], v[116:119], a[172:175]
s_add_u32 s101, s101, s24
v_accvgpr_read_b32 v216, a36
v_accvgpr_read_b32 v217, a37
v_mfma_f32_16x16x32_bf16 a[164:167], v[64:67], v[116:119], a[164:167]
v_accvgpr_read_b32 v218, a38
v_accvgpr_read_b32 v219, a39
v_mfma_f32_16x16x32_bf16 a[172:175], v[64:67], v[120:123], a[172:175]
ds_write_b128 v5, a[36:39] offset:4096
v_mov_b32_dpp v144, v156 row_shl:1 row_mask:0xf bank_mask:0xf bound_ctrl:0
v_mfma_f32_16x16x32_bf16 a[164:167], v[68:71], v[120:123], a[164:167]
v_mov_b32_dpp v145, v157 row_shl:1 row_mask:0xf bank_mask:0xf bound_ctrl:0
v_mov_b32_dpp v146, v158 row_shl:1 row_mask:0xf bank_mask:0xf bound_ctrl:0
v_mfma_f32_16x16x32_bf16 a[172:175], v[68:71], v[212:215], a[172:175]
v_mov_b32_dpp v147, v159 row_shl:1 row_mask:0xf bank_mask:0xf bound_ctrl:0
v_mov_b32_dpp v124, v96 row_shl:1 row_mask:0xf bank_mask:0xf bound_ctrl:0
v_mfma_f32_16x16x32_bf16 a[164:167], v[52:55], v[212:215], a[164:167]
v_mov_b32_dpp v125, v97 row_shl:1 row_mask:0xf bank_mask:0xf bound_ctrl:0
v_mov_b32_dpp v126, v98 row_shl:1 row_mask:0xf bank_mask:0xf bound_ctrl:0
v_mfma_f32_16x16x32_bf16 a[172:175], v[52:55], v[208:211], a[172:175]
s_lshl_b32 s101, s101, 13
ds_write_b128 v5, a[44:47] offset:5120
v_mov_b32_dpp v127, v99 row_shl:1 row_mask:0xf bank_mask:0xf bound_ctrl:0
v_mfma_f32_16x16x32_bf16 a[180:183], v[60:63], v[120:123], a[180:183]
ds_read_b128 a[212:215], v1 offset:38656
v_accvgpr_read_b32 v220, a4
v_mfma_f32_16x16x32_bf16 a[188:191], v[60:63], v[212:215], a[188:191]
ds_read_b128 a[204:207], v1 offset:40448
v_accvgpr_read_b32 v221, a5
v_mfma_f32_16x16x32_bf16 a[180:183], v[64:67], v[212:215], a[180:183]
ds_read_b128 a[216:219], v1 offset:38400
v_accvgpr_read_b32 v222, a6
v_mfma_f32_16x16x32_bf16 a[188:191], v[64:67], v[208:211], a[188:191]
ds_write_b128 v5, a[52:55] offset:6144
v_accvgpr_read_b32 v223, a7
v_mfma_f32_16x16x32_bf16 a[180:183], v[68:71], v[208:211], a[180:183]
ds_read_b128 a[228:231], v1 offset:36864
v_xor_b32 v11, 32768, v9
v_mfma_f32_16x16x32_bf16 a[188:191], v[68:71], v[144:147], a[188:191]
ds_read_b128 a[224:227], v1 offset:37376
v_mfma_f32_16x16x32_bf16 a[180:183], v[52:55], v[144:147], a[180:183]
ds_read_b128 a[220:223], v1 offset:37888
v_mfma_f32_16x16x32_bf16 a[188:191], v[52:55], v[124:127], a[188:191]
ds_write_b128 v5, a[60:63] offset:7168
v_mfma_f32_16x16x32_bf16 a[12:15], v[28:31], v[104:107], a[12:15]
s_waitcnt lgkmcnt(15)
ds_read_b128 a[208:211], v1 offset:38912
v_mfma_f32_16x16x32_bf16 a[20:23], v[28:31], v[80:83], a[20:23]
s_waitcnt lgkmcnt(15)
ds_read_b128 a[236:239], v1 offset:39424
v_mfma_f32_16x16x32_bf16 a[28:31], v[28:31], v[76:79], a[28:31]
s_waitcnt lgkmcnt(15)
ds_read_b128 a[232:235], v1 offset:39936
v_mfma_f32_16x16x32_bf16 a[68:71], v[32:35], v[112:115], a[68:71]
s_waitcnt lgkmcnt(15)
ds_write_b128 v5, a[4:7] offset:8192
v_mfma_f32_16x16x32_bf16 a[76:79], v[32:35], v[92:95], a[76:79]
s_waitcnt lgkmcnt(15)
ds_read_b128 a[248:251], v1 offset:37120
v_mfma_f32_16x16x32_bf16 a[84:87], v[32:35], v[88:91], a[84:87]
s_waitcnt lgkmcnt(15)
ds_read_b128 a[244:247], v1 offset:37632
v_mfma_f32_16x16x32_bf16 a[92:95], v[32:35], v[100:103], a[92:95]
s_waitcnt lgkmcnt(15)
ds_read_b128 a[240:243], v1 offset:38144
v_mfma_f32_16x16x32_bf16 a[12:15], v[44:47], v[80:83], a[12:15]
s_waitcnt lgkmcnt(15)
ds_write_b128 v6, a[164:167] offset:0
v_mfma_f32_16x16x32_bf16 a[20:23], v[44:47], v[76:79], a[20:23]
s_waitcnt lgkmcnt(15)
ds_read_b128 a[252:255], v1 offset:39168
v_mfma_f32_16x16x32_bf16 a[28:31], v[44:47], v[84:87], a[28:31]
s_waitcnt lgkmcnt(15)
v_mfma_f32_16x16x32_bf16 a[68:71], v[48:51], v[92:95], a[68:71]
v_mfma_f32_16x16x32_bf16 a[76:79], v[48:51], v[88:91], a[76:79]
ds_write_b128 v6, a[172:175] offset:1024
v_mfma_f32_16x16x32_bf16 a[84:87], v[48:51], v[100:103], a[84:87]
s_waitcnt lgkmcnt(15)
v_mfma_f32_16x16x32_bf16 a[92:95], v[48:51], v[168:171], a[92:95]
v_mfma_f32_16x16x32_bf16 a[12:15], v[36:39], v[76:79], a[12:15]
v_mfma_f32_16x16x32_bf16 a[20:23], v[36:39], v[84:87], a[20:23]
ds_write_b128 v6, a[180:183] offset:2048
v_mfma_f32_16x16x32_bf16 a[68:71], v[40:43], v[88:91], a[68:71]
s_waitcnt lgkmcnt(15)
v_mfma_f32_16x16x32_bf16 a[76:79], v[40:43], v[100:103], a[76:79]
v_mfma_f32_16x16x32_bf16 a[12:15], v[52:55], v[84:87], a[12:15]
v_mfma_f32_16x16x32_bf16 a[20:23], v[52:55], v[136:139], a[20:23]
ds_write_b128 v6, a[188:191] offset:3072
v_mfma_f32_16x16x32_bf16 a[132:135], v[60:63], v[172:175], a[132:135]
s_waitcnt vmcnt(8) lgkmcnt(0)
v_mfma_f32_16x16x32_bf16 a[140:143], v[60:63], v[156:159], a[140:143]
s_barrier
ds_read_b128 v[164:167], v7 offset:0
v_accvgpr_read_b32 v84, a68
v_mfma_f32_16x16x32_bf16 a[132:135], v[64:67], v[156:159], a[132:135]
ds_read_b128 v[100:103], v7 offset:4096
v_accvgpr_read_b32 v85, a69
v_mfma_f32_16x16x32_bf16 a[140:143], v[64:67], v[96:99], a[140:143]
ds_read_b128 v[92:95], v8 offset:0
v_accvgpr_read_b32 v86, a70
v_mfma_f32_16x16x32_bf16 a[132:135], v[68:71], v[96:99], a[132:135]
ds_read_b128 v[88:91], v7 offset:5120
v_accvgpr_read_b32 v87, a71
v_mfma_f32_16x16x32_bf16 a[140:143], v[68:71], v[108:111], a[140:143]
ds_read_b64_tr_b16 v[28:29], v3 offset:0
v_accvgpr_read_b32 v76, a12
v_mfma_f32_16x16x32_bf16 a[132:135], v[52:55], v[108:111], a[132:135]
ds_read_b64_tr_b16 v[30:31], v3 offset:512
v_accvgpr_read_b32 v77, a13
v_mfma_f32_16x16x32_bf16 a[140:143], v[52:55], v[140:143], a[140:143]
ds_read_b64_tr_b16 v[32:33], v4 offset:0
v_accvgpr_read_b32 v78, a14
v_mfma_f32_16x16x32_bf16 a[28:31], v[36:39], v[136:139], a[28:31]
ds_read_b64_tr_b16 v[34:35], v4 offset:512
v_accvgpr_read_b32 v79, a15
v_mfma_f32_16x16x32_bf16 a[84:87], v[40:43], v[168:171], a[84:87]
s_waitcnt lgkmcnt(7)
ds_read_b64_tr_b16 v[44:45], v3 offset:4096
v_add_f32 v84, v84, v164
v_mfma_f32_16x16x32_bf16 a[92:95], v[40:43], v[176:179], a[92:95]
ds_read_b64_tr_b16 v[46:47], v3 offset:4608
v_add_f32 v85, v85, v165
v_mfma_f32_16x16x32_bf16 a[28:31], v[52:55], v[128:131], a[28:31]
ds_read_b64_tr_b16 v[48:49], v4 offset:4096
v_add_f32 v86, v86, v166
v_mfma_f32_16x16x32_bf16 a[148:151], v[60:63], v[96:99], a[148:151]
s_add_u32 s36, s35, 13107200
ds_read_b64_tr_b16 v[50:51], v4 offset:4608
v_add_f32 v87, v87, v167
v_mfma_f32_16x16x32_bf16 a[156:159], v[60:63], v[108:111], a[156:159]
s_add_u32 m0, s30, 24576
ds_read_b128 v[104:107], v7 offset:1024
v_accvgpr_read_b32 v132, a132
v_mfma_f32_16x16x32_bf16 a[148:151], v[64:67], v[108:111], a[148:151]
buffer_load_dwordx4 v14, s[8:11], s36 offen offset:0 lds
v_mfma_f32_16x16x32_bf16 a[156:159], v[64:67], v[140:143], a[156:159]
buffer_load_dword v13, v10, s[16:19], 0 offen sc1
v_mfma_f32_16x16x32_bf16 a[148:151], v[68:71], v[140:143], a[148:151]
ds_read_b128 v[128:131], v8 offset:1024
v_accvgpr_read_b32 v133, a133
v_mfma_f32_16x16x32_bf16 a[156:159], v[68:71], v[116:119], a[156:159]
ds_read_b128 v[112:115], v7 offset:6144
v_accvgpr_read_b32 v134, a134
v_accvgpr_read_b32 v135, a135
v_mfma_f32_16x16x32_bf16 a[148:151], v[52:55], v[116:119], a[148:151]
s_waitcnt lgkmcnt(13)
buffer_load_dwordx4 v15, s[8:11], s36 offen offset:1024 lds
v_add_f32 v220, v220, v100
v_add_f32 v221, v221, v101
v_mfma_f32_16x16x32_bf16 a[156:159], v[52:55], v[120:123], a[156:159]
s_waitcnt lgkmcnt(9)
ds_read_b128 v[80:83], v7 offset:2048
v_add_f32 v222, v222, v102
v_add_f32 v223, v223, v103
v_add_f32 v132, v132, v92
v_mfma_f32_16x16x32_bf16 a[0:3], v[28:31], a[228:231], a[0:3]
s_add_u32 s36, s35, 15204352
ds_read_b128 v[100:103], v8 offset:2048
v_add_f32 v133, v133, v93
v_add_f32 v134, v134, v94
v_add_f32 v135, v135, v95
v_mfma_f32_16x16x32_bf16 a[8:11], v[28:31], a[224:227], a[8:11]
s_add_u32 m0, s30, 28672
ds_read_b128 v[92:95], v7 offset:7168
v_add_f32 v76, v76, v88
v_add_f32 v77, v77, v89
v_add_f32 v78, v78, v90
v_mfma_f32_16x16x32_bf16 a[16:19], v[28:31], a[220:223], a[16:19]
s_waitcnt lgkmcnt(10)
s_mul_i32 s38, s27, 2032640
buffer_load_dwordx4 v14, s[8:11], s36 offen offset:0 lds
v_add_f32 v79, v79, v91
v_lshlrev_b64 v[16:17], 16, v[28:29]
v_mfma_f32_16x16x32_bf16 a[24:27], v[28:31], a[216:219], a[24:27]
s_add_u32 s4, s58, s38
s_addc_u32 s5, s59, 0
ds_read_b128 v[180:183], v1 offset:39680
v_lshlrev_b64 v[18:19], 16, v[32:33]
v_add_f32 v20, v28, v32
v_add_f32 v21, v29, v33
v_mfma_f32_16x16x32_bf16 a[32:35], v[28:31], a[208:211], a[32:35]
s_mov_b32 s6, 2032640
ds_read_b128 a[228:231], v1 offset:40192
v_add_f32 v16, v16, v18
v_add_f32 v17, v17, v19
v_perm_b32 v60, v20, v16, s20
v_mfma_f32_16x16x32_bf16 a[40:43], v[28:31], a[236:239], a[40:43]
s_lshl_b32 s38, s25, 7
ds_read_b128 v[176:179], v1 offset:40704
v_perm_b32 v61, v21, v17, s20
v_lshlrev_b64 v[22:23], 16, v[30:31]
v_lshlrev_b64 v[24:25], 16, v[34:35]
v_mfma_f32_16x16x32_bf16 a[48:51], v[28:31], a[232:235], a[48:51]
s_lshl_b32 s39, s29, 6
buffer_load_dwordx4 v15, s[8:11], s36 offen offset:1024 lds
v_add_f32 v26, v30, v34
v_add_f32 v27, v31, v35
v_mfma_f32_16x16x32_bf16 a[56:59], v[28:31], a[204:207], a[56:59]
s_add_u32 s38, s38, s39
ds_read_b128 v[164:167], v7 offset:3072
v_add_f32 v22, v22, v24
v_add_f32 v23, v23, v25
v_cvt_pk_bf16_f32 v62, v22, v26
v_mfma_f32_16x16x32_bf16 a[64:67], v[32:35], a[248:251], a[64:67]
s_lshl_b32 s39, s32, 5
ds_read_b128 v[136:139], v8 offset:3072
v_perm_b32 v63, v27, v23, s20
v_sub_f32 v132, v132, v84
v_sub_f32 v133, v133, v85
v_mfma_f32_16x16x32_bf16 a[72:75], v[32:35], a[244:247], a[72:75]
s_add_u32 s38, s38, s39
ds_read_b128 v[88:91], v7 offset:8192
v_sub_f32 v134, v134, v86
v_sub_f32 v135, v135, v87
v_add_f32 v84, v84, v220
v_mfma_f32_16x16x32_bf16 a[80:83], v[32:35], a[240:243], a[80:83]
s_waitcnt lgkmcnt(15)
s_mul_i32 s39, s26, 253952
v_add_f32 v85, v85, v221
v_add_f32 v86, v86, v222
v_add_f32 v87, v87, v223
v_accvgpr_read_b32 v168, a76
v_mfma_f32_16x16x32_bf16 a[88:91], v[32:35], a[212:215], a[88:91]
s_add_u32 s38, s38, s39
v_accvgpr_read_b32 v169, a77
v_accvgpr_read_b32 v170, a78
v_accvgpr_read_b32 v171, a79
v_accvgpr_read_b32 v188, a140
v_mfma_f32_16x16x32_bf16 a[96:99], v[32:35], a[252:255], a[96:99]
s_waitcnt lgkmcnt(5)
s_lshl_b32 s40, s24, 16
v_accvgpr_read_b32 v189, a141
v_accvgpr_read_b32 v190, a142
v_accvgpr_read_b32 v191, a143
v_sub_f32 v132, v132, v76
v_mfma_f32_16x16x32_bf16 a[104:107], v[32:35], v[180:183], a[104:107]
s_waitcnt vmcnt(9) lgkmcnt(4)
s_add_u32 s40, s40, s39
ds_read_b128 a[248:251], v2 offset:36864
v_sub_f32 v133, v133, v77
v_sub_f32 v134, v134, v78
v_sub_f32 v135, v135, v79
v_mfma_f32_16x16x32_bf16 a[112:115], v[32:35], a[228:231], a[112:115]
s_waitcnt lgkmcnt(4)
s_barrier
s_lshl_b32 s39, s31, 13
ds_read_b64_tr_b16 v[36:37], v3 offset:8192
v_mov_b32 v199, s0
v_mov_b32 v195, s0
v_cvt_pk_bf16_f32 v196, v84, v132
v_mfma_f32_16x16x32_bf16 a[120:123], v[32:35], v[176:179], a[120:123]
s_add_u32 s38, s38, s39
ds_read_b64_tr_b16 v[38:39], v3 offset:8704
v_cvt_pk_bf16_f32 v197, v85, v133
v_cvt_pk_bf16_f32 v198, v86, v134
v_cvt_pk_bf16_f32 v192, v87, v135
v_mfma_f32_16x16x32_bf16 a[128:131], v[60:63], v[184:187], a[128:131]
s_lshl_b32 s41, s29, 8
ds_read_b64_tr_b16 v[40:41], v4 offset:8192
v_accvgpr_read_b32 v84, a20
v_accvgpr_read_b32 v85, a21
v_accvgpr_read_b32 v86, a22
v_mfma_f32_16x16x32_bf16 a[136:139], v[60:63], v[160:163], a[136:139]
s_lshl_b32 s39, s32, 7
ds_read_b64_tr_b16 v[42:43], v4 offset:8704
v_accvgpr_read_b32 v87, a23
v_add_f32 v168, v168, v104
v_add_f32 v169, v169, v105
v_mfma_f32_16x16x32_bf16 a[144:147], v[60:63], v[148:151], a[144:147]
s_add_u32 s41, s41, s39
ds_read_b64_tr_b16 v[52:53], v3 offset:12288
v_add_f32 v170, v170, v106
v_add_f32 v171, v171, v107
v_add_f32 v188, v188, v128
v_mfma_f32_16x16x32_bf16 a[152:155], v[60:63], v[152:155], a[152:155]
s_lshl_b32 s39, s26, 10
ds_read_b64_tr_b16 v[54:55], v3 offset:12800
v_add_f32 v189, v189, v129
v_add_f32 v190, v190, v130
v_add_f32 v191, v191, v131
v_mfma_f32_16x16x32_bf16 a[160:163], v[60:63], v[172:175], a[160:163]
s_lshl_b32 s37, s31, 9
ds_read_b64_tr_b16 v[56:57], v4 offset:12288
v_add_f32 v84, v84, v112
v_add_f32 v85, v85, v113
v_add_f32 v86, v86, v114
v_mfma_f32_16x16x32_bf16 a[168:171], v[60:63], v[156:159], a[168:171]
s_add_u32 s37, s37, s39
ds_read_b64_tr_b16 v[58:59], v4 offset:12800
v_add_f32 v87, v87, v115
v_sub_f32 v188, v188, v168
v_sub_f32 v189, v189, v169
v_mfma_f32_16x16x32_bf16 a[176:179], v[60:63], v[96:99], a[176:179]
s_mov_b32 s34, 0
buffer_store_dwordx4 v[196:199], v9, s[96:99], 0 offen offset:0 sc1
v_sub_f32 v190, v190, v170
v_sub_f32 v191, v191, v171
v_mfma_f32_16x16x32_bf16 a[184:187], v[60:63], v[108:111], a[184:187]
s_mov_b32 s47, 1048576
v_add_f32 v168, v168, v76
v_add_f32 v169, v169, v77
v_add_f32 v170, v170, v78
v_add_f32 v171, v171, v79
v_mfma_f32_16x16x32_bf16 a[0:3], v[44:47], a[224:227], a[0:3]
v_accvgpr_read_b32 v104, a84
v_accvgpr_read_b32 v105, a85
v_accvgpr_read_b32 v106, a86
v_accvgpr_read_b32 v107, a87
v_mfma_f32_16x16x32_bf16 a[8:11], v[44:47], a[220:223], a[8:11]
v_accvgpr_read_b32 v112, a148
v_accvgpr_read_b32 v113, a149
v_accvgpr_read_b32 v114, a150
v_accvgpr_read_b32 v115, a151
v_mfma_f32_16x16x32_bf16 a[16:19], v[44:47], a[216:219], a[16:19]
v_sub_f32 v188, v188, v84
v_sub_f32 v189, v189, v85
v_sub_f32 v190, v190, v86
v_sub_f32 v191, v191, v87
v_mfma_f32_16x16x32_bf16 a[24:27], v[44:47], a[208:211], a[24:27]
v_accvgpr_read_b32 v76, a28
v_accvgpr_read_b32 v77, a29
v_accvgpr_read_b32 v78, a30
v_accvgpr_read_b32 v79, a31
v_mfma_f32_16x16x32_bf16 a[32:35], v[44:47], a[236:239], a[32:35]
v_add_f32 v104, v104, v80
v_add_f32 v105, v105, v81
v_add_f32 v106, v106, v82
v_add_f32 v107, v107, v83
v_mfma_f32_16x16x32_bf16 a[40:43], v[44:47], a[232:235], a[40:43]
ds_read_b128 a[224:227], v2 offset:37120
v_add_f32 v112, v112, v100
v_add_f32 v113, v113, v101
v_add_f32 v114, v114, v102
v_mfma_f32_16x16x32_bf16 a[48:51], v[44:47], a[204:207], a[48:51]
s_waitcnt lgkmcnt(9)
v_add_f32 v115, v115, v103
v_mov_b32 v83, s0
v_cvt_pk_bf16_f32 v193, v168, v188
v_cvt_pk_bf16_f32 v194, v169, v189
v_mfma_f32_16x16x32_bf16 a[56:59], v[44:47], a[248:251], a[56:59]
v_cvt_pk_bf16_f32 v80, v170, v190
v_cvt_pk_bf16_f32 v81, v171, v191
v_add_f32 v76, v76, v92
v_add_f32 v77, v77, v93
v_mfma_f32_16x16x32_bf16 a[64:67], v[48:51], a[244:247], a[64:67]
v_add_f32 v78, v78, v94
v_add_f32 v79, v79, v95
v_sub_f32 v112, v112, v104
v_sub_f32 v113, v113, v105
v_mfma_f32_16x16x32_bf16 a[72:75], v[48:51], a[240:243], a[72:75]
v_sub_f32 v114, v114, v106
v_sub_f32 v115, v115, v107
v_add_f32 v104, v104, v84
v_add_f32 v105, v105, v85
v_mfma_f32_16x16x32_bf16 a[80:83], v[48:51], a[212:215], a[80:83]
buffer_store_dwordx4 v[192:195], v9, s[96:99], 0 offen offset:1024 sc1
v_add_f32 v106, v106, v86
v_add_f32 v107, v107, v87
v_mfma_f32_16x16x32_bf16 a[88:91], v[48:51], a[252:255], a[88:91]
v_lshlrev_b64 v[16:17], 16, v[44:45]
v_lshlrev_b64 v[18:19], 16, v[48:49]
v_add_f32 v20, v44, v48
v_add_f32 v21, v45, v49
v_mfma_f32_16x16x32_bf16 a[96:99], v[48:51], v[180:183], a[96:99]
v_add_f32 v16, v16, v18
v_add_f32 v17, v17, v19
v_perm_b32 v64, v20, v16, s20
v_perm_b32 v65, v21, v17, s20
v_mfma_f32_16x16x32_bf16 a[104:107], v[48:51], a[228:231], a[104:107]
v_lshlrev_b64 v[22:23], 16, v[46:47]
v_lshlrev_b64 v[24:25], 16, v[50:51]
v_add_f32 v26, v46, v50
v_add_f32 v27, v47, v51
v_mfma_f32_16x16x32_bf16 a[112:115], v[48:51], v[176:179], a[112:115]
s_waitcnt lgkmcnt(0)
v_add_f32 v22, v22, v24
v_add_f32 v23, v23, v25
v_cvt_pk_bf16_f32 v66, v22, v26
v_perm_b32 v67, v27, v23, s20
v_mfma_f32_16x16x32_bf16 a[120:123], v[48:51], a[224:227], a[120:123]
v_sub_f32 v112, v112, v76
v_sub_f32 v113, v113, v77
v_sub_f32 v114, v114, v78
v_sub_f32 v115, v115, v79
v_mfma_f32_16x16x32_bf16 a[128:131], v[64:67], v[160:163], a[128:131]
v_accvgpr_read_b32 v84, a92
v_accvgpr_read_b32 v85, a93
v_accvgpr_read_b32 v86, a94
v_accvgpr_read_b32 v87, a95
v_mfma_f32_16x16x32_bf16 a[136:139], v[64:67], v[148:151], a[136:139]
v_accvgpr_read_b32 v92, a156
v_accvgpr_read_b32 v93, a157
v_accvgpr_read_b32 v94, a158
v_accvgpr_read_b32 v95, a159
v_mfma_f32_16x16x32_bf16 a[144:147], v[64:67], v[152:155], a[144:147]
v_mov_b32 v103, s0
v_cvt_pk_bf16_f32 v82, v104, v112
v_cvt_pk_bf16_f32 v100, v105, v113
v_cvt_pk_bf16_f32 v101, v106, v114
v_mfma_f32_16x16x32_bf16 a[152:155], v[64:67], v[172:175], a[152:155]
v_cvt_pk_bf16_f32 v102, v107, v115
v_add_f32 v84, v84, v164
v_add_f32 v85, v85, v165
v_add_f32 v86, v86, v166
v_mfma_f32_16x16x32_bf16 a[160:163], v[64:67], v[156:159], a[160:163]
buffer_store_dwordx4 v[80:83], v9, s[96:99], 0 offen offset:2048 sc1
v_add_f32 v87, v87, v167
v_add_f32 v92, v92, v136
v_mfma_f32_16x16x32_bf16 a[168:171], v[64:67], v[96:99], a[168:171]
ds_read_b128 a[244:247], v2 offset:37376
v_add_f32 v93, v93, v137
v_add_f32 v94, v94, v138
v_add_f32 v95, v95, v139
v_mfma_f32_16x16x32_bf16 a[176:179], v[64:67], v[108:111], a[176:179]
v_add_f32 v216, v216, v88
v_add_f32 v217, v217, v89
v_mfma_f32_16x16x32_bf16 a[184:187], v[64:67], v[140:143], a[184:187]
v_add_f32 v218, v218, v90
v_add_f32 v219, v219, v91
v_mfma_f32_16x16x32_bf16 a[0:3], v[36:39], a[220:223], a[0:3]
s_waitcnt vmcnt(8)
ds_read_b128 v[80:83], v2 offset:37632
v_mov_b32 v216, v216
v_mov_b32 v217, v217
v_mov_b32 v218, v218
v_mfma_f32_16x16x32_bf16 a[8:11], v[36:39], a[216:219], a[8:11]
s_barrier
ds_read_b64_tr_b16 v[28:29], v3 offset:16384
v_mov_b32 v219, v219
v_sub_f32 v92, v92, v84
v_sub_f32 v93, v93, v85
v_mfma_f32_16x16x32_bf16 a[16:19], v[36:39], a[208:211], a[16:19]
ds_read_b64_tr_b16 v[30:31], v3 offset:16896
v_sub_f32 v94, v94, v86
v_sub_f32 v95, v95, v87
v_add_f32 v84, v84, v76
v_mfma_f32_16x16x32_bf16 a[24:27], v[36:39], a[236:239], a[24:27]
ds_read_b64_tr_b16 v[32:33], v4 offset:16384
v_add_f32 v85, v85, v77
v_add_f32 v86, v86, v78
v_add_f32 v87, v87, v79
v_mfma_f32_16x16x32_bf16 a[32:35], v[36:39], a[232:235], a[32:35]
ds_read_b64_tr_b16 v[34:35], v4 offset:16896
v_sub_f32 v92, v92, v216
v_mfma_f32_16x16x32_bf16 a[40:43], v[36:39], a[204:207], a[40:43]
ds_read_b64_tr_b16 v[44:45], v3 offset:20480
v_sub_f32 v93, v93, v217
v_mfma_f32_16x16x32_bf16 a[48:51], v[36:39], a[248:251], a[48:51]
s_waitcnt lgkmcnt(6)
ds_read_b64_tr_b16 v[46:47], v3 offset:20992
v_sub_f32 v94, v94, v218
v_sub_f32 v95, v95, v219
v_mfma_f32_16x16x32_bf16 a[56:59], v[36:39], a[244:247], a[56:59]
ds_read_b64_tr_b16 v[48:49], v4 offset:20480
v_mov_b32 v79, s0
v_mfma_f32_16x16x32_bf16 a[64:67], v[40:43], a[240:243], a[64:67]
ds_read_b64_tr_b16 v[50:51], v4 offset:20992
v_mov_b32 v91, s0
v_cvt_pk_bf16_f32 v76, v84, v92
v_cvt_pk_bf16_f32 v77, v85, v93
v_mfma_f32_16x16x32_bf16 a[72:75], v[40:43], a[212:215], a[72:75]
buffer_store_dwordx4 v[100:103], v9, s[96:99], 0 offen offset:3072 sc1
v_cvt_pk_bf16_f32 v78, v86, v94
v_cvt_pk_bf16_f32 v88, v87, v95
v_mfma_f32_16x16x32_bf16 a[80:83], v[40:43], a[252:255], a[80:83]
buffer_store_dwordx4 v[76:79], v9, s[96:99], s95 offen offset:0 sc1
v_lshlrev_b64 v[16:17], 16, v[36:37]
v_lshlrev_b64 v[18:19], 16, v[40:41]
v_mfma_f32_16x16x32_bf16 a[88:91], v[40:43], v[180:183], a[88:91]
v_add_f32 v20, v36, v40
v_add_f32 v21, v37, v41
v_add_f32 v16, v16, v18
v_add_f32 v17, v17, v19
v_mfma_f32_16x16x32_bf16 a[96:99], v[40:43], a[228:231], a[96:99]
L_pad7:
s_cbranch_execz L_pad11
v_perm_b32 v68, v20, v16, s20
v_perm_b32 v69, v21, v17, s20
v_lshlrev_b64 v[22:23], 16, v[38:39]
v_lshlrev_b64 v[24:25], 16, v[42:43]
v_mfma_f32_16x16x32_bf16 a[104:107], v[40:43], v[176:179], a[104:107]
v_add_f32 v26, v38, v42
v_add_f32 v27, v39, v43
v_add_f32 v22, v22, v24
v_add_f32 v23, v23, v25
v_mfma_f32_16x16x32_bf16 a[112:115], v[40:43], a[224:227], a[112:115]
s_waitcnt lgkmcnt(8)
buffer_store_dwordx4 v[88:91], v9, s[96:99], s95 offen offset:1024 sc1
v_cvt_pk_bf16_f32 v70, v22, v26
v_perm_b32 v71, v27, v23, s20
v_mfma_f32_16x16x32_bf16 a[120:123], v[40:43], v[80:83], a[120:123]
v_lshlrev_b64 v[16:17], 16, v[52:53]
v_lshlrev_b64 v[18:19], 16, v[56:57]
v_mfma_f32_16x16x32_bf16 a[128:131], v[68:71], v[148:151], a[128:131]
v_add_f32 v20, v52, v56
v_add_f32 v21, v53, v57
v_mfma_f32_16x16x32_bf16 a[136:139], v[68:71], v[152:155], a[136:139]
v_add_f32 v16, v16, v18
v_add_f32 v17, v17, v19
v_mfma_f32_16x16x32_bf16 a[144:147], v[68:71], v[172:175], a[144:147]
v_perm_b32 v72, v20, v16, s20
v_perm_b32 v73, v21, v17, s20
v_mfma_f32_16x16x32_bf16 a[152:155], v[68:71], v[156:159], a[152:155]
v_lshlrev_b64 v[22:23], 16, v[54:55]
v_lshlrev_b64 v[24:25], 16, v[58:59]
v_mfma_f32_16x16x32_bf16 a[160:163], v[68:71], v[96:99], a[160:163]
v_add_f32 v26, v54, v58
v_add_f32 v27, v55, v59
v_mfma_f32_16x16x32_bf16 a[168:171], v[68:71], v[108:111], a[168:171]
ds_read_b128 v[128:131], v2 offset:37888
v_add_f32 v22, v22, v24
v_mfma_f32_16x16x32_bf16 a[176:179], v[68:71], v[140:143], a[176:179]
v_add_f32 v23, v23, v25
v_cvt_pk_bf16_f32 v74, v22, v26
v_mfma_f32_16x16x32_bf16 a[184:187], v[68:71], v[116:119], a[184:187]
s_waitcnt lgkmcnt(5)
v_perm_b32 v75, v27, v23, s20
v_lshlrev_b64 v[16:17], 16, v[28:29]
v_mfma_f32_16x16x32_bf16 a[0:3], v[52:55], a[216:219], a[0:3]
v_lshlrev_b64 v[18:19], 16, v[32:33]
v_add_f32 v20, v28, v32
v_mfma_f32_16x16x32_bf16 a[8:11], v[52:55], a[208:211], a[8:11]
v_add_f32 v21, v29, v33
v_add_f32 v16, v16, v18
v_mfma_f32_16x16x32_bf16 a[16:19], v[52:55], a[236:239], a[16:19]
v_add_f32 v17, v17, v19
v_perm_b32 v60, v20, v16, s20
v_mfma_f32_16x16x32_bf16 a[24:27], v[52:55], a[232:235], a[24:27]
v_perm_b32 v61, v21, v17, s20
v_lshlrev_b64 v[22:23], 16, v[30:31]
v_mfma_f32_16x16x32_bf16 a[32:35], v[52:55], a[204:207], a[32:35]
v_lshlrev_b64 v[24:25], 16, v[34:35]
v_add_f32 v26, v30, v34
v_mfma_f32_16x16x32_bf16 a[40:43], v[52:55], a[248:251], a[40:43]
ds_read_b128 a[216:219], v2 offset:38144
v_add_f32 v27, v31, v35
v_mfma_f32_16x16x32_bf16 a[48:51], v[52:55], a[244:247], a[48:51]
s_waitcnt lgkmcnt(1)
v_add_f32 v22, v22, v24
v_add_f32 v23, v23, v25
v_mfma_f32_16x16x32_bf16 a[56:59], v[52:55], v[128:131], a[56:59]
v_cvt_pk_bf16_f32 v62, v22, v26
v_perm_b32 v63, v27, v23, s20
v_mfma_f32_16x16x32_bf16 a[64:67], v[56:59], a[212:215], a[64:67]
v_lshlrev_b64 v[16:17], 16, v[44:45]
v_lshlrev_b64 v[18:19], 16, v[48:49]
v_mfma_f32_16x16x32_bf16 a[72:75], v[56:59], a[252:255], a[72:75]
v_add_f32 v20, v44, v48
v_add_f32 v21, v45, v49
v_mfma_f32_16x16x32_bf16 a[80:83], v[56:59], v[180:183], a[80:83]
v_add_f32 v16, v16, v18
v_add_f32 v17, v17, v19
v_mfma_f32_16x16x32_bf16 a[88:91], v[56:59], a[228:231], a[88:91]
v_perm_b32 v64, v20, v16, s20
v_perm_b32 v65, v21, v17, s20
v_mfma_f32_16x16x32_bf16 a[96:99], v[56:59], v[176:179], a[96:99]
v_lshlrev_b64 v[22:23], 16, v[46:47]
v_lshlrev_b64 v[24:25], 16, v[50:51]
v_mfma_f32_16x16x32_bf16 a[104:107], v[56:59], a[224:227], a[104:107]
v_add_f32 v26, v46, v50
v_add_f32 v27, v47, v51
v_mfma_f32_16x16x32_bf16 a[112:115], v[56:59], v[80:83], a[112:115]
s_waitcnt lgkmcnt(0)
v_add_f32 v22, v22, v24
v_add_f32 v23, v23, v25
v_mfma_f32_16x16x32_bf16 a[120:123], v[56:59], a[216:219], a[120:123]
v_cvt_pk_bf16_f32 v66, v22, v26
v_perm_b32 v67, v27, v23, s20
v_mfma_f32_16x16x32_bf16 a[128:131], v[72:75], v[152:155], a[128:131]
v_and_b32 v76, 15, v0
v_lshrrev_b32 v77, 4, v0
v_mfma_f32_16x16x32_bf16 a[136:139], v[72:75], v[172:175], a[136:139]
ds_read_b128 a[240:243], v2 offset:38656
v_lshl_add_u32 v78, v77, 5, s41
v_mfma_f32_16x16x32_bf16 a[144:147], v[72:75], v[156:159], a[144:147]
v_lshl_add_u32 v12, v76, 9, v78
v_bfe_u32 v77, v76, 1, 1
v_mfma_f32_16x16x32_bf16 a[152:155], v[72:75], v[96:99], a[152:155]
v_lshl_add_u32 v78, v77, 16, v78
v_and_b32 v77, 12, v76
v_mfma_f32_16x16x32_bf16 a[160:163], v[72:75], v[108:111], a[160:163]
v_add_u32 v78, v77, v78
v_and_b32 v77, 1, v76
v_mfma_f32_16x16x32_bf16 a[168:171], v[72:75], v[140:143], a[168:171]
ds_read_b128 a[220:223], v2 offset:39168
v_add_u32 v78, s37, v78
v_mfma_f32_16x16x32_bf16 a[176:179], v[72:75], v[116:119], a[176:179]
v_lshl_add_u32 v78, v77, 4, v78
v_cmp_eq_u32 s[2:3], 1, v77
v_mfma_f32_16x16x32_bf16 a[184:187], v[72:75], v[120:123], a[184:187]
ds_read_b128 v[136:139], v2 offset:38912
s_mov_b64 s[42:43], -1
v_mfma_f32_16x16x32_bf16 a[96:99], v[32:35], a[224:227], a[96:99]
s_waitcnt vmcnt(6)
ds_read_b128 v[132:135], v2 offset:38400
v_mfma_f32_16x16x32_bf16 a[104:107], v[32:35], v[80:83], a[104:107]
s_barrier
ds_read_b64_tr_b16 v[36:37], v3 offset:24576
v_mfma_f32_16x16x32_bf16 a[112:115], v[32:35], a[216:219], a[112:115]
s_waitcnt lgkmcnt(4)
ds_read_b64_tr_b16 v[38:39], v3 offset:25088
v_mfma_f32_16x16x32_bf16 a[120:123], v[32:35], a[240:243], a[120:123]
ds_read_b64_tr_b16 v[40:41], v4 offset:24576
v_mfma_f32_16x16x32_bf16 a[96:99], v[48:51], v[80:83], a[96:99]
ds_read_b64_tr_b16 v[42:43], v4 offset:25088
v_mfma_f32_16x16x32_bf16 a[104:107], v[48:51], a[216:219], a[104:107]
ds_read_b64_tr_b16 v[52:53], v3 offset:28672
v_mfma_f32_16x16x32_bf16 a[112:115], v[48:51], a[240:243], a[112:115]
s_waitcnt lgkmcnt(7)
ds_read_b64_tr_b16 v[54:55], v3 offset:29184
v_mfma_f32_16x16x32_bf16 a[120:123], v[48:51], a[220:223], a[120:123]
ds_read_b64_tr_b16 v[56:57], v4 offset:28672
v_mfma_f32_16x16x32_bf16 a[32:35], v[28:31], a[248:251], a[32:35]
ds_read_b64_tr_b16 v[58:59], v4 offset:29184
v_mfma_f32_16x16x32_bf16 a[40:43], v[28:31], a[244:247], a[40:43]
v_mfma_f32_16x16x32_bf16 a[48:51], v[28:31], v[128:131], a[48:51]
s_waitcnt lgkmcnt(8)
v_mfma_f32_16x16x32_bf16 a[56:59], v[28:31], v[132:135], a[56:59]
ds_read_b128 a[212:215], v2 offset:39680
v_mfma_f32_16x16x32_bf16 a[0:3], v[28:31], a[208:211], a[0:3]
s_waitcnt lgkmcnt(5)
v_lshlrev_b64 v[16:17], 16, v[36:37]
v_lshlrev_b64 v[18:19], 16, v[40:41]
v_mfma_f32_16x16x32_bf16 a[32:35], v[44:47], a[244:247], a[32:35]
v_add_f32 v20, v36, v40
v_add_f32 v21, v37, v41
v_mfma_f32_16x16x32_bf16 a[40:43], v[44:47], v[128:131], a[40:43]
buffer_load_dwordx4 v[152:155], v11, s[96:99], 0 offen offset:0 sc1
v_mfma_f32_16x16x32_bf16 a[48:51], v[44:47], v[132:135], a[48:51]
v_add_f32 v16, v16, v18
v_add_f32 v17, v17, v19
v_mfma_f32_16x16x32_bf16 a[56:59], v[44:47], v[136:139], a[56:59]
v_perm_b32 v68, v20, v16, s20
v_perm_b32 v69, v21, v17, s20
v_mfma_f32_16x16x32_bf16 a[0:3], v[44:47], a[236:239], a[0:3]
ds_read_b128 v[148:151], v2 offset:39424
v_lshlrev_b64 v[22:23], 16, v[38:39]
v_mfma_f32_16x16x32_bf16 a[96:99], v[40:43], a[216:219], a[96:99]
v_lshlrev_b64 v[24:25], 16, v[42:43]
v_add_f32 v26, v38, v42
v_mfma_f32_16x16x32_bf16 a[104:107], v[40:43], a[240:243], a[104:107]
v_add_f32 v27, v39, v43
v_add_f32 v22, v22, v24
v_mfma_f32_16x16x32_bf16 a[112:115], v[40:43], a[220:223], a[112:115]
s_waitcnt lgkmcnt(1)
ds_read_b128 a[208:211], v2 offset:39936
v_add_f32 v23, v23, v25
v_mfma_f32_16x16x32_bf16 a[120:123], v[40:43], a[212:215], a[120:123]
v_cvt_pk_bf16_f32 v70, v22, v26
v_perm_b32 v71, v27, v23, s20
v_mfma_f32_16x16x32_bf16 a[32:35], v[36:39], v[128:131], a[32:35]
buffer_load_dwordx4 v[84:87], v11, s[96:99], 0 offen offset:1024 sc1
v_mfma_f32_16x16x32_bf16 a[40:43], v[36:39], v[132:135], a[40:43]
v_mfma_f32_16x16x32_bf16 a[32:35], v[52:55], v[132:135], a[32:35]
ds_write_b128 v5, a[96:99] offset:0
v_mfma_f32_16x16x32_bf16 a[40:43], v[52:55], v[136:139], a[40:43]
v_mfma_f32_16x16x32_bf16 a[48:51], v[36:39], v[136:139], a[48:51]
s_waitcnt lgkmcnt(2)
v_mfma_f32_16x16x32_bf16 a[56:59], v[36:39], v[148:151], a[56:59]
v_mfma_f32_16x16x32_bf16 a[0:3], v[36:39], a[232:235], a[0:3]
ds_write_b128 v5, a[104:107] offset:1024
v_mfma_f32_16x16x32_bf16 a[48:51], v[52:55], v[148:151], a[48:51]
s_waitcnt lgkmcnt(2)
v_mfma_f32_16x16x32_bf16 a[56:59], v[52:55], a[208:211], a[56:59]
buffer_load_dwordx4 v[88:91], v11, s[96:99], 0 offen offset:2048 sc1
v_mfma_f32_16x16x32_bf16 a[0:3], v[52:55], a[204:207], a[0:3]
v_accvgpr_read_b32 v104, a32
v_accvgpr_read_b32 v105, a33
v_mfma_f32_16x16x32_bf16 a[160:163], v[60:63], v[140:143], a[160:163]
ds_write_b128 v5, a[112:115] offset:2048
v_mfma_f32_16x16x32_bf16 a[168:171], v[60:63], v[116:119], a[168:171]
v_accvgpr_read_b32 v106, a34
v_accvgpr_read_b32 v107, a35
v_mfma_f32_16x16x32_bf16 a[160:163], v[64:67], v[116:119], a[160:163]
v_mfma_f32_16x16x32_bf16 a[168:171], v[64:67], v[120:123], a[168:171]
v_mfma_f32_16x16x32_bf16 a[160:163], v[68:71], v[120:123], a[160:163]
ds_write_b128 v5, a[120:123] offset:3072
v_mfma_f32_16x16x32_bf16 a[168:171], v[68:71], v[212:215], a[168:171]
v_accvgpr_read_b32 v100, a0
v_accvgpr_read_b32 v101, a1
v_mfma_f32_16x16x32_bf16 a[160:163], v[52:55], v[212:215], a[160:163]
buffer_load_dwordx4 v[92:95], v11, s[96:99], 0 offen offset:3072 sc1
v_mfma_f32_16x16x32_bf16 a[168:171], v[52:55], v[208:211], a[168:171]
v_accvgpr_read_b32 v102, a2
v_accvgpr_read_b32 v103, a3
v_mfma_f32_16x16x32_bf16 a[176:179], v[60:63], v[120:123], a[176:179]
ds_write_b128 v5, a[32:35] offset:4096
v_mfma_f32_16x16x32_bf16 a[184:187], v[60:63], v[212:215], a[184:187]
v_mfma_f32_16x16x32_bf16 a[176:179], v[64:67], v[212:215], a[176:179]
v_mfma_f32_16x16x32_bf16 a[184:187], v[64:67], v[208:211], a[184:187]
v_mfma_f32_16x16x32_bf16 a[176:179], v[68:71], v[208:211], a[176:179]
s_mov_b64 s[44:45], -1
s_mov_b32 s46, 0x3c000000
ds_write_b128 v5, a[40:43] offset:5120
v_mfma_f32_16x16x32_bf16 a[184:187], v[68:71], v[144:147], a[184:187]
v_mfma_f32_16x16x32_bf16 a[176:179], v[52:55], v[144:147], a[176:179]
v_mfma_f32_16x16x32_bf16 a[184:187], v[52:55], v[124:127], a[184:187]
v_mfma_f32_16x16x32_bf16 a[8:11], v[28:31], a[236:239], a[8:11]
ds_write_b128 v5, a[48:51] offset:6144
v_mfma_f32_16x16x32_bf16 a[16:19], v[28:31], a[232:235], a[16:19]
buffer_load_dwordx4 v[112:115], v11, s[96:99], s95 offen offset:0 sc1
v_mfma_f32_16x16x32_bf16 a[24:27], v[28:31], a[204:207], a[24:27]
v_mov_b32 v3, v78
v_sad_u32 v16, v13, 16, 0
v_mfma_f32_16x16x32_bf16 a[8:11], v[44:47], a[232:235], a[8:11]
v_mov_b32 v20, 0
v_mov_b32 v21, 0
v_mfma_f32_16x16x32_bf16 a[16:19], v[44:47], a[204:207], a[16:19]
ds_write_b128 v5, a[56:59] offset:7168
v_mfma_f32_16x16x32_bf16 a[24:27], v[44:47], a[248:251], a[24:27]
v_mov_b32 v22, 0
v_mov_b32 v23, 0
v_mfma_f32_16x16x32_bf16 a[8:11], v[36:39], a[204:207], a[8:11]
v_mov_b32 v24, 0
v_mov_b32 v25, 0
v_mfma_f32_16x16x32_bf16 a[16:19], v[36:39], a[248:251], a[16:19]
v_mov_b32 v26, 0
v_mov_b32 v27, 0
v_mfma_f32_16x16x32_bf16 a[24:27], v[36:39], a[244:247], a[24:27]
ds_write_b128 v5, a[0:3] offset:8192
v_mfma_f32_16x16x32_bf16 a[8:11], v[52:55], a[248:251], a[8:11]
v_mfma_f32_16x16x32_bf16 a[16:19], v[52:55], a[244:247], a[16:19]
v_mfma_f32_16x16x32_bf16 a[24:27], v[52:55], v[128:131], a[24:27]
buffer_load_dwordx4 v[76:79], v11, s[96:99], s95 offen offset:1024 sc1
v_mfma_f32_16x16x32_bf16 a[64:67], v[32:35], a[252:255], a[64:67]
ds_write_b128 v6, a[160:163] offset:0
v_mfma_f32_16x16x32_bf16 a[72:75], v[32:35], v[180:183], a[72:75]
v_mfma_f32_16x16x32_bf16 a[64:67], v[48:51], v[180:183], a[64:67]
v_mfma_f32_16x16x32_bf16 a[72:75], v[48:51], a[228:231], a[72:75]
v_accvgpr_read_b32 v180, a8
v_accvgpr_read_b32 v181, a9
v_mfma_f32_16x16x32_bf16 a[64:67], v[40:43], a[228:231], a[64:67]
ds_write_b128 v6, a[168:171] offset:1024
v_mfma_f32_16x16x32_bf16 a[72:75], v[40:43], v[176:179], a[72:75]
v_accvgpr_read_b32 v182, a10
v_accvgpr_read_b32 v183, a11
v_mfma_f32_16x16x32_bf16 a[80:83], v[32:35], a[228:231], a[80:83]
v_accvgpr_read_b32 v128, a16
v_accvgpr_read_b32 v129, a17
v_mfma_f32_16x16x32_bf16 a[88:91], v[32:35], v[176:179], a[88:91]
v_accvgpr_read_b32 v130, a18
v_accvgpr_read_b32 v131, a19
v_mfma_f32_16x16x32_bf16 a[80:83], v[48:51], v[176:179], a[80:83]
ds_write_b128 v6, a[176:179] offset:2048
v_mfma_f32_16x16x32_bf16 a[88:91], v[48:51], a[224:227], a[88:91]
v_accvgpr_read_b32 v176, a24
v_accvgpr_read_b32 v177, a25
v_mfma_f32_16x16x32_bf16 a[80:83], v[40:43], a[224:227], a[80:83]
v_accvgpr_read_b32 v178, a26
v_accvgpr_read_b32 v179, a27
v_mfma_f32_16x16x32_bf16 a[88:91], v[40:43], v[80:83], a[88:91]
v_accvgpr_read_b32 v132, a64
v_accvgpr_read_b32 v133, a65
v_mfma_f32_16x16x32_bf16 a[128:131], v[60:63], v[172:175], a[128:131]
ds_write_b128 v6, a[184:187] offset:3072
v_mfma_f32_16x16x32_bf16 a[136:139], v[60:63], v[156:159], a[136:139]
v_accvgpr_read_b32 v134, a66
v_accvgpr_read_b32 v135, a67
v_mfma_f32_16x16x32_bf16 a[128:131], v[64:67], v[156:159], a[128:131]
v_accvgpr_read_b32 v80, a72
v_accvgpr_read_b32 v81, a73
v_mfma_f32_16x16x32_bf16 a[136:139], v[64:67], v[96:99], a[136:139]
s_waitcnt lgkmcnt(0)
v_accvgpr_read_b32 v82, a74
v_accvgpr_read_b32 v83, a75
v_mfma_f32_16x16x32_bf16 a[128:131], v[68:71], v[96:99], a[128:131]
s_barrier
ds_read_b128 v[164:167], v7 offset:4096
v_accvgpr_read_b32 v136, a80
v_mfma_f32_16x16x32_bf16 a[136:139], v[68:71], v[108:111], a[136:139]
ds_read_b128 v[156:159], v7 offset:0
v_accvgpr_read_b32 v137, a81
v_mfma_f32_16x16x32_bf16 a[128:131], v[52:55], v[108:111], a[128:131]
ds_read_b128 v[172:175], v8 offset:0
v_accvgpr_read_b32 v138, a82
v_mfma_f32_16x16x32_bf16 a[136:139], v[52:55], v[140:143], a[136:139]
ds_read_b128 v[168:171], v7 offset:5120
v_accvgpr_read_b32 v139, a83
v_mfma_f32_16x16x32_bf16 a[144:147], v[60:63], v[96:99], a[144:147]
ds_read_b128 v[160:163], v7 offset:1024
v_accvgpr_read_b32 v148, a88
v_mfma_f32_16x16x32_bf16 a[152:155], v[60:63], v[108:111], a[152:155]
ds_read_b128 v[184:187], v8 offset:1024
v_accvgpr_read_b32 v149, a89
v_mfma_f32_16x16x32_bf16 a[144:147], v[64:67], v[108:111], a[144:147]
ds_read_b128 v[96:99], v7 offset:6144
v_accvgpr_read_b32 v150, a90
v_mfma_f32_16x16x32_bf16 a[152:155], v[64:67], v[140:143], a[152:155]
ds_read_b128 v[188:191], v7 offset:2048
v_accvgpr_read_b32 v151, a91
v_mfma_f32_16x16x32_bf16 a[144:147], v[68:71], v[140:143], a[144:147]
ds_read_b128 v[192:195], v8 offset:2048
v_accvgpr_read_b32 v108, a128
v_mfma_f32_16x16x32_bf16 a[152:155], v[68:71], v[116:119], a[152:155]
ds_read_b128 v[200:203], v7 offset:7168
v_accvgpr_read_b32 v109, a129
v_mfma_f32_16x16x32_bf16 a[144:147], v[52:55], v[116:119], a[144:147]
ds_read_b128 v[196:199], v7 offset:3072
v_accvgpr_read_b32 v110, a130
v_accvgpr_read_b32 v111, a131
v_accvgpr_read_b32 v140, a136
v_mfma_f32_16x16x32_bf16 a[152:155], v[52:55], v[120:123], a[152:155]
ds_read_b128 v[208:211], v8 offset:3072
v_accvgpr_read_b32 v141, a137
v_accvgpr_read_b32 v142, a138
v_accvgpr_read_b32 v143, a139
ds_read_b128 v[204:207], v7 offset:8192
v_accvgpr_read_b32 v116, a144
v_accvgpr_read_b32 v117, a145
v_accvgpr_read_b32 v118, a146
v_accvgpr_read_b32 v119, a147
buffer_load_dword v36, off, s[96:99], s101 offset:4092 sc1
v_accvgpr_read_b32 v144, a152
v_accvgpr_read_b32 v145, a153
v_accvgpr_read_b32 v146, a154
v_accvgpr_read_b32 v147, a155
s_branch L_cmb
.p2align 6
L_pad8:
s_branch L_hret
s_nop 0
L_ks1:
v_mfma_f32_16x16x32_bf16 a[188:191], v[72:75], v[120:123], a[188:191]
v_lshlrev_b64 v[22:23], 16, v[30:31]
v_lshlrev_b64 v[24:25], 16, v[34:35]
v_mfma_f32_16x16x32_bf16 a[68:71], v[32:35], v[112:115], a[68:71]
s_waitcnt vmcnt(8) lgkmcnt(6)
v_add_f32 v26, v30, v34
v_add_f32 v27, v31, v35
v_mfma_f32_16x16x32_bf16 a[76:79], v[32:35], v[92:95], a[76:79]
s_barrier
ds_read_b64_tr_b16 v[36:37], v3 offset:24576
v_add_f32 v22, v22, v24
v_mfma_f32_16x16x32_bf16 a[84:87], v[32:35], v[88:91], a[84:87]
s_waitcnt lgkmcnt(6)
ds_read_b64_tr_b16 v[38:39], v3 offset:25088
v_add_f32 v23, v23, v25
v_mfma_f32_16x16x32_bf16 a[92:95], v[32:35], v[100:103], a[92:95]
ds_read_b64_tr_b16 v[40:41], v4 offset:24576
v_cvt_pk_bf16_f32 v62, v22, v26
v_mfma_f32_16x16x32_bf16 a[68:71], v[48:51], v[92:95], a[68:71]
ds_read_b64_tr_b16 v[42:43], v4 offset:25088
v_perm_b32 v63, v27, v23, s20
v_mfma_f32_16x16x32_bf16 a[76:79], v[48:51], v[88:91], a[76:79]
ds_read_b64_tr_b16 v[52:53], v3 offset:28672
v_lshlrev_b64 v[16:17], 16, v[44:45]
v_mfma_f32_16x16x32_bf16 a[84:87], v[48:51], v[100:103], a[84:87]
s_waitcnt lgkmcnt(8)
ds_read_b64_tr_b16 v[54:55], v3 offset:29184
v_lshlrev_b64 v[18:19], 16, v[48:49]
v_mfma_f32_16x16x32_bf16 a[92:95], v[48:51], v[168:171], a[92:95]
ds_read_b64_tr_b16 v[56:57], v4 offset:28672
v_add_f32 v20, v44, v48
v_mfma_f32_16x16x32_bf16 a[4:7], v[28:31], v[124:127], a[4:7]
s_mov_b32 s22, 0x3f800000
ds_read_b64_tr_b16 v[58:59], v4 offset:29184
v_add_f32 v21, v45, v49
v_mfma_f32_16x16x32_bf16 a[12:15], v[28:31], v[104:107], a[12:15]
s_mov_b32 s21, 0x3f80
v_add_f32 v16, v16, v18
v_add_f32 v17, v17, v19
v_mfma_f32_16x16x32_bf16 a[20:23], v[28:31], v[80:83], a[20:23]
s_add_u32 s36, s35, 8912896
v_perm_b32 v64, v20, v16, s20
v_perm_b32 v65, v21, v17, s20
v_mfma_f32_16x16x32_bf16 a[28:31], v[28:31], v[76:79], a[28:31]
s_add_u32 m0, s30, 16384
v_lshlrev_b64 v[22:23], 16, v[46:47]
v_lshlrev_b64 v[24:25], 16, v[50:51]
v_mfma_f32_16x16x32_bf16 a[36:39], v[28:31], v[84:87], a[36:39]
s_waitcnt lgkmcnt(4)
buffer_load_dwordx4 v14, s[8:11], s36 offen offset:0 lds
v_mfma_f32_16x16x32_bf16 a[68:71], v[40:43], v[88:91], a[68:71]
s_add_u32 s33, s33, 4096
v_add_f32 v26, v46, v50
v_add_f32 v27, v47, v51
v_mfma_f32_16x16x32_bf16 a[76:79], v[40:43], v[100:103], a[76:79]
s_add_u32 s0, s0, 1
v_add_f32 v22, v22, v24
v_add_f32 v23, v23, v25
v_mfma_f32_16x16x32_bf16 a[84:87], v[40:43], v[168:171], a[84:87]
v_cvt_pk_bf16_f32 v66, v22, v26
v_perm_b32 v67, v27, v23, s20
v_mfma_f32_16x16x32_bf16 a[92:95], v[40:43], v[176:179], a[92:95]
v_lshlrev_b64 v[16:17], 16, v[36:37]
v_lshlrev_b64 v[18:19], 16, v[40:41]
v_mfma_f32_16x16x32_bf16 a[4:7], v[44:47], v[104:107], a[4:7]
v_add_f32 v20, v36, v40
v_add_f32 v21, v37, v41
v_mfma_f32_16x16x32_bf16 a[12:15], v[44:47], v[80:83], a[12:15]
buffer_load_dwordx4 v15, s[8:11], s36 offen offset:1024 lds
v_mfma_f32_16x16x32_bf16 a[20:23], v[44:47], v[76:79], a[20:23]
ds_write_b128 v5, a[68:71] offset:0
v_add_f32 v16, v16, v18
v_mfma_f32_16x16x32_bf16 a[28:31], v[44:47], v[84:87], a[28:31]
s_add_u32 s36, s35, 11010048
v_add_f32 v17, v17, v19
v_perm_b32 v68, v20, v16, s20
v_mfma_f32_16x16x32_bf16 a[36:39], v[44:47], v[136:139], a[36:39]
s_xor_b32 s101, s29, 1
v_perm_b32 v69, v21, v17, s20
v_lshlrev_b64 v[22:23], 16, v[38:39]
v_mfma_f32_16x16x32_bf16 a[4:7], v[36:39], v[80:83], a[4:7]
s_add_u32 m0, s30, 20480
v_lshlrev_b64 v[24:25], 16, v[42:43]
v_add_f32 v26, v38, v42
v_mfma_f32_16x16x32_bf16 a[12:15], v[36:39], v[76:79], a[12:15]
s_waitcnt lgkmcnt(3)
ds_write_b128 v5, a[76:79] offset:1024
v_add_f32 v27, v39, v43
v_mfma_f32_16x16x32_bf16 a[4:7], v[52:55], v[76:79], a[4:7]
buffer_load_dwordx4 v14, s[8:11], s36 offen offset:0 lds
v_mfma_f32_16x16x32_bf16 a[12:15], v[52:55], v[84:87], a[12:15]
v_add_f32 v22, v22, v24
v_add_f32 v23, v23, v25
v_mfma_f32_16x16x32_bf16 a[20:23], v[36:39], v[84:87], a[20:23]
v_cvt_pk_bf16_f32 v70, v22, v26
v_perm_b32 v71, v27, v23, s20
v_mfma_f32_16x16x32_bf16 a[28:31], v[36:39], v[136:139], a[28:31]
s_lshl_b32 s101, s101, 2
ds_write_b128 v5, a[84:87] offset:2048
v_mov_b32_dpp v212, v152 row_shl:1 row_mask:0xf bank_mask:0xf bound_ctrl:0
v_mfma_f32_16x16x32_bf16 a[36:39], v[36:39], v[128:131], a[36:39]
v_mov_b32_dpp v213, v153 row_shl:1 row_mask:0xf bank_mask:0xf bound_ctrl:0
v_mov_b32_dpp v214, v154 row_shl:1 row_mask:0xf bank_mask:0xf bound_ctrl:0
v_mfma_f32_16x16x32_bf16 a[20:23], v[52:55], v[136:139], a[20:23]
v_mov_b32_dpp v215, v155 row_shl:1 row_mask:0xf bank_mask:0xf bound_ctrl:0
v_mov_b32_dpp v208, v172 row_shl:1 row_mask:0xf bank_mask:0xf bound_ctrl:0
v_mfma_f32_16x16x32_bf16 a[28:31], v[52:55], v[128:131], a[28:31]
buffer_load_dwordx4 v15, s[8:11], s36 offen offset:1024 lds
v_mfma_f32_16x16x32_bf16 a[36:39], v[52:55], v[164:167], a[36:39]
ds_write_b128 v5, a[92:95] offset:3072
v_mov_b32_dpp v209, v173 row_shl:1 row_mask:0xf bank_mask:0xf bound_ctrl:0
v_mfma_f32_16x16x32_bf16 a[132:135], v[60:63], v[172:175], a[132:135]
v_mov_b32_dpp v210, v174 row_shl:1 row_mask:0xf bank_mask:0xf bound_ctrl:0
v_mov_b32_dpp v211, v175 row_shl:1 row_mask:0xf bank_mask:0xf bound_ctrl:0
v_mfma_f32_16x16x32_bf16 a[140:143], v[60:63], v[156:159], a[140:143]
s_add_u32 s101, s101, s24
v_accvgpr_read_b32 v216, a4
v_accvgpr_read_b32 v217, a5
v_mfma_f32_16x16x32_bf16 a[132:135], v[64:67], v[156:159], a[132:135]
v_accvgpr_read_b32 v218, a6
v_accvgpr_read_b32 v219, a7
v_mfma_f32_16x16x32_bf16 a[140:143], v[64:67], v[96:99], a[140:143]
ds_write_b128 v5, a[4:7] offset:4096
v_mov_b32_dpp v144, v156 row_shl:1 row_mask:0xf bank_mask:0xf bound_ctrl:0
v_mfma_f32_16x16x32_bf16 a[132:135], v[68:71], v[96:99], a[132:135]
v_mov_b32_dpp v145, v157 row_shl:1 row_mask:0xf bank_mask:0xf bound_ctrl:0
v_mov_b32_dpp v146, v158 row_shl:1 row_mask:0xf bank_mask:0xf bound_ctrl:0
v_mfma_f32_16x16x32_bf16 a[140:143], v[68:71], v[108:111], a[140:143]
v_mov_b32_dpp v147, v159 row_shl:1 row_mask:0xf bank_mask:0xf bound_ctrl:0
v_mov_b32_dpp v124, v96 row_shl:1 row_mask:0xf bank_mask:0xf bound_ctrl:0
v_mfma_f32_16x16x32_bf16 a[132:135], v[52:55], v[108:111], a[132:135]
v_mov_b32_dpp v125, v97 row_shl:1 row_mask:0xf bank_mask:0xf bound_ctrl:0
v_mov_b32_dpp v126, v98 row_shl:1 row_mask:0xf bank_mask:0xf bound_ctrl:0
v_mfma_f32_16x16x32_bf16 a[140:143], v[52:55], v[140:143], a[140:143]
s_lshl_b32 s101, s101, 13
ds_write_b128 v5, a[12:15] offset:5120
v_mov_b32_dpp v127, v99 row_shl:1 row_mask:0xf bank_mask:0xf bound_ctrl:0
v_mfma_f32_16x16x32_bf16 a[148:151], v[60:63], v[96:99], a[148:151]
ds_read_b128 a[212:215], v1 offset:38656
v_accvgpr_read_b32 v220, a36
v_mfma_f32_16x16x32_bf16 a[156:159], v[60:63], v[108:111], a[156:159]
ds_read_b128 a[204:207], v1 offset:40448
v_accvgpr_read_b32 v221, a37
v_mfma_f32_16x16x32_bf16 a[148:151], v[64:67], v[108:111], a[148:151]
ds_read_b128 a[216:219], v1 offset:38400
v_accvgpr_read_b32 v222, a38
v_mfma_f32_16x16x32_bf16 a[156:159], v[64:67], v[140:143], a[156:159]
ds_write_b128 v5, a[20:23] offset:6144
v_accvgpr_read_b32 v223, a39
v_mfma_f32_16x16x32_bf16 a[148:151], v[68:71], v[140:143], a[148:151]
ds_read_b128 a[228:231], v1 offset:36864
v_xor_b32 v11, 32768, v9
v_mfma_f32_16x16x32_bf16 a[156:159], v[68:71], v[116:119], a[156:159]
ds_read_b128 a[224:227], v1 offset:37376
v_mfma_f32_16x16x32_bf16 a[148:151], v[52:55], v[116:119], a[148:151]
ds_read_b128 a[220:223], v1 offset:37888
v_mfma_f32_16x16x32_bf16 a[156:159], v[52:55], v[120:123], a[156:159]
ds_write_b128 v5, a[28:31] offset:7168
v_mfma_f32_16x16x32_bf16 a[44:47], v[28:31], v[136:139], a[44:47]
s_waitcnt lgkmcnt(15)
ds_read_b128 a[208:211], v1 offset:38912
v_mfma_f32_16x16x32_bf16 a[52:55], v[28:31], v[128:131], a[52:55]
s_waitcnt lgkmcnt(15)
ds_read_b128 a[236:239], v1 offset:39424
v_mfma_f32_16x16x32_bf16 a[60:63], v[28:31], v[164:167], a[60:63]
s_waitcnt lgkmcnt(15)
ds_read_b128 a[232:235], v1 offset:39936
v_mfma_f32_16x16x32_bf16 a[100:103], v[32:35], v[168:171], a[100:103]
s_waitcnt lgkmcnt(15)
ds_write_b128 v5, a[36:39] offset:8192
v_mfma_f32_16x16x32_bf16 a[108:111], v[32:35], v[176:179], a[108:111]
s_waitcnt lgkmcnt(15)
ds_read_b128 a[248:251], v1 offset:37120
v_mfma_f32_16x16x32_bf16 a[116:119], v[32:35], v[180:183], a[116:119]
s_waitcnt lgkmcnt(15)
ds_read_b128 a[244:247], v1 offset:37632
v_mfma_f32_16x16x32_bf16 a[124:127], v[32:35], v[196:199], a[124:127]
s_waitcnt lgkmcnt(15)
ds_read_b128 a[240:243], v1 offset:38144
v_mfma_f32_16x16x32_bf16 a[44:47], v[44:47], v[128:131], a[44:47]
s_waitcnt lgkmcnt(15)
ds_write_b128 v6, a[132:135] offset:0
v_mfma_f32_16x16x32_bf16 a[52:55], v[44:47], v[164:167], a[52:55]
s_waitcnt lgkmcnt(15)
ds_read_b128 a[252:255], v1 offset:39168
v_mfma_f32_16x16x32_bf16 a[60:63], v[44:47], v[192:195], a[60:63]
s_waitcnt lgkmcnt(15)
v_mfma_f32_16x16x32_bf16 a[100:103], v[48:51], v[176:179], a[100:103]
v_mfma_f32_16x16x32_bf16 a[108:111], v[48:51], v[180:183], a[108:111]
ds_write_b128 v6, a[140:143] offset:1024
v_mfma_f32_16x16x32_bf16 a[116:119], v[48:51], v[196:199], a[116:119]
s_waitcnt lgkmcnt(15)
v_mfma_f32_16x16x32_bf16 a[124:127], v[48:51], v[188:191], a[124:127]
v_mfma_f32_16x16x32_bf16 a[44:47], v[36:39], v[164:167], a[44:47]
v_mfma_f32_16x16x32_bf16 a[52:55], v[36:39], v[192:195], a[52:55]
ds_write_b128 v6, a[148:151] offset:2048
v_mfma_f32_16x16x32_bf16 a[100:103], v[40:43], v[180:183], a[100:103]
s_waitcnt lgkmcnt(15)
v_mfma_f32_16x16x32_bf16 a[108:111], v[40:43], v[196:199], a[108:111]
v_mfma_f32_16x16x32_bf16 a[44:47], v[52:55], v[192:195], a[44:47]
v_mfma_f32_16x16x32_bf16 a[52:55], v[52:55], v[132:135], a[52:55]
ds_write_b128 v6, a[156:159] offset:3072
v_mfma_f32_16x16x32_bf16 a[164:167], v[60:63], v[140:143], a[164:167]
s_waitcnt vmcnt(8) lgkmcnt(0)
v_mfma_f32_16x16x32_bf16 a[172:175], v[60:63], v[116:119], a[172:175]
s_barrier
ds_read_b128 v[164:167], v7 offset:0
v_accvgpr_read_b32 v84, a100
v_mfma_f32_16x16x32_bf16 a[164:167], v[64:67], v[116:119], a[164:167]
ds_read_b128 v[100:103], v7 offset:4096
v_accvgpr_read_b32 v85, a101
v_mfma_f32_16x16x32_bf16 a[172:175], v[64:67], v[120:123], a[172:175]
ds_read_b128 v[92:95], v8 offset:0
v_accvgpr_read_b32 v86, a102
v_mfma_f32_16x16x32_bf16 a[164:167], v[68:71], v[120:123], a[164:167]
ds_read_b128 v[88:91], v7 offset:5120
v_accvgpr_read_b32 v87, a103
v_mfma_f32_16x16x32_bf16 a[172:175], v[68:71], v[212:215], a[172:175]
ds_read_b64_tr_b16 v[28:29], v3 offset:0
v_accvgpr_read_b32 v76, a44
v_mfma_f32_16x16x32_bf16 a[164:167], v[52:55], v[212:215], a[164:167]
ds_read_b64_tr_b16 v[30:31], v3 offset:512
v_accvgpr_read_b32 v77, a45
v_mfma_f32_16x16x32_bf16 a[172:175], v[52:55], v[208:211], a[172:175]
L_pad9:
s_cbranch_execz L_hret
ds_read_b64_tr_b16 v[32:33], v4 offset:0
v_accvgpr_read_b32 v78, a46
v_mfma_f32_16x16x32_bf16 a[60:63], v[36:39], v[132:135], a[60:63]
ds_read_b64_tr_b16 v[34:35], v4 offset:512
v_accvgpr_read_b32 v79, a47
v_mfma_f32_16x16x32_bf16 a[116:119], v[40:43], v[188:191], a[116:119]
s_waitcnt lgkmcnt(7)
ds_read_b64_tr_b16 v[44:45], v3 offset:4096
v_add_f32 v84, v84, v164
v_mfma_f32_16x16x32_bf16 a[124:127], v[40:43], v[204:207], a[124:127]
ds_read_b64_tr_b16 v[46:47], v3 offset:4608
v_add_f32 v85, v85, v165
v_mfma_f32_16x16x32_bf16 a[60:63], v[52:55], v[200:203], a[60:63]
ds_read_b64_tr_b16 v[48:49], v4 offset:4096
v_add_f32 v86, v86, v166
v_mfma_f32_16x16x32_bf16 a[180:183], v[60:63], v[120:123], a[180:183]
s_add_u32 s36, s35, 13107200
ds_read_b64_tr_b16 v[50:51], v4 offset:4608
v_add_f32 v87, v87, v167
v_mfma_f32_16x16x32_bf16 a[188:191], v[60:63], v[212:215], a[188:191]
s_add_u32 m0, s30, 24576
ds_read_b128 v[104:107], v7 offset:1024
v_accvgpr_read_b32 v132, a164
v_mfma_f32_16x16x32_bf16 a[180:183], v[64:67], v[212:215], a[180:183]
buffer_load_dwordx4 v14, s[8:11], s36 offen offset:0 lds
v_mfma_f32_16x16x32_bf16 a[188:191], v[64:67], v[208:211], a[188:191]
buffer_load_dword v13, v10, s[16:19], 0 offen sc1
v_mfma_f32_16x16x32_bf16 a[180:183], v[68:71], v[208:211], a[180:183]
ds_read_b128 v[128:131], v8 offset:1024
v_accvgpr_read_b32 v133, a165
v_mfma_f32_16x16x32_bf16 a[188:191], v[68:71], v[144:147], a[188:191]
ds_read_b128 v[112:115], v7 offset:6144
v_accvgpr_read_b32 v134, a166
v_accvgpr_read_b32 v135, a167
v_mfma_f32_16x16x32_bf16 a[180:183], v[52:55], v[144:147], a[180:183]
s_waitcnt lgkmcnt(13)
buffer_load_dwordx4 v15, s[8:11], s36 offen offset:1024 lds
v_add_f32 v220, v220, v100
v_add_f32 v221, v221, v101
v_mfma_f32_16x16x32_bf16 a[188:191], v[52:55], v[124:127], a[188:191]
s_waitcnt lgkmcnt(9)
ds_read_b128 v[80:83], v7 offset:2048
v_add_f32 v222, v222, v102
v_add_f32 v223, v223, v103
v_add_f32 v132, v132, v92
v_mfma_f32_16x16x32_bf16 a[0:3], v[28:31], a[228:231], a[0:3]
s_add_u32 s36, s35, 15204352
ds_read_b128 v[100:103], v8 offset:2048
v_add_f32 v133, v133, v93
v_add_f32 v134, v134, v94
v_add_f32 v135, v135, v95
v_mfma_f32_16x16x32_bf16 a[8:11], v[28:31], a[224:227], a[8:11]
s_add_u32 m0, s30, 28672
ds_read_b128 v[92:95], v7 offset:7168
v_add_f32 v76, v76, v88
v_add_f32 v77, v77, v89
v_add_f32 v78, v78, v90
v_mfma_f32_16x16x32_bf16 a[16:19], v[28:31], a[220:223], a[16:19]
s_waitcnt lgkmcnt(10)
s_mul_i32 s38, s27, 2032640
buffer_load_dwordx4 v14, s[8:11], s36 offen offset:0 lds
v_add_f32 v79, v79, v91
v_lshlrev_b64 v[16:17], 16, v[28:29]
v_mfma_f32_16x16x32_bf16 a[24:27], v[28:31], a[216:219], a[24:27]
s_add_u32 s4, s58, s38
s_addc_u32 s5, s59, 0
ds_read_b128 v[180:183], v1 offset:39680
v_lshlrev_b64 v[18:19], 16, v[32:33]
v_add_f32 v20, v28, v32
v_add_f32 v21, v29, v33
v_mfma_f32_16x16x32_bf16 a[32:35], v[28:31], a[208:211], a[32:35]
s_mov_b32 s6, 2032640
ds_read_b128 a[228:231], v1 offset:40192
v_add_f32 v16, v16, v18
v_add_f32 v17, v17, v19
v_perm_b32 v60, v20, v16, s20
v_mfma_f32_16x16x32_bf16 a[40:43], v[28:31], a[236:239], a[40:43]
s_lshl_b32 s38, s25, 7
ds_read_b128 v[176:179], v1 offset:40704
v_perm_b32 v61, v21, v17, s20
v_lshlrev_b64 v[22:23], 16, v[30:31]
v_lshlrev_b64 v[24:25], 16, v[34:35]
v_mfma_f32_16x16x32_bf16 a[48:51], v[28:31], a[232:235], a[48:51]
s_lshl_b32 s39, s29, 6
buffer_load_dwordx4 v15, s[8:11], s36 offen offset:1024 lds
v_add_f32 v26, v30, v34
v_add_f32 v27, v31, v35
v_mfma_f32_16x16x32_bf16 a[56:59], v[28:31], a[204:207], a[56:59]
s_add_u32 s38, s38, s39
ds_read_b128 v[164:167], v7 offset:3072
v_add_f32 v22, v22, v24
v_add_f32 v23, v23, v25
v_cvt_pk_bf16_f32 v62, v22, v26
v_mfma_f32_16x16x32_bf16 a[64:67], v[32:35], a[248:251], a[64:67]
s_lshl_b32 s39, s32, 5
ds_read_b128 v[136:139], v8 offset:3072
v_perm_b32 v63, v27, v23, s20
v_sub_f32 v132, v132, v84
v_sub_f32 v133, v133, v85
v_mfma_f32_16x16x32_bf16 a[72:75], v[32:35], a[244:247], a[72:75]
s_add_u32 s38, s38, s39
ds_read_b128 v[88:91], v7 offset:8192
v_sub_f32 v134, v134, v86
v_sub_f32 v135, v135, v87
v_add_f32 v84, v84, v220
v_mfma_f32_16x16x32_bf16 a[80:83], v[32:35], a[240:243], a[80:83]
s_waitcnt lgkmcnt(15)
s_mul_i32 s39, s26, 253952
v_add_f32 v85, v85, v221
v_add_f32 v86, v86, v222
v_add_f32 v87, v87, v223
v_accvgpr_read_b32 v168, a108
v_mfma_f32_16x16x32_bf16 a[88:91], v[32:35], a[212:215], a[88:91]
s_add_u32 s38, s38, s39
v_accvgpr_read_b32 v169, a109
v_accvgpr_read_b32 v170, a110
v_accvgpr_read_b32 v171, a111
v_accvgpr_read_b32 v188, a172
v_mfma_f32_16x16x32_bf16 a[96:99], v[32:35], a[252:255], a[96:99]
s_waitcnt lgkmcnt(5)
s_lshl_b32 s40, s24, 16
v_accvgpr_read_b32 v189, a173
v_accvgpr_read_b32 v190, a174
v_accvgpr_read_b32 v191, a175
v_sub_f32 v132, v132, v76
v_mfma_f32_16x16x32_bf16 a[104:107], v[32:35], v[180:183], a[104:107]
s_waitcnt vmcnt(9) lgkmcnt(4)
s_add_u32 s40, s40, s39
ds_read_b128 a[248:251], v2 offset:36864
v_sub_f32 v133, v133, v77
v_sub_f32 v134, v134, v78
v_sub_f32 v135, v135, v79
v_mfma_f32_16x16x32_bf16 a[112:115], v[32:35], a[228:231], a[112:115]
s_waitcnt lgkmcnt(4)
s_barrier
s_lshl_b32 s39, s31, 13
ds_read_b64_tr_b16 v[36:37], v3 offset:8192
v_mov_b32 v199, s0
v_mov_b32 v195, s0
v_cvt_pk_bf16_f32 v196, v84, v132
v_mfma_f32_16x16x32_bf16 a[120:123], v[32:35], v[176:179], a[120:123]
s_add_u32 s38, s38, s39
ds_read_b64_tr_b16 v[38:39], v3 offset:8704
v_cvt_pk_bf16_f32 v197, v85, v133
v_cvt_pk_bf16_f32 v198, v86, v134
v_cvt_pk_bf16_f32 v192, v87, v135
v_mfma_f32_16x16x32_bf16 a[128:131], v[60:63], v[184:187], a[128:131]
s_lshl_b32 s41, s29, 8
ds_read_b64_tr_b16 v[40:41], v4 offset:8192
v_accvgpr_read_b32 v84, a52
v_accvgpr_read_b32 v85, a53
v_accvgpr_read_b32 v86, a54
v_mfma_f32_16x16x32_bf16 a[136:139], v[60:63], v[160:163], a[136:139]
s_lshl_b32 s39, s32, 7
ds_read_b64_tr_b16 v[42:43], v4 offset:8704
v_accvgpr_read_b32 v87, a55
v_add_f32 v168, v168, v104
v_add_f32 v169, v169, v105
v_mfma_f32_16x16x32_bf16 a[144:147], v[60:63], v[148:151], a[144:147]
s_add_u32 s41, s41, s39
ds_read_b64_tr_b16 v[52:53], v3 offset:12288
v_add_f32 v170, v170, v106
v_add_f32 v171, v171, v107
v_add_f32 v188, v188, v128
v_mfma_f32_16x16x32_bf16 a[152:155], v[60:63], v[152:155], a[152:155]
s_lshl_b32 s39, s26, 10
ds_read_b64_tr_b16 v[54:55], v3 offset:12800
v_add_f32 v189, v189, v129
v_add_f32 v190, v190, v130
v_add_f32 v191, v191, v131
v_mfma_f32_16x16x32_bf16 a[160:163], v[60:63], v[172:175], a[160:163]
s_lshl_b32 s37, s31, 9
ds_read_b64_tr_b16 v[56:57], v4 offset:12288
v_add_f32 v84, v84, v112
v_add_f32 v85, v85, v113
v_add_f32 v86, v86, v114
v_mfma_f32_16x16x32_bf16 a[168:171], v[60:63], v[156:159], a[168:171]
s_add_u32 s37, s37, s39
ds_read_b64_tr_b16 v[58:59], v4 offset:12800
v_add_f32 v87, v87, v115
v_sub_f32 v188, v188, v168
v_sub_f32 v189, v189, v169
v_mfma_f32_16x16x32_bf16 a[176:179], v[60:63], v[96:99], a[176:179]
s_mov_b32 s34, 0
buffer_store_dwordx4 v[196:199], v9, s[96:99], 0 offen offset:0 sc1
v_sub_f32 v190, v190, v170
v_sub_f32 v191, v191, v171
v_mfma_f32_16x16x32_bf16 a[184:187], v[60:63], v[108:111], a[184:187]
s_mov_b32 s47, 1048576
v_add_f32 v168, v168, v76
v_add_f32 v169, v169, v77
v_add_f32 v170, v170, v78
v_add_f32 v171, v171, v79
v_mfma_f32_16x16x32_bf16 a[0:3], v[44:47], a[224:227], a[0:3]
v_accvgpr_read_b32 v104, a116
v_accvgpr_read_b32 v105, a117
v_accvgpr_read_b32 v106, a118
v_accvgpr_read_b32 v107, a119
v_mfma_f32_16x16x32_bf16 a[8:11], v[44:47], a[220:223], a[8:11]
v_accvgpr_read_b32 v112, a180
v_accvgpr_read_b32 v113, a181
v_accvgpr_read_b32 v114, a182
v_accvgpr_read_b32 v115, a183
v_mfma_f32_16x16x32_bf16 a[16:19], v[44:47], a[216:219], a[16:19]
v_sub_f32 v188, v188, v84
v_sub_f32 v189, v189, v85
v_sub_f32 v190, v190, v86
v_sub_f32 v191, v191, v87
v_mfma_f32_16x16x32_bf16 a[24:27], v[44:47], a[208:211], a[24:27]
v_accvgpr_read_b32 v76, a60
v_accvgpr_read_b32 v77, a61
v_accvgpr_read_b32 v78, a62
v_accvgpr_read_b32 v79, a63
v_mfma_f32_16x16x32_bf16 a[32:35], v[44:47], a[236:239], a[32:35]
v_add_f32 v104, v104, v80
v_add_f32 v105, v105, v81
v_add_f32 v106, v106, v82
v_add_f32 v107, v107, v83
v_mfma_f32_16x16x32_bf16 a[40:43], v[44:47], a[232:235], a[40:43]
ds_read_b128 a[224:227], v2 offset:37120
v_add_f32 v112, v112, v100
v_add_f32 v113, v113, v101
v_add_f32 v114, v114, v102
v_mfma_f32_16x16x32_bf16 a[48:51], v[44:47], a[204:207], a[48:51]
s_waitcnt lgkmcnt(9)
v_add_f32 v115, v115, v103
v_mov_b32 v83, s0
v_cvt_pk_bf16_f32 v193, v168, v188
v_cvt_pk_bf16_f32 v194, v169, v189
v_mfma_f32_16x16x32_bf16 a[56:59], v[44:47], a[248:251], a[56:59]
v_cvt_pk_bf16_f32 v80, v170, v190
v_cvt_pk_bf16_f32 v81, v171, v191
v_add_f32 v76, v76, v92
v_add_f32 v77, v77, v93
v_mfma_f32_16x16x32_bf16 a[64:67], v[48:51], a[244:247], a[64:67]
v_add_f32 v78, v78, v94
v_add_f32 v79, v79, v95
v_sub_f32 v112, v112, v104
v_sub_f32 v113, v113, v105
v_mfma_f32_16x16x32_bf16 a[72:75], v[48:51], a[240:243], a[72:75]
v_sub_f32 v114, v114, v106
v_sub_f32 v115, v115, v107
v_add_f32 v104, v104, v84
v_add_f32 v105, v105, v85
v_mfma_f32_16x16x32_bf16 a[80:83], v[48:51], a[212:215], a[80:83]
buffer_store_dwordx4 v[192:195], v9, s[96:99], 0 offen offset:1024 sc1
v_add_f32 v106, v106, v86
v_add_f32 v107, v107, v87
v_mfma_f32_16x16x32_bf16 a[88:91], v[48:51], a[252:255], a[88:91]
v_lshlrev_b64 v[16:17], 16, v[44:45]
v_lshlrev_b64 v[18:19], 16, v[48:49]
v_add_f32 v20, v44, v48
v_add_f32 v21, v45, v49
v_mfma_f32_16x16x32_bf16 a[96:99], v[48:51], v[180:183], a[96:99]
v_add_f32 v16, v16, v18
v_add_f32 v17, v17, v19
v_perm_b32 v64, v20, v16, s20
v_perm_b32 v65, v21, v17, s20
v_mfma_f32_16x16x32_bf16 a[104:107], v[48:51], a[228:231], a[104:107]
v_lshlrev_b64 v[22:23], 16, v[46:47]
v_lshlrev_b64 v[24:25], 16, v[50:51]
v_add_f32 v26, v46, v50
v_add_f32 v27, v47, v51
v_mfma_f32_16x16x32_bf16 a[112:115], v[48:51], v[176:179], a[112:115]
s_waitcnt lgkmcnt(0)
v_add_f32 v22, v22, v24
v_add_f32 v23, v23, v25
v_cvt_pk_bf16_f32 v66, v22, v26
v_perm_b32 v67, v27, v23, s20
v_mfma_f32_16x16x32_bf16 a[120:123], v[48:51], a[224:227], a[120:123]
v_sub_f32 v112, v112, v76
v_sub_f32 v113, v113, v77
v_sub_f32 v114, v114, v78
v_sub_f32 v115, v115, v79
v_mfma_f32_16x16x32_bf16 a[128:131], v[64:67], v[160:163], a[128:131]
v_accvgpr_read_b32 v84, a124
v_accvgpr_read_b32 v85, a125
v_accvgpr_read_b32 v86, a126
v_accvgpr_read_b32 v87, a127
v_mfma_f32_16x16x32_bf16 a[136:139], v[64:67], v[148:151], a[136:139]
v_accvgpr_read_b32 v92, a188
v_accvgpr_read_b32 v93, a189
v_accvgpr_read_b32 v94, a190
v_accvgpr_read_b32 v95, a191
v_mfma_f32_16x16x32_bf16 a[144:147], v[64:67], v[152:155], a[144:147]
v_mov_b32 v103, s0
v_cvt_pk_bf16_f32 v82, v104, v112
v_cvt_pk_bf16_f32 v100, v105, v113
v_cvt_pk_bf16_f32 v101, v106, v114
v_mfma_f32_16x16x32_bf16 a[152:155], v[64:67], v[172:175], a[152:155]
v_cvt_pk_bf16_f32 v102, v107, v115
v_add_f32 v84, v84, v164
v_add_f32 v85, v85, v165
v_add_f32 v86, v86, v166
v_mfma_f32_16x16x32_bf16 a[160:163], v[64:67], v[156:159], a[160:163]
buffer_store_dwordx4 v[80:83], v9, s[96:99], 0 offen offset:2048 sc1
v_add_f32 v87, v87, v167
v_add_f32 v92, v92, v136
v_mfma_f32_16x16x32_bf16 a[168:171], v[64:67], v[96:99], a[168:171]
ds_read_b128 a[244:247], v2 offset:37376
v_add_f32 v93, v93, v137
v_add_f32 v94, v94, v138
v_add_f32 v95, v95, v139
v_mfma_f32_16x16x32_bf16 a[176:179], v[64:67], v[108:111], a[176:179]
v_add_f32 v216, v216, v88
v_add_f32 v217, v217, v89
v_mfma_f32_16x16x32_bf16 a[184:187], v[64:67], v[140:143], a[184:187]
v_add_f32 v218, v218, v90
v_add_f32 v219, v219, v91
v_mfma_f32_16x16x32_bf16 a[0:3], v[36:39], a[220:223], a[0:3]
s_waitcnt vmcnt(8)
ds_read_b128 v[80:83], v2 offset:37632
v_mov_b32_dpp v216, v216 row_shl:1 row_mask:0xf bank_mask:0xf bound_ctrl:1
v_mov_b32_dpp v217, v217 row_shl:1 row_mask:0xf bank_mask:0xf bound_ctrl:1
v_mov_b32_dpp v218, v218 row_shl:1 row_mask:0xf bank_mask:0xf bound_ctrl:1
v_mfma_f32_16x16x32_bf16 a[8:11], v[36:39], a[216:219], a[8:11]
s_barrier
ds_read_b64_tr_b16 v[28:29], v3 offset:16384
v_mov_b32_dpp v219, v219 row_shl:1 row_mask:0xf bank_mask:0xf bound_ctrl:1
v_sub_f32 v92, v92, v84
v_sub_f32 v93, v93, v85
v_mfma_f32_16x16x32_bf16 a[16:19], v[36:39], a[208:211], a[16:19]
ds_read_b64_tr_b16 v[30:31], v3 offset:16896
v_sub_f32 v94, v94, v86
v_sub_f32 v95, v95, v87
v_add_f32 v84, v84, v76
v_mfma_f32_16x16x32_bf16 a[24:27], v[36:39], a[236:239], a[24:27]
ds_read_b64_tr_b16 v[32:33], v4 offset:16384
v_add_f32 v85, v85, v77
v_add_f32 v86, v86, v78
v_add_f32 v87, v87, v79
v_mfma_f32_16x16x32_bf16 a[32:35], v[36:39], a[232:235], a[32:35]
ds_read_b64_tr_b16 v[34:35], v4 offset:16896
v_sub_f32 v92, v92, v216
v_mfma_f32_16x16x32_bf16 a[40:43], v[36:39], a[204:207], a[40:43]
ds_read_b64_tr_b16 v[44:45], v3 offset:20480
v_sub_f32 v93, v93, v217
v_mfma_f32_16x16x32_bf16 a[48:51], v[36:39], a[248:251], a[48:51]
s_waitcnt lgkmcnt(6)
ds_read_b64_tr_b16 v[46:47], v3 offset:20992
v_sub_f32 v94, v94, v218
v_sub_f32 v95, v95, v219
v_mfma_f32_16x16x32_bf16 a[56:59], v[36:39], a[244:247], a[56:59]
ds_read_b64_tr_b16 v[48:49], v4 offset:20480
v_mov_b32 v79, s0
v_mfma_f32_16x16x32_bf16 a[64:67], v[40:43], a[240:243], a[64:67]
ds_read_b64_tr_b16 v[50:51], v4 offset:20992
v_mov_b32 v91, s0
v_cvt_pk_bf16_f32 v76, v84, v92
v_cvt_pk_bf16_f32 v77, v85, v93
v_mfma_f32_16x16x32_bf16 a[72:75], v[40:43], a[212:215], a[72:75]
buffer_store_dwordx4 v[100:103], v9, s[96:99], 0 offen offset:3072 sc1
v_cvt_pk_bf16_f32 v78, v86, v94
v_cvt_pk_bf16_f32 v88, v87, v95
v_mfma_f32_16x16x32_bf16 a[80:83], v[40:43], a[252:255], a[80:83]
buffer_store_dwordx4 v[76:79], v9, s[96:99], s95 offen offset:0 sc1
v_lshlrev_b64 v[16:17], 16, v[36:37]
v_lshlrev_b64 v[18:19], 16, v[40:41]
v_mfma_f32_16x16x32_bf16 a[88:91], v[40:43], v[180:183], a[88:91]
v_add_f32 v20, v36, v40
v_add_f32 v21, v37, v41
v_add_f32 v16, v16, v18
v_add_f32 v17, v17, v19
v_mfma_f32_16x16x32_bf16 a[96:99], v[40:43], a[228:231], a[96:99]
v_perm_b32 v68, v20, v16, s20
v_perm_b32 v69, v21, v17, s20
v_lshlrev_b64 v[22:23], 16, v[38:39]
v_lshlrev_b64 v[24:25], 16, v[42:43]
v_mfma_f32_16x16x32_bf16 a[104:107], v[40:43], v[176:179], a[104:107]
v_add_f32 v26, v38, v42
v_add_f32 v27, v39, v43
v_add_f32 v22, v22, v24
v_add_f32 v23, v23, v25
v_mfma_f32_16x16x32_bf16 a[112:115], v[40:43], a[224:227], a[112:115]
s_waitcnt lgkmcnt(8)
buffer_store_dwordx4 v[88:91], v9, s[96:99], s95 offen offset:1024 sc1
v_cvt_pk_bf16_f32 v70, v22, v26
v_perm_b32 v71, v27, v23, s20
v_mfma_f32_16x16x32_bf16 a[120:123], v[40:43], v[80:83], a[120:123]
v_lshlrev_b64 v[16:17], 16, v[52:53]
v_lshlrev_b64 v[18:19], 16, v[56:57]
v_mfma_f32_16x16x32_bf16 a[128:131], v[68:71], v[148:151], a[128:131]
v_add_f32 v20, v52, v56
v_add_f32 v21, v53, v57
v_mfma_f32_16x16x32_bf16 a[136:139], v[68:71], v[152:155], a[136:139]
v_add_f32 v16, v16, v18
v_add_f32 v17, v17, v19
v_mfma_f32_16x16x32_bf16 a[144:147], v[68:71], v[172:175], a[144:147]
v_perm_b32 v72, v20, v16, s20
v_perm_b32 v73, v21, v17, s20
v_mfma_f32_16x16x32_bf16 a[152:155], v[68:71], v[156:159], a[152:155]
v_lshlrev_b64 v[22:23], 16, v[54:55]
v_lshlrev_b64 v[24:25], 16, v[58:59]
v_mfma_f32_16x16x32_bf16 a[160:163], v[68:71], v[96:99], a[160:163]
v_add_f32 v26, v54, v58
v_add_f32 v27, v55, v59
v_mfma_f32_16x16x32_bf16 a[168:171], v[68:71], v[108:111], a[168:171]
ds_read_b128 v[128:131], v2 offset:37888
v_add_f32 v22, v22, v24
v_mfma_f32_16x16x32_bf16 a[176:179], v[68:71], v[140:143], a[176:179]
v_add_f32 v23, v23, v25
v_cvt_pk_bf16_f32 v74, v22, v26
v_mfma_f32_16x16x32_bf16 a[184:187], v[68:71], v[116:119], a[184:187]
s_waitcnt lgkmcnt(5)
v_perm_b32 v75, v27, v23, s20
v_lshlrev_b64 v[16:17], 16, v[28:29]
v_mfma_f32_16x16x32_bf16 a[0:3], v[52:55], a[216:219], a[0:3]
v_lshlrev_b64 v[18:19], 16, v[32:33]
v_add_f32 v20, v28, v32
v_mfma_f32_16x16x32_bf16 a[8:11], v[52:55], a[208:211], a[8:11]
v_add_f32 v21, v29, v33
v_add_f32 v16, v16, v18
v_mfma_f32_16x16x32_bf16 a[16:19], v[52:55], a[236:239], a[16:19]
v_add_f32 v17, v17, v19
v_perm_b32 v60, v20, v16, s20
v_mfma_f32_16x16x32_bf16 a[24:27], v[52:55], a[232:235], a[24:27]
v_perm_b32 v61, v21, v17, s20
v_lshlrev_b64 v[22:23], 16, v[30:31]
v_mfma_f32_16x16x32_bf16 a[32:35], v[52:55], a[204:207], a[32:35]
v_lshlrev_b64 v[24:25], 16, v[34:35]
v_add_f32 v26, v30, v34
v_mfma_f32_16x16x32_bf16 a[40:43], v[52:55], a[248:251], a[40:43]
ds_read_b128 a[216:219], v2 offset:38144
v_add_f32 v27, v31, v35
v_mfma_f32_16x16x32_bf16 a[48:51], v[52:55], a[244:247], a[48:51]
s_waitcnt lgkmcnt(1)
v_add_f32 v22, v22, v24
v_add_f32 v23, v23, v25
v_mfma_f32_16x16x32_bf16 a[56:59], v[52:55], v[128:131], a[56:59]
v_cvt_pk_bf16_f32 v62, v22, v26
v_perm_b32 v63, v27, v23, s20
v_mfma_f32_16x16x32_bf16 a[64:67], v[56:59], a[212:215], a[64:67]
v_lshlrev_b64 v[16:17], 16, v[44:45]
v_lshlrev_b64 v[18:19], 16, v[48:49]
v_mfma_f32_16x16x32_bf16 a[72:75], v[56:59], a[252:255], a[72:75]
v_add_f32 v20, v44, v48
v_add_f32 v21, v45, v49
v_mfma_f32_16x16x32_bf16 a[80:83], v[56:59], v[180:183], a[80:83]
v_add_f32 v16, v16, v18
v_add_f32 v17, v17, v19
v_mfma_f32_16x16x32_bf16 a[88:91], v[56:59], a[228:231], a[88:91]
v_perm_b32 v64, v20, v16, s20
v_perm_b32 v65, v21, v17, s20
v_mfma_f32_16x16x32_bf16 a[96:99], v[56:59], v[176:179], a[96:99]
v_lshlrev_b64 v[22:23], 16, v[46:47]
v_lshlrev_b64 v[24:25], 16, v[50:51]
v_mfma_f32_16x16x32_bf16 a[104:107], v[56:59], a[224:227], a[104:107]
v_add_f32 v26, v46, v50
v_add_f32 v27, v47, v51
v_mfma_f32_16x16x32_bf16 a[112:115], v[56:59], v[80:83], a[112:115]
s_waitcnt lgkmcnt(0)
v_add_f32 v22, v22, v24
v_add_f32 v23, v23, v25
v_mfma_f32_16x16x32_bf16 a[120:123], v[56:59], a[216:219], a[120:123]
v_cvt_pk_bf16_f32 v66, v22, v26
v_perm_b32 v67, v27, v23, s20
v_mfma_f32_16x16x32_bf16 a[128:131], v[72:75], v[152:155], a[128:131]
v_and_b32 v76, 15, v0
v_lshrrev_b32 v77, 4, v0
v_mfma_f32_16x16x32_bf16 a[136:139], v[72:75], v[172:175], a[136:139]
ds_read_b128 a[240:243], v2 offset:38656
v_lshl_add_u32 v78, v77, 5, s41
v_mfma_f32_16x16x32_bf16 a[144:147], v[72:75], v[156:159], a[144:147]
v_lshl_add_u32 v12, v76, 9, v78
v_bfe_u32 v77, v76, 1, 1
v_mfma_f32_16x16x32_bf16 a[152:155], v[72:75], v[96:99], a[152:155]
v_lshl_add_u32 v78, v77, 16, v78
v_and_b32 v77, 12, v76
v_mfma_f32_16x16x32_bf16 a[160:163], v[72:75], v[108:111], a[160:163]
v_add_u32 v78, v77, v78
v_and_b32 v77, 1, v76
v_mfma_f32_16x16x32_bf16 a[168:171], v[72:75], v[140:143], a[168:171]
ds_read_b128 a[220:223], v2 offset:39168
v_add_u32 v78, s37, v78
v_mfma_f32_16x16x32_bf16 a[176:179], v[72:75], v[116:119], a[176:179]
v_lshl_add_u32 v78, v77, 4, v78
v_cmp_eq_u32 s[2:3], 1, v77
v_mfma_f32_16x16x32_bf16 a[184:187], v[72:75], v[120:123], a[184:187]
ds_read_b128 v[136:139], v2 offset:38912
v_cmp_gt_u32 s[42:43], 15, v76
v_mfma_f32_16x16x32_bf16 a[64:67], v[32:35], a[252:255], a[64:67]
s_waitcnt vmcnt(6)
ds_read_b128 v[132:135], v2 offset:38400
v_mfma_f32_16x16x32_bf16 a[72:75], v[32:35], v[180:183], a[72:75]
s_barrier
ds_read_b64_tr_b16 v[36:37], v3 offset:24576
v_mfma_f32_16x16x32_bf16 a[80:83], v[32:35], a[228:231], a[80:83]
s_waitcnt lgkmcnt(4)
ds_read_b64_tr_b16 v[38:39], v3 offset:25088
v_mfma_f32_16x16x32_bf16 a[88:91], v[32:35], v[176:179], a[88:91]
ds_read_b64_tr_b16 v[40:41], v4 offset:24576
v_mfma_f32_16x16x32_bf16 a[64:67], v[48:51], v[180:183], a[64:67]
ds_read_b64_tr_b16 v[42:43], v4 offset:25088
v_mfma_f32_16x16x32_bf16 a[72:75], v[48:51], a[228:231], a[72:75]
ds_read_b64_tr_b16 v[52:53], v3 offset:28672
v_mfma_f32_16x16x32_bf16 a[80:83], v[48:51], v[176:179], a[80:83]
s_waitcnt lgkmcnt(7)
ds_read_b64_tr_b16 v[54:55], v3 offset:29184
v_mfma_f32_16x16x32_bf16 a[88:91], v[48:51], a[224:227], a[88:91]
ds_read_b64_tr_b16 v[56:57], v4 offset:28672
v_mfma_f32_16x16x32_bf16 a[0:3], v[28:31], a[208:211], a[0:3]
ds_read_b64_tr_b16 v[58:59], v4 offset:29184
v_mfma_f32_16x16x32_bf16 a[8:11], v[28:31], a[236:239], a[8:11]
v_mfma_f32_16x16x32_bf16 a[16:19], v[28:31], a[232:235], a[16:19]
s_waitcnt lgkmcnt(8)
v_mfma_f32_16x16x32_bf16 a[24:27], v[28:31], a[204:207], a[24:27]
ds_read_b128 a[212:215], v2 offset:39680
v_mfma_f32_16x16x32_bf16 a[32:35], v[28:31], a[248:251], a[32:35]
s_waitcnt lgkmcnt(5)
v_lshlrev_b64 v[16:17], 16, v[36:37]
v_lshlrev_b64 v[18:19], 16, v[40:41]
v_mfma_f32_16x16x32_bf16 a[0:3], v[44:47], a[236:239], a[0:3]
v_add_f32 v20, v36, v40
v_add_f32 v21, v37, v41
v_mfma_f32_16x16x32_bf16 a[8:11], v[44:47], a[232:235], a[8:11]
buffer_load_dwordx4 v[152:155], v11, s[96:99], 0 offen offset:0 sc1
v_mfma_f32_16x16x32_bf16 a[16:19], v[44:47], a[204:207], a[16:19]
v_add_f32 v16, v16, v18
v_add_f32 v17, v17, v19
v_mfma_f32_16x16x32_bf16 a[24:27], v[44:47], a[248:251], a[24:27]
v_perm_b32 v68, v20, v16, s20
v_perm_b32 v69, v21, v17, s20
v_mfma_f32_16x16x32_bf16 a[32:35], v[44:47], a[244:247], a[32:35]
ds_read_b128 v[148:151], v2 offset:39424
v_lshlrev_b64 v[22:23], 16, v[38:39]
v_mfma_f32_16x16x32_bf16 a[64:67], v[40:43], a[228:231], a[64:67]
v_lshlrev_b64 v[24:25], 16, v[42:43]
v_add_f32 v26, v38, v42
v_mfma_f32_16x16x32_bf16 a[72:75], v[40:43], v[176:179], a[72:75]
v_add_f32 v27, v39, v43
v_add_f32 v22, v22, v24
v_mfma_f32_16x16x32_bf16 a[80:83], v[40:43], a[224:227], a[80:83]
s_waitcnt lgkmcnt(1)
ds_read_b128 a[208:211], v2 offset:39936
v_add_f32 v23, v23, v25
v_mfma_f32_16x16x32_bf16 a[88:91], v[40:43], v[80:83], a[88:91]
v_cvt_pk_bf16_f32 v70, v22, v26
v_perm_b32 v71, v27, v23, s20
v_mfma_f32_16x16x32_bf16 a[0:3], v[36:39], a[232:235], a[0:3]
buffer_load_dwordx4 v[84:87], v11, s[96:99], 0 offen offset:1024 sc1
v_mfma_f32_16x16x32_bf16 a[8:11], v[36:39], a[204:207], a[8:11]
v_mfma_f32_16x16x32_bf16 a[0:3], v[52:55], a[204:207], a[0:3]
ds_write_b128 v5, a[64:67] offset:0
v_mfma_f32_16x16x32_bf16 a[8:11], v[52:55], a[248:251], a[8:11]
v_mfma_f32_16x16x32_bf16 a[16:19], v[36:39], a[248:251], a[16:19]
s_waitcnt lgkmcnt(2)
v_mfma_f32_16x16x32_bf16 a[24:27], v[36:39], a[244:247], a[24:27]
v_mfma_f32_16x16x32_bf16 a[32:35], v[36:39], v[128:131], a[32:35]
ds_write_b128 v5, a[72:75] offset:1024
v_mfma_f32_16x16x32_bf16 a[16:19], v[52:55], a[244:247], a[16:19]
s_waitcnt lgkmcnt(2)
v_mfma_f32_16x16x32_bf16 a[24:27], v[52:55], v[128:131], a[24:27]
buffer_load_dwordx4 v[88:91], v11, s[96:99], 0 offen offset:2048 sc1
v_mfma_f32_16x16x32_bf16 a[32:35], v[52:55], v[132:135], a[32:35]
v_accvgpr_read_b32 v104, a0
v_accvgpr_read_b32 v105, a1
v_mfma_f32_16x16x32_bf16 a[128:131], v[60:63], v[172:175], a[128:131]
ds_write_b128 v5, a[80:83] offset:2048
v_mfma_f32_16x16x32_bf16 a[136:139], v[60:63], v[156:159], a[136:139]
v_accvgpr_read_b32 v106, a2
v_accvgpr_read_b32 v107, a3
v_mfma_f32_16x16x32_bf16 a[128:131], v[64:67], v[156:159], a[128:131]
v_mfma_f32_16x16x32_bf16 a[136:139], v[64:67], v[96:99], a[136:139]
v_mfma_f32_16x16x32_bf16 a[128:131], v[68:71], v[96:99], a[128:131]
ds_write_b128 v5, a[88:91] offset:3072
v_mfma_f32_16x16x32_bf16 a[136:139], v[68:71], v[108:111], a[136:139]
v_accvgpr_read_b32 v100, a32
v_accvgpr_read_b32 v101, a33
v_mfma_f32_16x16x32_bf16 a[128:131], v[52:55], v[108:111], a[128:131]
buffer_load_dwordx4 v[92:95], v11, s[96:99], 0 offen offset:3072 sc1
v_mfma_f32_16x16x32_bf16 a[136:139], v[52:55], v[140:143], a[136:139]
v_accvgpr_read_b32 v102, a34
v_accvgpr_read_b32 v103, a35
v_mfma_f32_16x16x32_bf16 a[144:147], v[60:63], v[96:99], a[144:147]
ds_write_b128 v5, a[0:3] offset:4096
v_mfma_f32_16x16x32_bf16 a[152:155], v[60:63], v[108:111], a[152:155]
v_mfma_f32_16x16x32_bf16 a[144:147], v[64:67], v[108:111], a[144:147]
v_mfma_f32_16x16x32_bf16 a[152:155], v[64:67], v[140:143], a[152:155]
v_mfma_f32_16x16x32_bf16 a[144:147], v[68:71], v[140:143], a[144:147]
s_cmp_eq_u32 s26, 7
s_cselect_b64 s[44:45], -1, s[42:43]
s_mov_b32 s46, 0x3c088889
s_cmov_b32 s46, 0x3c0767ab
ds_write_b128 v5, a[8:11] offset:5120
v_mfma_f32_16x16x32_bf16 a[152:155], v[68:71], v[116:119], a[152:155]
v_mfma_f32_16x16x32_bf16 a[144:147], v[52:55], v[116:119], a[144:147]
v_mfma_f32_16x16x32_bf16 a[152:155], v[52:55], v[120:123], a[152:155]
v_mfma_f32_16x16x32_bf16 a[40:43], v[28:31], a[244:247], a[40:43]
ds_write_b128 v5, a[16:19] offset:6144
v_mfma_f32_16x16x32_bf16 a[48:51], v[28:31], v[128:131], a[48:51]
buffer_load_dwordx4 v[112:115], v11, s[96:99], s95 offen offset:0 sc1
v_mfma_f32_16x16x32_bf16 a[56:59], v[28:31], v[132:135], a[56:59]
v_mov_b32 v3, v78
v_sad_u32 v16, v13, 16, 0
v_mfma_f32_16x16x32_bf16 a[40:43], v[44:47], v[128:131], a[40:43]
v_mov_b32 v20, 0
v_mov_b32 v21, 0
v_mfma_f32_16x16x32_bf16 a[48:51], v[44:47], v[132:135], a[48:51]
ds_write_b128 v5, a[24:27] offset:7168
v_mfma_f32_16x16x32_bf16 a[56:59], v[44:47], v[136:139], a[56:59]
v_mov_b32 v22, 0
v_mov_b32 v23, 0
v_mfma_f32_16x16x32_bf16 a[40:43], v[36:39], v[132:135], a[40:43]
v_mov_b32 v24, 0
v_mov_b32 v25, 0
v_mfma_f32_16x16x32_bf16 a[48:51], v[36:39], v[136:139], a[48:51]
v_mov_b32 v26, 0
v_mov_b32 v27, 0
v_mfma_f32_16x16x32_bf16 a[56:59], v[36:39], v[148:151], a[56:59]
ds_write_b128 v5, a[32:35] offset:8192
v_mfma_f32_16x16x32_bf16 a[40:43], v[52:55], v[136:139], a[40:43]
v_mfma_f32_16x16x32_bf16 a[48:51], v[52:55], v[148:151], a[48:51]
v_mfma_f32_16x16x32_bf16 a[56:59], v[52:55], a[208:211], a[56:59]
buffer_load_dwordx4 v[76:79], v11, s[96:99], s95 offen offset:1024 sc1
v_mfma_f32_16x16x32_bf16 a[96:99], v[32:35], a[224:227], a[96:99]
ds_write_b128 v6, a[128:131] offset:0
v_mfma_f32_16x16x32_bf16 a[104:107], v[32:35], v[80:83], a[104:107]
v_mfma_f32_16x16x32_bf16 a[96:99], v[48:51], v[80:83], a[96:99]
v_mfma_f32_16x16x32_bf16 a[104:107], v[48:51], a[216:219], a[104:107]
v_accvgpr_read_b32 v180, a40
v_accvgpr_read_b32 v181, a41
v_mfma_f32_16x16x32_bf16 a[96:99], v[40:43], a[216:219], a[96:99]
L_pad10:
s_cbranch_execz L_hret
ds_write_b128 v6, a[136:139] offset:1024
v_mfma_f32_16x16x32_bf16 a[104:107], v[40:43], a[240:243], a[104:107]
v_accvgpr_read_b32 v182, a42
v_accvgpr_read_b32 v183, a43
v_mfma_f32_16x16x32_bf16 a[112:115], v[32:35], a[216:219], a[112:115]
v_accvgpr_read_b32 v128, a48
v_accvgpr_read_b32 v129, a49
v_mfma_f32_16x16x32_bf16 a[120:123], v[32:35], a[240:243], a[120:123]
v_accvgpr_read_b32 v130, a50
v_accvgpr_read_b32 v131, a51
v_mfma_f32_16x16x32_bf16 a[112:115], v[48:51], a[240:243], a[112:115]
ds_write_b128 v6, a[144:147] offset:2048
v_mfma_f32_16x16x32_bf16 a[120:123], v[48:51], a[220:223], a[120:123]
v_accvgpr_read_b32 v176, a56
v_accvgpr_read_b32 v177, a57
v_mfma_f32_16x16x32_bf16 a[112:115], v[40:43], a[220:223], a[112:115]
v_accvgpr_read_b32 v178, a58
v_accvgpr_read_b32 v179, a59
v_mfma_f32_16x16x32_bf16 a[120:123], v[40:43], a[212:215], a[120:123]
v_accvgpr_read_b32 v132, a96
v_accvgpr_read_b32 v133, a97
v_mfma_f32_16x16x32_bf16 a[160:163], v[60:63], v[140:143], a[160:163]
ds_write_b128 v6, a[152:155] offset:3072
v_mfma_f32_16x16x32_bf16 a[168:171], v[60:63], v[116:119], a[168:171]
v_accvgpr_read_b32 v134, a98
v_accvgpr_read_b32 v135, a99
v_mfma_f32_16x16x32_bf16 a[160:163], v[64:67], v[116:119], a[160:163]
v_accvgpr_read_b32 v80, a104
v_accvgpr_read_b32 v81, a105
v_mfma_f32_16x16x32_bf16 a[168:171], v[64:67], v[120:123], a[168:171]
s_waitcnt lgkmcnt(0)
v_accvgpr_read_b32 v82, a106
v_accvgpr_read_b32 v83, a107
v_mfma_f32_16x16x32_bf16 a[160:163], v[68:71], v[120:123], a[160:163]
s_barrier
ds_read_b128 v[164:167], v7 offset:4096
v_accvgpr_read_b32 v136, a112
v_mfma_f32_16x16x32_bf16 a[168:171], v[68:71], v[212:215], a[168:171]
ds_read_b128 v[156:159], v7 offset:0
v_accvgpr_read_b32 v137, a113
v_mfma_f32_16x16x32_bf16 a[160:163], v[52:55], v[212:215], a[160:163]
ds_read_b128 v[172:175], v8 offset:0
v_accvgpr_read_b32 v138, a114
v_mfma_f32_16x16x32_bf16 a[168:171], v[52:55], v[208:211], a[168:171]
ds_read_b128 v[168:171], v7 offset:5120
v_accvgpr_read_b32 v139, a115
v_mfma_f32_16x16x32_bf16 a[176:179], v[60:63], v[120:123], a[176:179]
ds_read_b128 v[160:163], v7 offset:1024
v_accvgpr_read_b32 v148, a120
v_mfma_f32_16x16x32_bf16 a[184:187], v[60:63], v[212:215], a[184:187]
ds_read_b128 v[184:187], v8 offset:1024
v_accvgpr_read_b32 v149, a121
v_mfma_f32_16x16x32_bf16 a[176:179], v[64:67], v[212:215], a[176:179]
ds_read_b128 v[96:99], v7 offset:6144
v_accvgpr_read_b32 v150, a122
v_mfma_f32_16x16x32_bf16 a[184:187], v[64:67], v[208:211], a[184:187]
ds_read_b128 v[188:191], v7 offset:2048
v_accvgpr_read_b32 v151, a123
v_mfma_f32_16x16x32_bf16 a[176:179], v[68:71], v[208:211], a[176:179]
ds_read_b128 v[192:195], v8 offset:2048
v_accvgpr_read_b32 v108, a160
v_mfma_f32_16x16x32_bf16 a[184:187], v[68:71], v[144:147], a[184:187]
ds_read_b128 v[200:203], v7 offset:7168
v_accvgpr_read_b32 v109, a161
v_mfma_f32_16x16x32_bf16 a[176:179], v[52:55], v[144:147], a[176:179]
ds_read_b128 v[196:199], v7 offset:3072
v_accvgpr_read_b32 v110, a162
v_accvgpr_read_b32 v111, a163
v_accvgpr_read_b32 v140, a168
v_mfma_f32_16x16x32_bf16 a[184:187], v[52:55], v[124:127], a[184:187]
ds_read_b128 v[208:211], v8 offset:3072
v_accvgpr_read_b32 v141, a169
v_accvgpr_read_b32 v142, a170
v_accvgpr_read_b32 v143, a171
ds_read_b128 v[204:207], v7 offset:8192
v_accvgpr_read_b32 v116, a176
v_accvgpr_read_b32 v117, a177
v_accvgpr_read_b32 v118, a178
v_accvgpr_read_b32 v119, a179
buffer_load_dword v36, off, s[96:99], s101 offset:4092 sc1
v_accvgpr_read_b32 v144, a184
v_accvgpr_read_b32 v145, a185
v_accvgpr_read_b32 v146, a186
v_accvgpr_read_b32 v147, a187
L_cmb:
s_cmp_eq_u32 s31, 0
s_waitcnt lgkmcnt(6)
v_pk_add_f32 v[100:101], v[100:101], v[164:165]
v_pk_add_f32 v[102:103], v[102:103], v[166:167]
v_pk_add_f32 v[132:133], v[132:133], v[156:157]
v_pk_add_f32 v[134:135], v[134:135], v[158:159]
v_pk_add_f32 v[108:109], v[108:109], v[172:173]
v_pk_add_f32 v[110:111], v[110:111], v[174:175]
v_pk_add_f32 v[180:181], v[180:181], v[168:169]
v_pk_add_f32 v[182:183], v[182:183], v[170:171]
v_pk_add_f32 v[108:109], v[108:109], v[132:133] neg_lo:[0,1] neg_hi:[0,1]
v_pk_add_f32 v[110:111], v[110:111], v[134:135] neg_lo:[0,1] neg_hi:[0,1]
v_pk_add_f32 v[132:133], v[132:133], v[100:101]
v_pk_add_f32 v[134:135], v[134:135], v[102:103]
v_pk_add_f32 v[108:109], v[108:109], v[180:181] neg_lo:[0,1] neg_hi:[0,1]
v_pk_add_f32 v[110:111], v[110:111], v[182:183] neg_lo:[0,1] neg_hi:[0,1]
v_pk_add_f32 v[80:81], v[80:81], v[160:161]
v_pk_add_f32 v[82:83], v[82:83], v[162:163]
v_pk_add_f32 v[140:141], v[140:141], v[184:185]
v_pk_add_f32 v[142:143], v[142:143], v[186:187]
v_pk_add_f32 v[128:129], v[128:129], v[96:97]
v_pk_add_f32 v[130:131], v[130:131], v[98:99]
v_pk_add_f32 v[140:141], v[140:141], v[80:81] neg_lo:[0,1] neg_hi:[0,1]
v_pk_add_f32 v[142:143], v[142:143], v[82:83] neg_lo:[0,1] neg_hi:[0,1]
v_pk_add_f32 v[80:81], v[80:81], v[180:181]
v_pk_add_f32 v[82:83], v[82:83], v[182:183]
v_pk_add_f32 v[140:141], v[140:141], v[128:129] neg_lo:[0,1] neg_hi:[0,1]
v_pk_add_f32 v[142:143], v[142:143], v[130:131] neg_lo:[0,1] neg_hi:[0,1]
buffer_load_dword v37, off, s[96:99], s101 offset:4092 sc1
s_waitcnt lgkmcnt(0)
v_pk_add_f32 v[136:137], v[136:137], v[188:189]
v_pk_add_f32 v[138:139], v[138:139], v[190:191]
v_pk_add_f32 v[116:117], v[116:117], v[192:193]
v_pk_add_f32 v[118:119], v[118:119], v[194:195]
v_pk_add_f32 v[176:177], v[176:177], v[200:201]
v_pk_add_f32 v[178:179], v[178:179], v[202:203]
v_pk_add_f32 v[116:117], v[116:117], v[136:137] neg_lo:[0,1] neg_hi:[0,1]
v_pk_add_f32 v[118:119], v[118:119], v[138:139] neg_lo:[0,1] neg_hi:[0,1]
v_pk_add_f32 v[136:137], v[136:137], v[128:129]
v_pk_add_f32 v[138:139], v[138:139], v[130:131]
v_pk_add_f32 v[116:117], v[116:117], v[176:177] neg_lo:[0,1] neg_hi:[0,1]
v_pk_add_f32 v[118:119], v[118:119], v[178:179] neg_lo:[0,1] neg_hi:[0,1]
v_pk_add_f32 v[148:149], v[148:149], v[196:197]
v_pk_add_f32 v[150:151], v[150:151], v[198:199]
v_pk_add_f32 v[144:145], v[144:145], v[208:209]
v_pk_add_f32 v[146:147], v[146:147], v[210:211]
v_pk_add_f32 v[104:105], v[104:105], v[204:205]
v_pk_add_f32 v[106:107], v[106:107], v[206:207]
s_cbranch_scc1 L_nodpp
s_nop 0
v_mov_b32_dpp v104, v104 row_shl:1 row_mask:0xf bank_mask:0xf bound_ctrl:1
v_mov_b32_dpp v105, v105 row_shl:1 row_mask:0xf bank_mask:0xf bound_ctrl:1
v_mov_b32_dpp v106, v106 row_shl:1 row_mask:0xf bank_mask:0xf bound_ctrl:1
v_mov_b32_dpp v107, v107 row_shl:1 row_mask:0xf bank_mask:0xf bound_ctrl:1
L_nodpp:
v_pk_add_f32 v[144:145], v[144:145], v[148:149] neg_lo:[0,1] neg_hi:[0,1]
v_pk_add_f32 v[146:147], v[146:147], v[150:151] neg_lo:[0,1] neg_hi:[0,1]
v_pk_add_f32 v[148:149], v[148:149], v[176:177]
v_pk_add_f32 v[150:151], v[150:151], v[178:179]
v_pk_add_f32 v[144:145], v[144:145], v[104:105] neg_lo:[0,1] neg_hi:[0,1]
v_pk_add_f32 v[146:147], v[146:147], v[106:107] neg_lo:[0,1] neg_hi:[0,1]
s_waitcnt vmcnt(2)
v_sad_u32 v16, v155, s0, v16
v_sad_u32 v16, v87, s0, v16
v_sad_u32 v16, v91, s0, v16
v_sad_u32 v16, v95, s0, v16
v_sad_u32 v16, v115, s0, v16
v_sad_u32 v16, v79, s0, v16
v_cmp_ne_u32 vcc, 0, v16
s_nop 0
s_cbranch_vccnz L_cchk
L_iok:
v_dot2_f32_bf16 v132, v152, s21, v132
v_dot2_f32_bf16 v133, v153, s21, v133
v_dot2_f32_bf16 v134, v154, s21, v134
v_dot2_f32_bf16 v135, v84, s21, v135
v_dot2_f32_bf16 v108, v152, s22, v108
v_dot2_f32_bf16 v109, v153, s22, v109
v_dot2_f32_bf16 v110, v154, s22, v110
v_dot2_f32_bf16 v111, v84, s22, v111
s_mov_b64 exec, s[44:45]
v_pk_add_f32 v[20:21], v[20:21], v[132:133]
v_pk_add_f32 v[22:23], v[22:23], v[134:135]
v_dot2_f32_bf16 v80, v85, s21, v80
v_dot2_f32_bf16 v81, v86, s21, v81
v_dot2_f32_bf16 v82, v88, s21, v82
v_dot2_f32_bf16 v83, v89, s21, v83
s_mov_b64 exec, s[42:43]
v_pk_add_f32 v[20:21], v[20:21], v[108:109]
v_pk_add_f32 v[22:23], v[22:23], v[110:111]
v_dot2_f32_bf16 v140, v85, s22, v140
v_dot2_f32_bf16 v141, v86, s22, v141
v_dot2_f32_bf16 v142, v88, s22, v142
v_dot2_f32_bf16 v143, v89, s22, v143
v_pk_add_f32 v[20:21], v[20:21], v[80:81]
v_pk_add_f32 v[22:23], v[22:23], v[82:83]
v_dot2_f32_bf16 v136, v90, s21, v136
v_dot2_f32_bf16 v137, v92, s21, v137
v_dot2_f32_bf16 v138, v93, s21, v138
v_dot2_f32_bf16 v139, v94, s21, v139
v_pk_add_f32 v[20:21], v[20:21], v[140:141]
v_pk_add_f32 v[22:23], v[22:23], v[142:143]
v_dot2_f32_bf16 v116, v90, s22, v116
v_dot2_f32_bf16 v117, v92, s22, v117
v_dot2_f32_bf16 v118, v93, s22, v118
v_dot2_f32_bf16 v119, v94, s22, v119
v_pk_add_f32 v[20:21], v[20:21], v[136:137]
v_pk_add_f32 v[22:23], v[22:23], v[138:139]
v_dot2_f32_bf16 v148, v112, s21, v148
v_dot2_f32_bf16 v149, v113, s21, v149
v_dot2_f32_bf16 v150, v114, s21, v150
v_dot2_f32_bf16 v151, v76, s21, v151
v_pk_add_f32 v[20:21], v[20:21], v[116:117]
v_pk_add_f32 v[22:23], v[22:23], v[118:119]
v_dot2_f32_bf16 v144, v112, s22, v144
v_dot2_f32_bf16 v145, v113, s22, v145
v_dot2_f32_bf16 v146, v114, s22, v146
v_dot2_f32_bf16 v147, v76, s22, v147
v_pk_add_f32 v[20:21], v[20:21], v[148:149]
v_pk_add_f32 v[22:23], v[22:23], v[150:151]
v_pk_add_f32 v[20:21], v[20:21], v[144:145]
v_pk_add_f32 v[22:23], v[22:23], v[146:147]
s_mov_b64 exec, -1
s_nop 0
v_add_f32_dpp v20, v20, v20 row_ror:8 row_mask:0xf bank_mask:0xf
v_add_f32_dpp v21, v21, v21 row_ror:8 row_mask:0xf bank_mask:0xf
v_add_f32_dpp v22, v22, v22 row_ror:8 row_mask:0xf bank_mask:0xf
v_add_f32_dpp v23, v23, v23 row_ror:8 row_mask:0xf bank_mask:0xf
v_add_f32_dpp v20, v20, v20 row_ror:4 row_mask:0xf bank_mask:0xf
v_add_f32_dpp v21, v21, v21 row_ror:4 row_mask:0xf bank_mask:0xf
v_add_f32_dpp v22, v22, v22 row_ror:4 row_mask:0xf bank_mask:0xf
v_add_f32_dpp v23, v23, v23 row_ror:4 row_mask:0xf bank_mask:0xf
v_add_f32_dpp v20, v20, v20 row_ror:2 row_mask:0xf bank_mask:0xf
v_add_f32_dpp v21, v21, v21 row_ror:2 row_mask:0xf bank_mask:0xf
v_add_f32_dpp v22, v22, v22 row_ror:2 row_mask:0xf bank_mask:0xf
v_add_f32_dpp v23, v23, v23 row_ror:2 row_mask:0xf bank_mask:0xf
v_add_f32_dpp v20, v20, v20 row_ror:1 row_mask:0xf bank_mask:0xf
v_add_f32_dpp v21, v21, v21 row_ror:1 row_mask:0xf bank_mask:0xf
v_add_f32_dpp v22, v22, v22 row_ror:1 row_mask:0xf bank_mask:0xf
v_add_f32_dpp v23, v23, v23 row_ror:1 row_mask:0xf bank_mask:0xf
v_mul_f32 v64, s46, v20
v_mul_f32 v65, s46, v21
v_mul_f32 v66, s46, v22
v_mul_f32 v67, s46, v23
v_pk_add_f32 v[132:133], v[132:133], v[64:65] neg_lo:[0,1] neg_hi:[0,1]
v_pk_add_f32 v[134:135], v[134:135], v[66:67] neg_lo:[0,1] neg_hi:[0,1]
v_pk_add_f32 v[108:109], v[108:109], v[64:65] neg_lo:[0,1] neg_hi:[0,1]
v_pk_add_f32 v[110:111], v[110:111], v[66:67] neg_lo:[0,1] neg_hi:[0,1]
s_mov_b64 exec, s[44:45]
v_pk_fma_f32 v[24:25], v[132:133], v[132:133], v[24:25]
v_pk_fma_f32 v[26:27], v[134:135], v[134:135], v[26:27]
v_pk_add_f32 v[80:81], v[80:81], v[64:65] neg_lo:[0,1] neg_hi:[0,1]
v_pk_add_f32 v[82:83], v[82:83], v[66:67] neg_lo:[0,1] neg_hi:[0,1]
s_mov_b64 exec, s[42:43]
v_pk_fma_f32 v[24:25], v[108:109], v[108:109], v[24:25]
v_pk_fma_f32 v[26:27], v[110:111], v[110:111], v[26:27]
v_pk_add_f32 v[140:141], v[140:141], v[64:65] neg_lo:[0,1] neg_hi:[0,1]
v_pk_add_f32 v[142:143], v[142:143], v[66:67] neg_lo:[0,1] neg_hi:[0,1]
v_pk_fma_f32 v[24:25], v[80:81], v[80:81], v[24:25]
v_pk_fma_f32 v[26:27], v[82:83], v[82:83], v[26:27]
v_pk_add_f32 v[136:137], v[136:137], v[64:65] neg_lo:[0,1] neg_hi:[0,1]
v_pk_add_f32 v[138:139], v[138:139], v[66:67] neg_lo:[0,1] neg_hi:[0,1]
v_pk_fma_f32 v[24:25], v[140:141], v[140:141], v[24:25]
v_pk_fma_f32 v[26:27], v[142:143], v[142:143], v[26:27]
v_pk_add_f32 v[116:117], v[116:117], v[64:65] neg_lo:[0,1] neg_hi:[0,1]
v_pk_add_f32 v[118:119], v[118:119], v[66:67] neg_lo:[0,1] neg_hi:[0,1]
v_pk_fma_f32 v[24:25], v[136:137], v[136:137], v[24:25]
v_pk_fma_f32 v[26:27], v[138:139], v[138:139], v[26:27]
v_pk_add_f32 v[148:149], v[148:149], v[64:65] neg_lo:[0,1] neg_hi:[0,1]
v_pk_add_f32 v[150:151], v[150:151], v[66:67] neg_lo:[0,1] neg_hi:[0,1]
v_pk_fma_f32 v[24:25], v[116:117], v[116:117], v[24:25]
v_pk_fma_f32 v[26:27], v[118:119], v[118:119], v[26:27]
v_pk_add_f32 v[144:145], v[144:145], v[64:65] neg_lo:[0,1] neg_hi:[0,1]
v_pk_add_f32 v[146:147], v[146:147], v[66:67] neg_lo:[0,1] neg_hi:[0,1]
v_pk_fma_f32 v[24:25], v[148:149], v[148:149], v[24:25]
v_pk_fma_f32 v[26:27], v[150:151], v[150:151], v[26:27]
v_pk_fma_f32 v[24:25], v[144:145], v[144:145], v[24:25]
v_pk_fma_f32 v[26:27], v[146:147], v[146:147], v[26:27]
s_mov_b64 exec, -1
v_mov_b32 v68, v64
v_add_f32_dpp v24, v24, v24 row_ror:8 row_mask:0xf bank_mask:0xf
v_add_f32_dpp v25, v25, v25 row_ror:8 row_mask:0xf bank_mask:0xf
v_add_f32_dpp v24, v26, v26 row_ror:8 row_mask:0xf bank_mask:0xc
v_add_f32_dpp v25, v27, v27 row_ror:8 row_mask:0xf bank_mask:0xc
v_mov_b32_dpp v68, v65 quad_perm:[0,1,2,3] row_mask:0xf bank_mask:0x2
v_add_f32_dpp v24, v24, v24 row_half_mirror row_mask:0xf bank_mask:0xf
v_add_f32_dpp v24, v25, v25 row_half_mirror row_mask:0xf bank_mask:0xa
v_mov_b32_dpp v68, v66 quad_perm:[0,1,2,3] row_mask:0xf bank_mask:0x4
v_mov_b32_dpp v68, v67 quad_perm:[0,1,2,3] row_mask:0xf bank_mask:0x8
v_add_f32_dpp v24, v24, v24 quad_perm:[1,0,3,2] row_mask:0xf bank_mask:0xf
s_nop 1
v_add_f32_dpp v24, v24, v24 quad_perm:[2,3,0,1] row_mask:0xf bank_mask:0xf
v_cndmask_b32 v68, v68, v24, s[2:3]
v_min_u32 v68, -2, v68
buffer_store_dword v68, v3, s[12:15], 0 offen
v_mov_b32 v24, 0x3727c5ac
v_mov_b32 v25, s0
v_and_b32 v16, 15, v0
v_lshrrev_b32 v17, 4, v0
v_accvgpr_read_b32 v213, a194
v_accvgpr_read_b32 v215, a195
v_accvgpr_read_b32 v217, a196
v_accvgpr_read_b32 v219, a197
v_accvgpr_read_b32 v221, a198
v_accvgpr_read_b32 v223, a199
v_lshrrev_b32 v14, 5, v0
v_and_b32 v17, 1, v17
v_lshlrev_b32 v14, 4, v14
v_lshl_add_u32 v14, v17, 10, v14
s_and_b32 s44, s44, 0xffff
s_and_b32 s45, s45, 0xffff
s_or_b64 s[44:45], s[44:45], s[42:43]
v_lshl_add_u32 v14, v16, 14, v14
v_add_u32 v14, s38, v14
v_add_u32 v15, 4096, v14
v_lshlrev_b32 v212, 16, v213
v_lshlrev_b32 v214, 16, v215
v_and_b32 v213, 0xffff0000, v213
v_and_b32 v215, 0xffff0000, v215
v_lshlrev_b32 v216, 16, v217
v_lshlrev_b32 v218, 16, v219
v_and_b32 v217, 0xffff0000, v217
v_and_b32 v219, 0xffff0000, v219
v_lshlrev_b32 v220, 16, v221
v_lshlrev_b32 v222, 16, v223
v_and_b32 v221, 0xffff0000, v221
v_and_b32 v223, 0xffff0000, v223
v_and_b32 v127, 1, v16
v_cmp_eq_u32 vcc, 15, v16
v_lshlrev_b32 v127, 3, v127
v_sub_u32 v126, 128, v127
v_addc_co_u32 v126, vcc, 0, v126, vcc
v_cvt_f32_u32 v126, v126
v_mov_b32 v124, 0x3eeff558
v_mov_b32 v125, 0x3eeff558
v_mov_b32 v127, v126
v_mov_b32 v120, 0x409d30fc
v_mov_b32 v121, 0x409d30fc
v_pk_add_f32 v[212:213], v[212:213], v[212:213] neg_lo:[0,1] neg_hi:[0,1]
v_pk_add_f32 v[214:215], v[214:215], v[214:215] neg_lo:[0,1] neg_hi:[0,1]
v_pk_add_f32 v[220:221], v[220:221], v[212:213]
v_pk_add_f32 v[222:223], v[222:223], v[214:215]
v_mov_b32_dpp v216, v217 quad_perm:[0,1,2,3] row_mask:0xf bank_mask:0x2
v_mov_b32_dpp v216, v218 quad_perm:[0,1,2,3] row_mask:0xf bank_mask:0x4
v_mov_b32_dpp v216, v219 quad_perm:[0,1,2,3] row_mask:0xf bank_mask:0x8
v_mov_b32_dpp v220, v221 quad_perm:[0,1,2,3] row_mask:0xf bank_mask:0x2
v_mov_b32_dpp v220, v222 quad_perm:[0,1,2,3] row_mask:0xf bank_mask:0x4
v_mov_b32_dpp v220, v223 quad_perm:[0,1,2,3] row_mask:0xf bank_mask:0x8
v_mul_f32 v216, v124, v216
v_mul_f32 v220, v124, v220
s_mov_b32 s47, 1048576
s_mov_b32 s38, 0x3a040ffe
s_mov_b32 s39, s38
L_poll:
buffer_load_dwordx4 v[28:31], v12, s[12:15], s34 offen sc1
buffer_load_dwordx4 v[32:35], v12, s[12:15], s34 offen offset:16 sc1
s_sub_u32 s47, s47, 1
s_cbranch_scc1 L_pollout
s_and_b32 s34, s47, 63
s_cselect_b32 s34, 0, 8192
s_cbranch_scc0 L_watch
L_w2:
s_waitcnt vmcnt(0)
v_max3_u32 v16, v28, v29, v30
v_max3_u32 v17, v31, v32, v33
v_max3_u32 v16, v16, v34, v35
v_max_u32 v16, v16, v17
v_cmp_eq_u32 vcc, -1, v16
s_mov_b64 exec, vcc
s_cbranch_execnz L_poll
L_pollout:
s_mov_b64 exec, -1
s_mov_b32 s34, 8192
buffer_store_dword v68, v3, s[12:15], s34 offen sc1
buffer_store_dword v25, off, s[96:99], s33 offset:3840 sc1
v_pk_add_f32 v[16:17], v[28:29], v[64:65] neg_lo:[0,1] neg_hi:[0,1]
v_pk_add_f32 v[18:19], v[30:31], v[66:67] neg_lo:[0,1] neg_hi:[0,1]
v_pk_mul_f32 v[20:21], v[16:17], v[126:127]
v_pk_mul_f32 v[22:23], v[18:19], v[126:127]
v_pk_fma_f32 v[16:17], v[20:21], v[16:17], v[32:33]
v_pk_fma_f32 v[18:19], v[22:23], v[18:19], v[34:35]
v_add_f32_dpp v20, v20, v20 row_ror:8 row_mask:0xf bank_mask:0xf
v_add_f32_dpp v21, v21, v21 row_ror:8 row_mask:0xf bank_mask:0xf
v_add_f32_dpp v20, v22, v22 row_ror:8 row_mask:0xf bank_mask:0xc
v_add_f32_dpp v21, v23, v23 row_ror:8 row_mask:0xf bank_mask:0xc
v_add_f32_dpp v16, v16, v16 row_ror:8 row_mask:0xf bank_mask:0xf
v_add_f32_dpp v17, v17, v17 row_ror:8 row_mask:0xf bank_mask:0xf
v_add_f32_dpp v16, v18, v18 row_ror:8 row_mask:0xf bank_mask:0xc
v_add_f32_dpp v17, v19, v19 row_ror:8 row_mask:0xf bank_mask:0xc
v_add_f32_dpp v20, v20, v20 row_half_mirror row_mask:0xf bank_mask:0xf
v_add_f32_dpp v20, v21, v21 row_half_mirror row_mask:0xf bank_mask:0xa
v_add_f32_dpp v16, v16, v16 row_half_mirror row_mask:0xf bank_mask:0xf
v_add_f32_dpp v16, v17, v17 row_half_mirror row_mask:0xf bank_mask:0xa
v_add_f32_dpp v20, v20, v20 quad_perm:[1,0,3,2] row_mask:0xf bank_mask:0xf
s_nop 0
v_add_f32_dpp v16, v16, v16 quad_perm:[1,0,3,2] row_mask:0xf bank_mask:0xf
v_add_f32_dpp v20, v20, v20 quad_perm:[2,3,0,1] row_mask:0xf bank_mask:0xf
v_mul_f32 v20, s38, v20
v_add_f32_dpp v16, v16, v16 quad_perm:[2,3,0,1] row_mask:0xf bank_mask:0xf
v_fma_f32 v16, v16, s38, v24
v_fma_f32 v16, -v20, v20, v16
v_rsq_f32 v16, v16
s_nop 0
v_mul_f32 v16, v16, v216
v_fma_f32 v20, -v20, v16, v220
s_nop 0
v_mov_b32_dpp v72, v16 row_newbcast:0 row_mask:0xf bank_mask:0xf
v_mov_b32_dpp v73, v16 row_newbcast:4 row_mask:0xf bank_mask:0xf
v_mov_b32_dpp v74, v16 row_newbcast:8 row_mask:0xf bank_mask:0xf
v_mov_b32_dpp v75, v16 row_newbcast:12 row_mask:0xf bank_mask:0xf
v_mov_b32_dpp v76, v20 row_newbcast:0 row_mask:0xf bank_mask:0xf
v_mov_b32_dpp v77, v20 row_newbcast:4 row_mask:0xf bank_mask:0xf
v_mov_b32_dpp v78, v20 row_newbcast:8 row_mask:0xf bank_mask:0xf
v_mov_b32_dpp v79, v20 row_newbcast:12 row_mask:0xf bank_mask:0xf
v_pk_fma_f32 v[44:45], v[132:133], v[72:73], v[76:77]
v_pk_fma_f32 v[46:47], v[134:135], v[74:75], v[78:79]
v_pk_fma_f32 v[48:49], v[108:109], v[72:73], v[76:77]
v_pk_fma_f32 v[50:51], v[110:111], v[74:75], v[78:79]
v_pk_fma_f32 v[52:53], v[44:45], v[44:45], v[120:121]
v_pk_fma_f32 v[54:55], v[46:47], v[46:47], v[120:121]
v_pk_fma_f32 v[56:57], v[48:49], v[48:49], v[120:121]
v_pk_fma_f32 v[58:59], v[50:51], v[50:51], v[120:121]
v_pk_mul_f32 v[52:53], v[52:53], v[44:45] neg_lo:[0,1] neg_hi:[0,1]
v_pk_mul_f32 v[54:55], v[54:55], v[46:47] neg_lo:[0,1] neg_hi:[0,1]
v_pk_mul_f32 v[56:57], v[56:57], v[48:49] neg_lo:[0,1] neg_hi:[0,1]
v_pk_mul_f32 v[58:59], v[58:59], v[50:51] neg_lo:[0,1] neg_hi:[0,1]
v_exp_f32 v52, v52
v_exp_f32 v53, v53
v_exp_f32 v54, v54
v_exp_f32 v55, v55
v_exp_f32 v56, v56
v_exp_f32 v57, v57
v_exp_f32 v58, v58
v_exp_f32 v59, v59
v_pk_fma_f32 v[52:53], v[52:53], v[124:125], v[124:125]
v_pk_fma_f32 v[54:55], v[54:55], v[124:125], v[124:125]
v_pk_fma_f32 v[56:57], v[56:57], v[124:125], v[124:125]
v_pk_fma_f32 v[58:59], v[58:59], v[124:125], v[124:125]
v_rcp_f32 v52, v52
v_pk_fma_f32 v[84:85], v[80:81], v[72:73], v[76:77]
v_rcp_f32 v53, v53
v_pk_fma_f32 v[86:87], v[82:83], v[74:75], v[78:79]
v_rcp_f32 v54, v54
v_pk_fma_f32 v[88:89], v[140:141], v[72:73], v[76:77]
v_rcp_f32 v55, v55
v_pk_fma_f32 v[90:91], v[142:143], v[74:75], v[78:79]
v_rcp_f32 v56, v56
v_pk_fma_f32 v[92:93], v[84:85], v[84:85], v[120:121]
v_rcp_f32 v57, v57
v_pk_fma_f32 v[94:95], v[86:87], v[86:87], v[120:121]
v_rcp_f32 v58, v58
v_pk_fma_f32 v[96:97], v[88:89], v[88:89], v[120:121]
v_rcp_f32 v59, v59
v_pk_fma_f32 v[98:99], v[90:91], v[90:91], v[120:121]
v_pk_mul_f32 v[92:93], v[92:93], v[84:85] neg_lo:[0,1] neg_hi:[0,1]
v_pk_mul_f32 v[94:95], v[94:95], v[86:87] neg_lo:[0,1] neg_hi:[0,1]
v_pk_mul_f32 v[96:97], v[96:97], v[88:89] neg_lo:[0,1] neg_hi:[0,1]
v_pk_mul_f32 v[98:99], v[98:99], v[90:91] neg_lo:[0,1] neg_hi:[0,1]
v_exp_f32 v92, v92
v_pk_mul_f32 v[44:45], v[52:53], v[44:45]
v_exp_f32 v93, v93
v_pk_mul_f32 v[46:47], v[54:55], v[46:47]
v_exp_f32 v94, v94
v_pk_mul_f32 v[48:49], v[56:57], v[48:49]
v_exp_f32 v95, v95
v_pk_mul_f32 v[50:51], v[58:59], v[50:51]
v_exp_f32 v96, v96
v_cvt_pk_bf16_f32 v60, v44, v45
v_exp_f32 v97, v97
v_cvt_pk_bf16_f32 v61, v46, v47
v_exp_f32 v98, v98
v_cvt_pk_bf16_f32 v62, v48, v49
v_exp_f32 v99, v99
v_cvt_pk_bf16_f32 v63, v50, v51
v_pk_fma_f32 v[92:93], v[92:93], v[124:125], v[124:125]
v_pk_fma_f32 v[94:95], v[94:95], v[124:125], v[124:125]
v_pk_fma_f32 v[96:97], v[96:97], v[124:125], v[124:125]
v_pk_fma_f32 v[98:99], v[98:99], v[124:125], v[124:125]
v_permlane16_swap_b32 v60, v62
v_permlane16_swap_b32 v61, v63
s_mov_b64 exec, s[44:45]
buffer_store_dwordx4 v[60:63], v14, s[4:7], 0 offen offset:0
s_mov_b64 exec, s[42:43]
v_rcp_f32 v92, v92
v_pk_fma_f32 v[44:45], v[136:137], v[72:73], v[76:77]
v_rcp_f32 v93, v93
v_pk_fma_f32 v[46:47], v[138:139], v[74:75], v[78:79]
v_rcp_f32 v94, v94
v_pk_fma_f32 v[48:49], v[116:117], v[72:73], v[76:77]
v_rcp_f32 v95, v95
v_pk_fma_f32 v[50:51], v[118:119], v[74:75], v[78:79]
v_rcp_f32 v96, v96
v_pk_fma_f32 v[52:53], v[44:45], v[44:45], v[120:121]
v_rcp_f32 v97, v97
v_pk_fma_f32 v[54:55], v[46:47], v[46:47], v[120:121]
v_rcp_f32 v98, v98
v_pk_fma_f32 v[56:57], v[48:49], v[48:49], v[120:121]
v_rcp_f32 v99, v99
v_pk_fma_f32 v[58:59], v[50:51], v[50:51], v[120:121]
v_pk_mul_f32 v[52:53], v[52:53], v[44:45] neg_lo:[0,1] neg_hi:[0,1]
v_pk_mul_f32 v[54:55], v[54:55], v[46:47] neg_lo:[0,1] neg_hi:[0,1]
v_pk_mul_f32 v[56:57], v[56:57], v[48:49] neg_lo:[0,1] neg_hi:[0,1]
v_pk_mul_f32 v[58:59], v[58:59], v[50:51] neg_lo:[0,1] neg_hi:[0,1]
v_exp_f32 v52, v52
v_pk_mul_f32 v[84:85], v[92:93], v[84:85]
v_exp_f32 v53, v53
v_pk_mul_f32 v[86:87], v[94:95], v[86:87]
v_exp_f32 v54, v54
v_pk_mul_f32 v[88:89], v[96:97], v[88:89]
v_exp_f32 v55, v55
v_pk_mul_f32 v[90:91], v[98:99], v[90:91]
v_exp_f32 v56, v56
v_cvt_pk_bf16_f32 v100, v84, v85
v_exp_f32 v57, v57
v_cvt_pk_bf16_f32 v101, v86, v87
v_exp_f32 v58, v58
v_cvt_pk_bf16_f32 v102, v88, v89
v_exp_f32 v59, v59
v_cvt_pk_bf16_f32 v103, v90, v91
v_pk_fma_f32 v[52:53], v[52:53], v[124:125], v[124:125]
v_pk_fma_f32 v[54:55], v[54:55], v[124:125], v[124:125]
v_pk_fma_f32 v[56:57], v[56:57], v[124:125], v[124:125]
v_pk_fma_f32 v[58:59], v[58:59], v[124:125], v[124:125]
v_permlane16_swap_b32 v100, v102
v_permlane16_swap_b32 v101, v103
buffer_store_dwordx4 v[100:103], v14, s[4:7], 0 offen offset:2048
v_rcp_f32 v52, v52
v_pk_fma_f32 v[84:85], v[148:149], v[72:73], v[76:77]
v_rcp_f32 v53, v53
v_pk_fma_f32 v[86:87], v[150:151], v[74:75], v[78:79]
v_rcp_f32 v54, v54
v_pk_fma_f32 v[88:89], v[144:145], v[72:73], v[76:77]
v_rcp_f32 v55, v55
v_pk_fma_f32 v[90:91], v[146:147], v[74:75], v[78:79]
v_rcp_f32 v56, v56
v_pk_fma_f32 v[92:93], v[84:85], v[84:85], v[120:121]
v_rcp_f32 v57, v57
v_pk_fma_f32 v[94:95], v[86:87], v[86:87], v[120:121]
v_rcp_f32 v58, v58
v_pk_fma_f32 v[96:97], v[88:89], v[88:89], v[120:121]
v_rcp_f32 v59, v59
v_pk_fma_f32 v[98:99], v[90:91], v[90:91], v[120:121]
v_pk_mul_f32 v[92:93], v[92:93], v[84:85] neg_lo:[0,1] neg_hi:[0,1]
v_pk_mul_f32 v[94:95], v[94:95], v[86:87] neg_lo:[0,1] neg_hi:[0,1]
v_pk_mul_f32 v[96:97], v[96:97], v[88:89] neg_lo:[0,1] neg_hi:[0,1]
v_pk_mul_f32 v[98:99], v[98:99], v[90:91] neg_lo:[0,1] neg_hi:[0,1]
v_exp_f32 v92, v92
v_pk_mul_f32 v[44:45], v[52:53], v[44:45]
v_exp_f32 v93, v93
v_pk_mul_f32 v[46:47], v[54:55], v[46:47]
v_exp_f32 v94, v94
v_pk_mul_f32 v[48:49], v[56:57], v[48:49]
v_exp_f32 v95, v95
v_pk_mul_f32 v[50:51], v[58:59], v[50:51]
v_exp_f32 v96, v96
v_cvt_pk_bf16_f32 v60, v44, v45
v_exp_f32 v97, v97
v_cvt_pk_bf16_f32 v61, v46, v47
v_exp_f32 v98, v98
v_cvt_pk_bf16_f32 v62, v48, v49
v_exp_f32 v99, v99
v_cvt_pk_bf16_f32 v63, v50, v51
v_pk_fma_f32 v[92:93], v[92:93], v[124:125], v[124:125]
v_pk_fma_f32 v[94:95], v[94:95], v[124:125], v[124:125]
v_pk_fma_f32 v[96:97], v[96:97], v[124:125], v[124:125]
v_pk_fma_f32 v[98:99], v[98:99], v[124:125], v[124:125]
v_permlane16_swap_b32 v60, v62
v_permlane16_swap_b32 v61, v63
buffer_store_dwordx4 v[60:63], v15, s[4:7], 0 offen offset:0
v_rcp_f32 v92, v92
v_rcp_f32 v93, v93
v_rcp_f32 v94, v94
v_rcp_f32 v95, v95
v_rcp_f32 v96, v96
v_rcp_f32 v97, v97
v_rcp_f32 v98, v98
v_rcp_f32 v99, v99
v_pk_mul_f32 v[84:85], v[92:93], v[84:85]
v_pk_mul_f32 v[86:87], v[94:95], v[86:87]
v_pk_mul_f32 v[88:89], v[96:97], v[88:89]
v_pk_mul_f32 v[90:91], v[98:99], v[90:91]
v_cvt_pk_bf16_f32 v100, v84, v85
v_cvt_pk_bf16_f32 v101, v86, v87
v_cvt_pk_bf16_f32 v102, v88, v89
v_cvt_pk_bf16_f32 v103, v90, v91
s_nop 1
v_permlane16_swap_b32 v100, v102
v_permlane16_swap_b32 v101, v103
buffer_store_dwordx4 v[100:103], v15, s[4:7], 0 offen offset:2048
L_done:
s_endpgm
L_pad11:
s_branch L_hret
s_nop 0
L_sw:
v_xor_b32 v7, 64, v14
v_xor_b32 v8, 64, v15
s_mov_b32 s33, 2097152
s_mov_b32 s34, 0x40000000
s_mov_b32 s98, 65536
s_lshl_b32 s38, s24, 14
s_lshl_b32 s39, s28, 4
s_add_u32 s38, s38, s39
v_lshlrev_b32 v13, 8, v0
v_add_u32 v13, s38, v13
v_mov_b32 v16, 1
buffer_atomic_add v16, v13, s[16:19], 0 offen sc1
s_branch L_loop
L_watch:
s_mov_b64 vcc, exec
s_mov_b64 exec, -1
buffer_store_dword v68, v3, s[12:15], s34 offen sc1
s_mov_b64 exec, vcc
s_branch L_w2
L_cpoll:
buffer_load_dword v13, v10, s[16:19], 0 offen sc1
s_sub_u32 s47, s47, 1
s_cbranch_scc1 L_iok
s_waitcnt vmcnt(0)
L_cchk:
v_readfirstlane_b32 s39, v13
s_cmp_lt_u32 s39, 16
s_cbranch_scc1 L_cpoll
L_islow:
s_waitcnt vmcnt(1)
v_cmp_eq_u32 vcc, s0, v36
s_nop 0
s_cbranch_vccnz L_irel
buffer_load_dword v36, off, s[96:99], s101 offset:4092 sc1
s_waitcnt vmcnt(1)
v_cmp_eq_u32 vcc, s0, v37
s_nop 0
s_cbranch_vccnz L_irel
buffer_load_dword v37, off, s[96:99], s101 offset:4092 sc1
s_sub_u32 s47, s47, 1
s_cbranch_scc0 L_islow
s_mov_b32 s47, 0
L_irel:
buffer_load_dwordx4 v[152:155], v11, s[96:99], 0 offen offset:0 sc1
buffer_load_dwordx4 v[84:87], v11, s[96:99], 0 offen offset:1024 sc1
buffer_load_dwordx4 v[88:91], v11, s[96:99], 0 offen offset:2048 sc1
buffer_load_dwordx4 v[92:95], v11, s[96:99], 0 offen offset:3072 sc1
buffer_load_dwordx4 v[112:115], v11, s[96:99], s95 offen offset:0 sc1
buffer_load_dwordx4 v[76:79], v11, s[96:99], s95 offen offset:1024 sc1
s_waitcnt vmcnt(0)
v_sad_u32 v16, v155, s0, 0
v_sad_u32 v16, v87, s0, v16
v_sad_u32 v16, v91, s0, v16
v_sad_u32 v16, v95, s0, v16
v_sad_u32 v16, v115, s0, v16
v_sad_u32 v16, v79, s0, v16
v_cmp_ne_u32 vcc, 0, v16
s_sub_u32 s47, s47, 1
s_cbranch_scc1 L_iok
s_cbranch_vccnz L_irel
s_branch L_iok
L_end:
.section .rodata,"a"
.p2align 6
.amdhsa_kernel standalone__self_sup_conv_stem_hubert__speech_kernel
  .amdhsa_next_free_vgpr 512
  .amdhsa_next_free_sgpr 102
  .amdhsa_accum_offset 256
  .amdhsa_group_segment_fixed_size 0
  .amdhsa_kernarg_size 64
  .amdhsa_user_sgpr_count 2
  .amdhsa_user_sgpr_kernarg_segment_ptr 1
  .amdhsa_system_sgpr_workgroup_id_x 1
.end_amdhsa_kernel
```
